```python
import torch

def _softmax(x, axis=-1):
    return torch.softmax(x, dim=axis)
def _gelu(x):
    return torch.nn.functional.gelu(x, approximate="tanh")
def _silu(x):
    return torch.nn.functional.silu(x)
def _sigmoid(x):
    return torch.sigmoid(x)
def _layernorm(x, axis=-1, eps=1e-5):
    m = x.mean(dim=axis, keepdim=True)
    v = x.var(dim=axis, keepdim=True, unbiased=False)
    return (x - m) / torch.sqrt(v + eps)
def _scatter_add(tgt, idx, src, axis=0):
    return tgt.clone().index_add_(axis, idx, src)
def _segment_sum(src, seg, n):
    out = torch.zeros((n,) + src.shape[1:], dtype=src.dtype)
    return out.index_add_(0, seg, src)
def _pad(x, pw):
    flat = tuple(v for pair in reversed(pw) for v in pair)
    return torch.nn.functional.pad(x, flat)

kernel_name = 'sequential_preLN__softmax_full_mha__glu_gated_bilinear__prompt'

def setup_inputs():

    _w = (lambda a: (lambda t: t.to(torch.bfloat16) if t.is_floating_point() else t)(torch.as_tensor(a)))
    def _A_setup():
        B, S, D = 1, 2048, 640
        return {
            "x": _w((lambda *s: torch.randn(*s, dtype=torch.bfloat16) * 0.05)(B, S, D)),
            "wqkv": _w((lambda *s: torch.randn(*s, dtype=torch.bfloat16) * 0.05)(D, 3 * D)),
            "wo": _w((lambda *s: torch.randn(*s, dtype=torch.bfloat16) * 0.05)(D, D)),
        }
    _A_in = _A_setup()

    def _B_setup():
        B, S, D, F = 1, 2048, 640, 1728
        return {
            "x": _w((lambda *s: torch.randn(*s, dtype=torch.bfloat16) * 0.05)(B, S, D)),
            "w_gate": _w((lambda *s: torch.randn(*s, dtype=torch.bfloat16) * 0.8)(D, F) * (D ** -0.5)),
            "w_up": _w((lambda *s: torch.randn(*s, dtype=torch.bfloat16) * 0.8)(D, F) * (D ** -0.5)),
            "w_down": _w((lambda *s: torch.randn(*s, dtype=torch.bfloat16) * 0.8)(F, D) * (F ** -0.5)),
        }
    _B_in = _B_setup()

    return {
        "A_x": _A_in["x"],
        "A_wqkv": _A_in["wqkv"],
        "A_wo": _A_in["wo"],
        "B_x": _B_in["x"],
        "B_w_gate": _B_in["w_gate"],
        "B_w_up": _B_in["w_up"],
        "B_w_down": _B_in["w_down"],
    }

def reference(A_x, A_wqkv, A_wo, B_x, B_w_gate, B_w_up, B_w_down):
    def _A_ref(x, wqkv, wo):
        B, S, D = x.shape
        H = 32; Dh = D // H
        qkv = (lambda x, *d: x.permute(*d))((x @ wqkv).reshape(B, S, 3, H, Dh), 2, 0, 3, 1, 4)
        q, k, v = qkv[0], qkv[1], qkv[2]
        scale = Dh ** -0.5
        scores = torch.einsum("bhqd,bhkd->bhqk", q, k) * scale
        p = _softmax(scores, axis=-1)
        o = torch.einsum("bhqk,bhkd->bhqd", p, v)
        return (lambda x, *d: x.permute(*d))(o, 0, 2, 1, 3).reshape(B, S, D) @ wo

    def _B_ref(x, w_gate, w_up, w_down):
        g = torch.einsum("bsd,df->bsf", x, w_gate)
        u = torch.einsum("bsd,df->bsf", x, w_up)
        h = g * u
        return torch.einsum("bsf,fd->bsd", h, w_down)

    x = A_x
    h = x + _A_ref(_layernorm(x, axis=-1), A_wqkv, A_wo)
    h2 = h + _B_ref(_layernorm(h, axis=-1), B_w_gate, B_w_up, B_w_down)
    return h2
```

```asm
; @launch grid=(256,1,1) block=(512,1,1) lds=163840
.amdgcn_target "amdgcn-amd-amdhsa--gfx950"
.text
.globl sequential_preLN__softmax_full_mha__glu_gated_bilinear__prompt_kernel
.type sequential_preLN__softmax_full_mha__glu_gated_bilinear__prompt_kernel,@function
.p2align 8
sequential_preLN__softmax_full_mha__glu_gated_bilinear__prompt_kernel:
    s_load_dwordx16 s[36:51], s[0:1], 0
    s_load_dwordx4 s[52:55], s[0:1], 64
    s_getpc_b64 s[74:75]
    s_cmp_ge_u32 s2, 256
    s_cbranch_scc1 L_end
    v_lshrrev_b32 v4, 6, v0
    v_and_b32 v10, 63, v0
    v_readfirstlane_b32 s28, v4
    v_lshlrev_b32 v9, 4, v0
    s_and_b32 s29, s2, 7
    s_lshr_b32 s30, s2, 3
    s_lshl_b32 s84, s29, 1
    s_lshr_b32 s34, s30, 4
    s_add_u32 s84, s84, s34
    s_and_b32 s85, s30, 15
    s_and_b32 s34, s29, 3
    s_mul_i32 s34, s34, 5
    s_cmp_ge_u32 s85, s34
    s_cselect_b32 s86, 15, 10
    s_add_u32 s86, s86, s85
    s_cmp_ge_u32 s85, 10
    s_cselect_b32 s96, s34, 0
    s_add_u32 s96, s96, s85
    s_and_b32 s87, s28, 3
    v_and_b32 v11, 31, v10
    v_lshrrev_b32 v12, 5, v10
    v_lshlrev_b32 v1, 4, v10
    s_mov_b32 s72, 0
    s_mov_b32 s73, -1
    s_mov_b32 s64, 2146435072
    s_mov_b32 s97, 1
    s_cmp_eq_u32 s85, 15
    s_cbranch_scc1 L_spare
    s_cmp_lt_u32 s28, 4
    s_cbranch_scc1 L_p1c
    s_lshl_b32 s34, s30, 2
    s_add_u32 s34, s34, s87
    s_mul_i32 s34, s34, 640
    v_lshl_add_u32 v70, v10, 7, s34
    v_min_u32 v70, L_end-sequential_preLN__softmax_full_mha__glu_gated_bilinear__prompt_kernel-128, v70
    s_mov_b64 exec, 31
    global_load_dword v71, v70, s[74:75]
    s_mov_b64 exec, -1
    v_lshrrev_b32 v4, 3, v10
    v_mul_u32_u24 v8, 1280, v4
    v_lshrrev_b32 v5, 4, v10
    v_and_b32 v6, 7, v10
    v_xor_b32 v7, v6, v5
    v_lshl_add_u32 v16, v7, 4, v8
    v_xor_b32 v7, 64, v16
    v_add_u32 v17, 9216, v7
    v_add_u32 v18, 18432, v16
    v_add_u32 v19, 27648, v7
    v_mul_u32_u24 v4, 3840, v4
    v_and_b32 v5, 1, v5
    v_lshlrev_b32 v5, 2, v5
    v_xor_b32 v6, v6, v5
    v_lshl_add_u32 v20, v6, 4, v4
    v_add_u32 v21, 29696, v20
    s_lshl_b32 s88, s84, 2
    s_add_u32 s88, s88, s87
    s_mul_i32 s88, s88, 40960
    s_mul_i32 s35, s87, 61440
    s_lshl_b32 s34, s86, 7
    s_add_u32 s89, s35, s34
    s_lshl_b32 s34, s96, 7
    s_add_u32 s82, s35, s34
    s_lshl_b32 s97, s87, 12
    s_lshl_b32 s91, s87, 11
    s_mul_i32 s98, s85, 3
    s_mul_i32 s34, s29, 1
    s_add_u32 s98, s98, s34
    s_lshr_b32 s34, s30, 4
    s_mul_i32 s34, s34, 0
    s_add_u32 s98, s98, s34
    s_mul_i32 s34, s98, 205
    s_lshr_b32 s34, s34, 11
    s_mul_i32 s34, s34, 10
    s_sub_u32 s98, s98, s34
    s_waitcnt lgkmcnt(0)
    s_mov_b32 s95, 1
    s_mov_b32 s4, s36
    s_mov_b32 s5, s37
    s_mov_b32 s6, 2621440
    s_mov_b32 s7, 0x00020000
    s_mov_b32 s20, s38
    s_mov_b32 s21, s39
    s_mov_b32 s22, 2457600
    s_mov_b32 s23, 0x00020000
    s_add_u32 s99, s98, 0
    s_cmp_ge_u32 s99, 10
    s_cselect_b32 s34, 10, 0
    s_sub_u32 s99, s99, s34
    s_lshl_b32 s34, s99, 7
    s_add_u32 m0, s97, 0
    s_add_u32 s34, s88, s34
    buffer_load_dwordx4 v16, s[4:7], s34 offen offset:0 lds
    buffer_load_dwordx4 v17, s[4:7], s34 offen offset:1024 lds
    buffer_load_dwordx4 v18, s[4:7], s34 offen offset:2048 lds
    buffer_load_dwordx4 v19, s[4:7], s34 offen offset:3072 lds
    s_mul_i32 s34, s99, 245760
    s_add_u32 m0, s91, 65536
    s_add_u32 s34, s89, s34
    buffer_load_dwordx4 v20, s[20:23], s34 offen offset:0 lds
    buffer_load_dwordx4 v21, s[20:23], s34 offen offset:1024 lds
    s_mov_b32 s16, s54
    s_mov_b32 s17, s55
    s_mov_b32 s18, 31457280
    s_mov_b32 s19, 0x00020000
    s_mov_b32 s24, s52
    s_mov_b32 s25, s53
    s_mov_b32 s26, 256
    s_mov_b32 s27, 0x00020000
    s_getreg_b32 s32, hwreg(HW_REG_XCC_ID, 0, 4)
    s_lshl_b32 s34, s29, 12
    s_add_u32 s34, s34, 28102660
    s_add_u32 s32, s32, 1
    v_lshl_add_u32 v75, v11, 7, s34
    v_mov_b32 v69, s32
    s_lshl_b32 s64, s30, 7
    s_add_u32 s64, s64, s34
    s_cmp_eq_u32 s28, 4
    s_cselect_b32 s64, s64, 2146435072
    v_and_b32 v76, 15, v10
    v_lshlrev_b32 v76, 2, v76
    s_lshl_b32 s34, s29, 3
    v_and_or_b32 v68, v76, 4, s34
    s_add_u32 s99, s98, 1
    s_cmp_ge_u32 s99, 10
    s_cselect_b32 s34, 10, 0
    s_sub_u32 s99, s99, s34
    s_lshl_b32 s34, s99, 7
    s_add_u32 m0, s97, 16384
    s_add_u32 s34, s88, s34
    buffer_load_dwordx4 v16, s[4:7], s34 offen offset:0 lds
    buffer_load_dwordx4 v17, s[4:7], s34 offen offset:1024 lds
    buffer_load_dwordx4 v18, s[4:7], s34 offen offset:2048 lds
    buffer_load_dwordx4 v19, s[4:7], s34 offen offset:3072 lds
    s_mul_i32 s34, s99, 245760
    s_add_u32 m0, s91, 73728
    s_add_u32 s34, s89, s34
    buffer_load_dwordx4 v20, s[20:23], s34 offen offset:0 lds
    buffer_load_dwordx4 v21, s[20:23], s34 offen offset:1024 lds
    s_waitcnt vmcnt(6)
    s_barrier
    s_add_u32 s99, s98, 2
    s_cmp_ge_u32 s99, 10
    s_cselect_b32 s34, 10, 0
    s_sub_u32 s99, s99, s34
    s_lshl_b32 s34, s99, 7
    s_add_u32 m0, s97, 32768
    s_add_u32 s34, s88, s34
    buffer_load_dwordx4 v16, s[4:7], s34 offen offset:0 lds
    buffer_load_dwordx4 v17, s[4:7], s34 offen offset:1024 lds
    buffer_load_dwordx4 v18, s[4:7], s34 offen offset:2048 lds
    buffer_load_dwordx4 v19, s[4:7], s34 offen offset:3072 lds
    s_mul_i32 s34, s99, 245760
    s_add_u32 m0, s91, 81920
    s_add_u32 s34, s89, s34
    buffer_load_dwordx4 v20, s[20:23], s34 offen offset:0 lds
    buffer_load_dwordx4 v21, s[20:23], s34 offen offset:1024 lds
    s_add_u32 s99, s98, 3
    s_cmp_ge_u32 s99, 10
    s_cselect_b32 s34, 10, 0
    s_sub_u32 s99, s99, s34
    s_lshl_b32 s34, s99, 7
    s_add_u32 m0, s97, 49152
    s_add_u32 s34, s88, s34
    buffer_load_dwordx4 v16, s[4:7], s34 offen offset:0 lds
    s_and_b32 s80, s87, 1
    s_lshr_b32 s81, s87, 1
    v_bfe_u32 v4, v10, 2, 2
    v_lshl_add_u32 v5, v12, 3, v4
    v_lshlrev_b32 v5, 7, v5
    v_lshrrev_b32 v4, 1, v4
    v_xor_b32 v4, s80, v4
    v_lshl_add_u32 v5, v4, 6, v5
    v_bfe_u32 v4, v10, 4, 1
    v_lshl_add_u32 v5, v4, 5, v5
    v_add_u32 v5, 98304, v5
    v_and_b32 v4, 1, v10
    v_bfe_u32 v6, v10, 1, 1
    v_lshl_add_u32 v4, v4, 1, v6
    v_and_b32 v6, 3, v10
    s_cmp_ge_u32 s96, 20
    s_cselect_b64 s[76:77], -1, 0
    v_cndmask_b32 v4, v4, v6, s[76:77]
    v_lshl_add_u32 v22, v4, 3, v5
    v_bfe_u32 v4, v10, 1, 2
    v_cmp_eq_u32 vcc, 0, v4
    v_cmp_eq_u32 s[76:77], 2, v4
    v_mov_b32 v5, 0x3f803f80
    v_and_b32 v4, 1, v10
    v_cndmask_b32 v24, 0, v5, vcc
    v_cndmask_b32 v25, 0, v5, vcc
    v_cndmask_b32 v26, 0, v5, s[76:77]
    v_cndmask_b32 v27, 0, v5, s[76:77]
    v_mul_u32_u24 v4, 0xaaaa, v4
    v_add_u32 v28, 0x4444, v4
    v_lshl_or_b32 v28, v28, 16, v28
    v_mov_b32 v32, 0
    v_mov_b32 v33, 0
    v_mov_b32 v34, 0
    v_mov_b32 v35, 0
    s_lshl_b32 s34, s81, 12
    v_add_u32 v22, s34, v22
    v_subrev_u32 v23, 16384, v22
    s_lshl_b32 s80, s80, 9
    s_lshl_b32 s81, s81, 8
    s_add_u32 s80, s80, s81
    s_add_u32 s80, s80, 32768
    v_lshl_add_u32 v64, v11, 3, s80
    v_mov_b32 v65, 34304
    s_lshl_b32 s34, s84, 2
    s_add_u32 s34, s34, s87
    s_mul_i32 s34, s34, 110592
    s_add_u32 s34, s34, 13238272
    s_mul_i32 s35, s85, 22
    v_add_u32 v72, s35, v10
    v_min_u32 v72, 319, v72
    v_lshl_add_u32 v72, v72, 7, s34
    s_waitcnt vmcnt(7)
    s_barrier
    s_add_u32 s99, s98, 3
    s_cmp_ge_u32 s99, 10
    s_cselect_b32 s34, 10, 0
    s_sub_u32 s99, s99, s34
    s_lshl_b32 s34, s99, 7
    s_add_u32 m0, s97, 49152
    s_add_u32 s34, s88, s34
    buffer_load_dwordx4 v17, s[4:7], s34 offen offset:1024 lds
    buffer_load_dwordx4 v18, s[4:7], s34 offen offset:2048 lds
    buffer_load_dwordx4 v19, s[4:7], s34 offen offset:3072 lds
    s_mul_i32 s34, s99, 245760
    s_add_u32 m0, s91, 90112
    s_add_u32 s34, s89, s34
    buffer_load_dwordx4 v20, s[20:23], s34 offen offset:0 lds
    buffer_load_dwordx4 v21, s[20:23], s34 offen offset:1024 lds
    s_add_u32 s99, s98, 4
    s_cmp_ge_u32 s99, 10
    s_cselect_b32 s34, 10, 0
    s_sub_u32 s99, s99, s34
    s_lshl_b32 s34, s99, 7
    s_add_u32 m0, s97, 0
    s_add_u32 s34, s88, s34
    buffer_load_dwordx4 v16, s[4:7], s34 offen offset:0 lds
    buffer_load_dwordx4 v17, s[4:7], s34 offen offset:1024 lds
    s_waitcnt vmcnt(8)
    s_barrier
    s_add_u32 s99, s98, 4
    s_cmp_ge_u32 s99, 10
    s_cselect_b32 s34, 10, 0
    s_sub_u32 s99, s99, s34
    s_lshl_b32 s34, s99, 7
    s_add_u32 m0, s97, 0
    s_add_u32 s34, s88, s34
    buffer_load_dwordx4 v18, s[4:7], s34 offen offset:2048 lds
    buffer_load_dwordx4 v19, s[4:7], s34 offen offset:3072 lds
    s_mul_i32 s34, s99, 245760
    s_add_u32 m0, s91, 65536
    s_add_u32 s34, s89, s34
    buffer_load_dwordx4 v20, s[20:23], s34 offen offset:0 lds
    buffer_load_dwordx4 v21, s[20:23], s34 offen offset:1024 lds
    s_add_u32 s99, s98, 5
    s_cmp_ge_u32 s99, 10
    s_cselect_b32 s34, 10, 0
    s_sub_u32 s99, s99, s34
    s_lshl_b32 s34, s99, 7
    s_add_u32 m0, s97, 16384
    s_add_u32 s34, s88, s34
    buffer_load_dwordx4 v16, s[4:7], s34 offen offset:0 lds
    buffer_load_dwordx4 v17, s[4:7], s34 offen offset:1024 lds
    buffer_load_dwordx4 v18, s[4:7], s34 offen offset:2048 lds
    s_branch L_ch0
L_hr0:
    s_waitcnt vmcnt(9)
    s_barrier
    s_add_u32 s99, s98, 5
    s_cmp_ge_u32 s99, 10
    s_cselect_b32 s34, 10, 0
    s_sub_u32 s99, s99, s34
    s_lshl_b32 s34, s99, 7
    s_add_u32 m0, s97, 16384
    s_add_u32 s34, s88, s34
    buffer_load_dwordx4 v19, s[4:7], s34 offen offset:3072 lds
    s_mul_i32 s34, s99, 245760
    s_add_u32 m0, s91, 73728
    s_add_u32 s34, s89, s34
    buffer_load_dwordx4 v20, s[20:23], s34 offen offset:0 lds
    buffer_load_dwordx4 v21, s[20:23], s34 offen offset:1024 lds
    s_add_u32 s99, s98, 6
    s_cmp_ge_u32 s99, 10
    s_cselect_b32 s34, 10, 0
    s_sub_u32 s99, s99, s34
    s_lshl_b32 s34, s99, 7
    s_add_u32 m0, s97, 32768
    s_add_u32 s34, s88, s34
    buffer_load_dwordx4 v16, s[4:7], s34 offen offset:0 lds
    buffer_load_dwordx4 v17, s[4:7], s34 offen offset:1024 lds
    buffer_load_dwordx4 v18, s[4:7], s34 offen offset:2048 lds
    buffer_load_dword v67, v68, s[24:27], 0 offen sc1
    s_waitcnt vmcnt(10)
    s_barrier
    s_add_u32 s99, s98, 6
    s_cmp_ge_u32 s99, 10
    s_cselect_b32 s34, 10, 0
    s_sub_u32 s99, s99, s34
    s_lshl_b32 s34, s99, 7
    s_add_u32 m0, s97, 32768
    s_add_u32 s34, s88, s34
    buffer_load_dwordx4 v19, s[4:7], s34 offen offset:3072 lds
    s_mul_i32 s34, s99, 245760
    s_add_u32 m0, s91, 81920
    s_add_u32 s34, s89, s34
    buffer_load_dwordx4 v20, s[20:23], s34 offen offset:0 lds
    buffer_load_dwordx4 v21, s[20:23], s34 offen offset:1024 lds
    s_add_u32 s99, s98, 7
    s_cmp_ge_u32 s99, 10
    s_cselect_b32 s34, 10, 0
    s_sub_u32 s99, s99, s34
    s_lshl_b32 s34, s99, 7
    s_add_u32 m0, s97, 49152
    s_add_u32 s34, s88, s34
    buffer_load_dwordx4 v16, s[4:7], s34 offen offset:0 lds
    buffer_load_dwordx4 v17, s[4:7], s34 offen offset:1024 lds
    buffer_load_dwordx4 v18, s[4:7], s34 offen offset:2048 lds
    s_waitcnt vmcnt(6)
    s_barrier
    s_add_u32 s99, s98, 7
    s_cmp_ge_u32 s99, 10
    s_cselect_b32 s34, 10, 0
    s_sub_u32 s99, s99, s34
    s_lshl_b32 s34, s99, 7
    s_add_u32 m0, s97, 49152
    s_add_u32 s34, s88, s34
    buffer_load_dwordx4 v19, s[4:7], s34 offen offset:3072 lds
    s_mul_i32 s34, s99, 245760
    s_add_u32 m0, s91, 90112
    s_add_u32 s34, s89, s34
    buffer_load_dwordx4 v20, s[20:23], s34 offen offset:0 lds
    buffer_load_dwordx4 v21, s[20:23], s34 offen offset:1024 lds
    s_add_u32 s99, s98, 8
    s_cmp_ge_u32 s99, 10
    s_cselect_b32 s34, 10, 0
    s_sub_u32 s99, s99, s34
    s_lshl_b32 s34, s99, 7
    s_add_u32 m0, s97, 0
    s_add_u32 s34, s88, s34
    buffer_load_dwordx4 v16, s[4:7], s34 offen offset:0 lds
    buffer_load_dwordx4 v17, s[4:7], s34 offen offset:1024 lds
    buffer_load_dwordx4 v18, s[4:7], s34 offen offset:2048 lds
    s_branch L_ch1
L_hr1:
    s_mov_b32 s56, 400000
L_dc1:
    v_cmp_eq_u32 vcc, 0, v67
    s_nop 0
    s_cbranch_vccnz L_dr1
L_do1:
    buffer_store_dword v69, off, s[16:19], s64 sc1
    s_waitcnt vmcnt(10)
    s_barrier
    s_add_u32 s99, s98, 8
    s_cmp_ge_u32 s99, 10
    s_cselect_b32 s34, 10, 0
    s_sub_u32 s99, s99, s34
    s_lshl_b32 s34, s99, 7
    s_add_u32 m0, s97, 0
    s_add_u32 s34, s88, s34
    buffer_load_dwordx4 v19, s[4:7], s34 offen offset:3072 lds
    s_mul_i32 s34, s99, 245760
    s_add_u32 m0, s91, 65536
    s_add_u32 s34, s89, s34
    buffer_load_dwordx4 v20, s[20:23], s34 offen offset:0 lds
    buffer_load_dwordx4 v21, s[20:23], s34 offen offset:1024 lds
    s_add_u32 s99, s98, 9
    s_cmp_ge_u32 s99, 10
    s_cselect_b32 s34, 10, 0
    s_sub_u32 s99, s99, s34
    s_lshl_b32 s34, s99, 7
    s_add_u32 m0, s97, 16384
    s_add_u32 s34, s88, s34
    buffer_load_dwordx4 v16, s[4:7], s34 offen offset:0 lds
    buffer_load_dwordx4 v17, s[4:7], s34 offen offset:1024 lds
    buffer_load_dwordx4 v18, s[4:7], s34 offen offset:2048 lds
    s_waitcnt vmcnt(10)
    s_barrier
    s_add_u32 s99, s98, 9
    s_cmp_ge_u32 s99, 10
    s_cselect_b32 s34, 10, 0
    s_sub_u32 s99, s99, s34
    s_lshl_b32 s34, s99, 7
    s_add_u32 m0, s97, 16384
    s_add_u32 s34, s88, s34
    buffer_load_dwordx4 v19, s[4:7], s34 offen offset:3072 lds
    s_mul_i32 s34, s99, 245760
    s_add_u32 m0, s91, 73728
    s_add_u32 s34, s89, s34
    buffer_load_dwordx4 v20, s[20:23], s34 offen offset:0 lds
    buffer_load_dwordx4 v21, s[20:23], s34 offen offset:1024 lds
    s_add_u32 s99, s98, 0
    s_cmp_ge_u32 s99, 10
    s_cselect_b32 s34, 10, 0
    s_sub_u32 s99, s99, s34
    s_mul_i32 s34, s99, 245760
    s_add_u32 m0, s91, 98304
    s_add_u32 s34, s82, s34
    buffer_load_dwordx4 v20, s[20:23], s34 offen offset:0 lds
    buffer_load_dwordx4 v21, s[20:23], s34 offen offset:1024 lds
    s_waitcnt vmcnt(8)
    s_barrier
    s_add_u32 s99, s98, 1
    s_cmp_ge_u32 s99, 10
    s_cselect_b32 s34, 10, 0
    s_sub_u32 s99, s99, s34
    s_mul_i32 s34, s99, 245760
    s_add_u32 m0, s91, 106496
    s_add_u32 s34, s82, s34
    buffer_load_dwordx4 v20, s[20:23], s34 offen offset:0 lds
    buffer_load_dwordx4 v21, s[20:23], s34 offen offset:1024 lds
    s_add_u32 s99, s98, 7
    s_cmp_ge_u32 s99, 10
    s_cselect_b32 s34, 10, 0
    s_sub_u32 s99, s99, s34
    s_mul_i32 s34, s99, 245760
    s_add_u32 m0, s91, 114688
    s_add_u32 s34, s82, s34
    buffer_load_dwordx4 v20, s[20:23], s34 offen offset:0 lds
    buffer_load_dwordx4 v21, s[20:23], s34 offen offset:1024 lds
    s_add_u32 s99, s98, 8
    s_cmp_ge_u32 s99, 10
    s_cselect_b32 s34, 10, 0
    s_sub_u32 s99, s99, s34
    s_mul_i32 s34, s99, 245760
    s_add_u32 m0, s91, 122880
    s_add_u32 s34, s82, s34
    buffer_load_dwordx4 v20, s[20:23], s34 offen offset:0 lds
    buffer_load_dwordx4 v21, s[20:23], s34 offen offset:1024 lds
    s_branch L_ch8
L_hr8:
    s_waitcnt vmcnt(8)
    s_barrier
    s_add_u32 s99, s98, 9
    s_cmp_ge_u32 s99, 10
    s_cselect_b32 s34, 10, 0
    s_sub_u32 s99, s99, s34
    s_mul_i32 s34, s99, 245760
    s_add_u32 m0, s91, 131072
    s_add_u32 s34, s82, s34
    buffer_load_dwordx4 v20, s[20:23], s34 offen offset:0 lds
    buffer_load_dwordx4 v21, s[20:23], s34 offen offset:1024 lds
    s_add_u32 s99, s98, 2
    s_cmp_ge_u32 s99, 10
    s_cselect_b32 s34, 10, 0
    s_sub_u32 s99, s99, s34
    s_mul_i32 s34, s99, 245760
    s_add_u32 m0, s91, 139264
    s_add_u32 s34, s82, s34
    buffer_load_dwordx4 v20, s[20:23], s34 offen offset:0 lds
    buffer_load_dwordx4 v21, s[20:23], s34 offen offset:1024 lds
    s_add_u32 s99, s98, 3
    s_cmp_ge_u32 s99, 10
    s_cselect_b32 s34, 10, 0
    s_sub_u32 s99, s99, s34
    s_mul_i32 s34, s99, 245760
    s_add_u32 m0, s91, 147456
    s_add_u32 s34, s82, s34
    buffer_load_dwordx4 v20, s[20:23], s34 offen offset:0 lds
    buffer_load_dwordx4 v21, s[20:23], s34 offen offset:1024 lds
    s_setprio 1
    s_waitcnt vmcnt(12) lgkmcnt(0)
    s_barrier
    s_add_u32 s99, s98, 4
    s_cmp_ge_u32 s99, 10
    s_cselect_b32 s34, 10, 0
    s_sub_u32 s99, s99, s34
    s_mul_i32 s34, s99, 245760
    s_add_u32 m0, s91, 155648
    s_add_u32 s34, s82, s34
    buffer_load_dwordx4 v20, s[20:23], s34 offen offset:0 lds
    buffer_load_dwordx4 v21, s[20:23], s34 offen offset:1024 lds
    s_add_u32 s99, s98, 5
    s_cmp_ge_u32 s99, 10
    s_cselect_b32 s34, 10, 0
    s_sub_u32 s99, s99, s34
    s_mul_i32 s34, s99, 245760
    s_add_u32 m0, s91, 81920
    s_add_u32 s34, s82, s34
    buffer_load_dwordx4 v20, s[20:23], s34 offen offset:0 lds
    buffer_load_dwordx4 v21, s[20:23], s34 offen offset:1024 lds
    s_add_u32 s99, s98, 6
    s_cmp_ge_u32 s99, 10
    s_cselect_b32 s34, 10, 0
    s_sub_u32 s99, s99, s34
    s_mul_i32 s34, s99, 245760
    s_add_u32 m0, s91, 90112
    s_add_u32 s34, s82, s34
    buffer_load_dwordx4 v20, s[20:23], s34 offen offset:0 lds
    buffer_load_dwordx4 v21, s[20:23], s34 offen offset:1024 lds
    ds_read_b64_tr_b16 v[40:41], v22 offset:0
    ds_read_b64_tr_b16 v[42:43], v22 offset:512
    ds_read_b64_tr_b16 v[44:45], v22 offset:2048
    ds_read_b64_tr_b16 v[46:47], v22 offset:2560
    s_waitcnt lgkmcnt(0)
    v_smfmac_f32_16x16x64_bf16 v[32:35], v[24:27], v[40:47], v28
    s_waitcnt vmcnt(14) lgkmcnt(0)
    s_barrier
    ds_read_b64_tr_b16 v[40:41], v22 offset:8192
    ds_read_b64_tr_b16 v[42:43], v22 offset:8704
    ds_read_b64_tr_b16 v[44:45], v22 offset:10240
    ds_read_b64_tr_b16 v[46:47], v22 offset:10752
    ds_read_b64_tr_b16 v[48:49], v22 offset:16384
    ds_read_b64_tr_b16 v[50:51], v22 offset:16896
    ds_read_b64_tr_b16 v[52:53], v22 offset:18432
    ds_read_b64_tr_b16 v[54:55], v22 offset:18944
    s_waitcnt lgkmcnt(4)
    v_smfmac_f32_16x16x64_bf16 v[32:35], v[24:27], v[40:47], v28
    s_waitcnt lgkmcnt(0)
    v_smfmac_f32_16x16x64_bf16 v[32:35], v[24:27], v[48:55], v28
    s_waitcnt vmcnt(10) lgkmcnt(0)
    s_barrier
    buffer_load_dword v67, v75, s[16:19], 0 offen sc1
    ds_read_b64_tr_b16 v[40:41], v22 offset:24576
    ds_read_b64_tr_b16 v[42:43], v22 offset:25088
    ds_read_b64_tr_b16 v[44:45], v22 offset:26624
    ds_read_b64_tr_b16 v[46:47], v22 offset:27136
    ds_read_b64_tr_b16 v[48:49], v22 offset:32768
    ds_read_b64_tr_b16 v[50:51], v22 offset:33280
    ds_read_b64_tr_b16 v[52:53], v22 offset:34816
    ds_read_b64_tr_b16 v[54:55], v22 offset:35328
    s_waitcnt lgkmcnt(4)
    v_smfmac_f32_16x16x64_bf16 v[32:35], v[24:27], v[40:47], v28
    s_waitcnt lgkmcnt(0)
    v_smfmac_f32_16x16x64_bf16 v[32:35], v[24:27], v[48:55], v28
    s_waitcnt vmcnt(5) lgkmcnt(0)
    s_barrier
    s_mov_b64 exec, 0x3fffff
    buffer_load_dword v74, v72, s[16:19], 0 offen sc1
    s_mov_b64 exec, -1
    ds_read_b64_tr_b16 v[40:41], v22 offset:40960
    ds_read_b64_tr_b16 v[42:43], v22 offset:41472
    ds_read_b64_tr_b16 v[44:45], v22 offset:43008
    ds_read_b64_tr_b16 v[46:47], v22 offset:43520
    ds_read_b64_tr_b16 v[48:49], v22 offset:49152
    ds_read_b64_tr_b16 v[50:51], v22 offset:49664
    ds_read_b64_tr_b16 v[52:53], v22 offset:51200
    ds_read_b64_tr_b16 v[54:55], v22 offset:51712
    ds_read_b64_tr_b16 v[56:57], v22 offset:57344
    ds_read_b64_tr_b16 v[58:59], v22 offset:57856
    ds_read_b64_tr_b16 v[60:61], v22 offset:59392
    ds_read_b64_tr_b16 v[62:63], v22 offset:59904
    s_waitcnt lgkmcnt(8)
    v_smfmac_f32_16x16x64_bf16 v[32:35], v[24:27], v[40:47], v28
    s_waitcnt lgkmcnt(4)
    v_smfmac_f32_16x16x64_bf16 v[32:35], v[24:27], v[48:55], v28
    s_waitcnt lgkmcnt(0)
    v_smfmac_f32_16x16x64_bf16 v[32:35], v[24:27], v[56:63], v28
    s_waitcnt vmcnt(1) lgkmcnt(0)
    s_barrier
    s_mov_b32 s56, 400000
L_dc2:
    v_cmp_eq_u32 vcc, 0, v67
    s_nop 0
    s_cbranch_vccnz L_dr2
L_do2:
    v_cmp_ne_u32 vcc, s32, v67
    s_nop 0
    s_cmp_lg_u32 vcc_lo, 0
    s_cselect_b32 s31, 1, 0
    v_mov_b32 v66, s31
    ds_write_b32 v65, v66
    buffer_load_dword v67, v76, s[24:27], 0 offen sc1
    ds_read_b64_tr_b16 v[40:41], v23 offset:0
    ds_read_b64_tr_b16 v[42:43], v23 offset:512
    ds_read_b64_tr_b16 v[44:45], v23 offset:2048
    ds_read_b64_tr_b16 v[46:47], v23 offset:2560
    ds_read_b64_tr_b16 v[48:49], v23 offset:8192
    ds_read_b64_tr_b16 v[50:51], v23 offset:8704
    ds_read_b64_tr_b16 v[52:53], v23 offset:10240
    ds_read_b64_tr_b16 v[54:55], v23 offset:10752
    s_waitcnt lgkmcnt(4)
    v_smfmac_f32_16x16x64_bf16 v[32:35], v[24:27], v[40:47], v28
    s_waitcnt lgkmcnt(0)
    v_smfmac_f32_16x16x64_bf16 v[32:35], v[24:27], v[48:55], v28
    s_nop 7
    v_add_f32 v6, v32, v33
    v_cvt_pk_bf16_f32 v9, v6, 0
    v_lshlrev_b32 v8, 16, v9
    v_sub_f32 v8, v6, v8
    v_cvt_pk_bf16_f32 v8, v6, v8
    ds_write_b64 v64, v[8:9]
    s_waitcnt lgkmcnt(0)
    s_barrier
    s_setprio 0
    s_branch L_ch2
L_hr2:
    s_branch L_ch3
L_hr3:
    s_branch L_ch4
L_hr4:
    s_cmp_eq_u32 s28, 4
    s_cbranch_scc0 L_hk
    s_mov_b32 s83, 28135424
    s_mul_i32 s82, s30, 163840
    s_waitcnt vmcnt(0)
    s_mov_b32 s56, 400000
L_dc3:
    v_cmp_eq_u32 vcc, 0, v67
    s_nop 0
    s_cbranch_vccnz L_dr3
L_do3:
    s_mov_b32 exec_hi, 0
    s_mov_b32 s56, 400000
    s_branch L_pin4
L_poll4:
    s_sleep 1
L_pin4:
    buffer_load_dwordx4 v[16:19], v179, s[16:19], s83 offen sc1
    s_sub_u32 s56, s56, 1
    s_waitcnt vmcnt(0)
    v_min3_u32 v16, v16, v17, v18
    v_min_u32 v16, v16, v19
    v_cmp_eq_u32 vcc, 0, v16
    s_cbranch_scc1 L_pout4
    s_cbranch_vccnz L_poll4
L_pout4:
    s_mov_b32 exec_hi, -1
    s_mov_b32 m0, 0
    s_add_u32 s34, s82, 2621440
    buffer_load_dwordx4 v1, s[16:19], s34 offen offset:0 sc1 lds
    buffer_load_dwordx4 v1, s[16:19], s34 offen offset:1024 sc1 lds
    buffer_load_dwordx4 v1, s[16:19], s34 offen offset:2048 sc1 lds
    buffer_load_dwordx4 v1, s[16:19], s34 offen offset:3072 sc1 lds
    s_mov_b32 m0, 4096
    s_add_u32 s34, s82, 2625536
    buffer_load_dwordx4 v1, s[16:19], s34 offen offset:0 sc1 lds
    buffer_load_dwordx4 v1, s[16:19], s34 offen offset:1024 sc1 lds
    buffer_load_dwordx4 v1, s[16:19], s34 offen offset:2048 sc1 lds
    buffer_load_dwordx4 v1, s[16:19], s34 offen offset:3072 sc1 lds
    s_mov_b32 m0, 8192
    s_add_u32 s34, s82, 2629632
    buffer_load_dwordx4 v1, s[16:19], s34 offen offset:0 sc1 lds
    buffer_load_dwordx4 v1, s[16:19], s34 offen offset:1024 sc1 lds
    buffer_load_dwordx4 v1, s[16:19], s34 offen offset:2048 sc1 lds
    buffer_load_dwordx4 v1, s[16:19], s34 offen offset:3072 sc1 lds
    s_mov_b32 m0, 12288
    s_add_u32 s34, s82, 2633728
    buffer_load_dwordx4 v1, s[16:19], s34 offen offset:0 sc1 lds
    buffer_load_dwordx4 v1, s[16:19], s34 offen offset:1024 sc1 lds
    buffer_load_dwordx4 v1, s[16:19], s34 offen offset:2048 sc1 lds
    buffer_load_dwordx4 v1, s[16:19], s34 offen offset:3072 sc1 lds
L_hk:
    s_branch L_ch5
L_hr5:
    s_branch L_ch6
L_hr6:
    s_branch L_ch7
L_hr7:
    s_mov_b32 s95, 0
    s_branch L_kd
L_p1c:
    s_lshl_b32 s34, s28, 12
    v_bfe_u32 v4, v11, 1, 3
    v_xor_b32 v4, v4, v12
    v_lshlrev_b32 v4, 4, v4
    v_lshl_add_u32 v4, v11, 7, v4
    v_add_u32 v2, s34, v4
    v_xor_b32 v3, 32, v2
    v_xor_b32 v13, 64, v2
    v_xor_b32 v14, 96, v2
    v_bfe_u32 v4, v10, 2, 2
    v_lshl_add_u32 v5, v12, 3, v4
    v_lshlrev_b32 v5, 7, v5
    v_lshrrev_b32 v4, 1, v4
    v_lshl_add_u32 v5, v4, 6, v5
    v_bfe_u32 v4, v10, 4, 1
    v_lshl_add_u32 v5, v4, 5, v5
    v_add_u32 v5, 65536, v5
    v_and_b32 v4, 1, v10
    v_bfe_u32 v6, v10, 1, 1
    v_lshl_add_u32 v4, v4, 1, v6
    v_and_b32 v6, 3, v10
    s_cmp_ge_u32 s86, 20
    s_cselect_b64 s[76:77], -1, 0
    v_cndmask_b32 v4, v4, v6, s[76:77]
    v_lshl_add_u32 v16, v4, 3, v5
    v_xor_b32 v17, 64, v16
    v_bfe_u32 v4, v10, 2, 2
    v_lshl_add_u32 v5, v12, 3, v4
    v_lshlrev_b32 v5, 7, v5
    v_lshrrev_b32 v4, 1, v4
    v_lshl_add_u32 v5, v4, 6, v5
    v_bfe_u32 v4, v10, 4, 1
    v_lshl_add_u32 v5, v4, 5, v5
    v_add_u32 v5, 98304, v5
    v_and_b32 v4, 1, v10
    v_bfe_u32 v6, v10, 1, 1
    v_lshl_add_u32 v4, v4, 1, v6
    v_and_b32 v6, 3, v10
    s_cmp_ge_u32 s96, 20
    s_cselect_b64 s[76:77], -1, 0
    v_cndmask_b32 v4, v4, v6, s[76:77]
    v_lshl_add_u32 v18, v4, 3, v5
    v_xor_b32 v19, 64, v18
    v_bfe_u32 v4, v10, 1, 2
    v_bfe_u32 v5, v10, 3, 1
    v_xor_b32 v5, v5, v12
    v_or_b32 v4, v4, v5
    v_cmp_eq_u32 vcc, 0, v4
    v_cmp_eq_u32 s[76:77], 2, v4
    v_mov_b32 v5, 0x3f803f80
    v_and_b32 v4, 1, v10
    v_cndmask_b32 v92, 0, v5, vcc
    v_cndmask_b32 v93, 0, v5, vcc
    v_cndmask_b32 v94, 0, v5, s[76:77]
    v_cndmask_b32 v95, 0, v5, s[76:77]
    v_mul_u32_u24 v4, 0xaaaa, v4
    v_add_u32 v96, 0x4444, v4
    v_lshl_or_b32 v96, v96, 16, v96
    v_mov_b32 v236, 0
    v_mov_b32 v237, 0
    v_mov_b32 v238, 0
    v_mov_b32 v239, 0
    v_mov_b32 v240, 0
    v_mov_b32 v241, 0
    v_mov_b32 v242, 0
    v_mov_b32 v243, 0
    s_cmp_ge_u32 s86, 20
    s_cselect_b32 s34, 20, 10
    s_cmp_ge_u32 s86, 10
    s_cselect_b32 s34, s34, 0
    s_sub_u32 s82, s86, s34
    s_cmp_ge_u32 s82, 5
    s_cselect_b32 s34, 0, 1
    s_xor_b32 s34, s34, s29
    s_and_b32 s34, s34, 1
    s_lshl_b32 s34, s34, 3
    s_and_b32 s35, s29, 6
    s_add_u32 s34, s34, s35
    s_lshr_b32 s35, s30, 4
    s_add_u32 s34, s34, s35
    s_lshl_b32 s34, s34, 2
    s_add_u32 s34, s34, s28
    s_mul_i32 s78, s34, 2560
    s_add_u32 s78, s78, 2621440
    s_lshl_b32 s98, s86, 4
    s_add_u32 s98, s98, s84
    s_lshl_b32 s98, s98, 5
    s_add_u32 s98, s98, s28
    s_lshl_b32 s98, s98, 2
    s_add_u32 s98, s98, 28114944
    s_mov_b32 s83, 163840
    s_cmp_ge_u32 s86, 20
    s_cbranch_scc1 L_sva
    v_and_b32 v15, 0x13, v11
    v_bfe_u32 v5, v11, 2, 1
    v_lshl_or_b32 v15, v5, 3, v15
    v_bfe_u32 v5, v11, 3, 1
    v_lshl_or_b32 v15, v5, 2, v15
    s_add_u32 s79, s78, s83
    s_lshl_b32 s82, s82, 3
    s_mov_b32 s88, 0
    v_add3_u32 v4, s82, v12, 0
    v_mul_u32_u24 v5, 205, v4
    v_lshrrev_b32 v5, 10, v5
    v_mul_u32_u24 v6, 5, v5
    v_sub_u32 v6, v4, v6
    v_cmp_lt_u32 vcc, 2, v6
    v_cmp_eq_u32 s[76:77], 2, v6
    v_lshlrev_b32 v4, 1, v5
    v_cndmask_b32 v7, 0, 1, vcc
    v_add_u32 v4, v4, v7
    v_mul_u32_u24 v7, 3, v7
    v_sub_u32 v6, v6, v7
    v_mul_u32_u24 v4, s83, v4
    v_lshl_add_u32 v4, v6, 9, v4
    v_lshl_add_u32 v5, v15, 4, v4
    v_lshl_add_u32 v6, v15, 3, v4
    v_or_b32 v6, 0x80000000, v6
    v_cndmask_b32 v248, v5, v6, s[76:77]
    s_cmp_lg_u64 s[76:77], 0
    s_cselect_b32 s34, 1, 0
    s_or_b32 s88, s88, s34
    v_add3_u32 v4, s82, v12, 2
    v_mul_u32_u24 v5, 205, v4
    v_lshrrev_b32 v5, 10, v5
    v_mul_u32_u24 v6, 5, v5
    v_sub_u32 v6, v4, v6
    v_cmp_lt_u32 vcc, 2, v6
    v_cmp_eq_u32 s[76:77], 2, v6
    v_lshlrev_b32 v4, 1, v5
    v_cndmask_b32 v7, 0, 1, vcc
    v_add_u32 v4, v4, v7
    v_mul_u32_u24 v7, 3, v7
    v_sub_u32 v6, v6, v7
    v_mul_u32_u24 v4, s83, v4
    v_lshl_add_u32 v4, v6, 9, v4
    v_lshl_add_u32 v5, v15, 4, v4
    v_lshl_add_u32 v6, v15, 3, v4
    v_or_b32 v6, 0x80000000, v6
    v_cndmask_b32 v249, v5, v6, s[76:77]
    s_cmp_lg_u64 s[76:77], 0
    s_cselect_b32 s34, 2, 0
    s_or_b32 s88, s88, s34
    v_add3_u32 v4, s82, v12, 4
    v_mul_u32_u24 v5, 205, v4
    v_lshrrev_b32 v5, 10, v5
    v_mul_u32_u24 v6, 5, v5
    v_sub_u32 v6, v4, v6
    v_cmp_lt_u32 vcc, 2, v6
    v_cmp_eq_u32 s[76:77], 2, v6
    v_lshlrev_b32 v4, 1, v5
    v_cndmask_b32 v7, 0, 1, vcc
    v_add_u32 v4, v4, v7
    v_mul_u32_u24 v7, 3, v7
    v_sub_u32 v6, v6, v7
    v_mul_u32_u24 v4, s83, v4
    v_lshl_add_u32 v4, v6, 9, v4
    v_lshl_add_u32 v5, v15, 4, v4
    v_lshl_add_u32 v6, v15, 3, v4
    v_or_b32 v6, 0x80000000, v6
    v_cndmask_b32 v250, v5, v6, s[76:77]
    s_cmp_lg_u64 s[76:77], 0
    s_cselect_b32 s34, 4, 0
    s_or_b32 s88, s88, s34
    v_add3_u32 v4, s82, v12, 6
    v_mul_u32_u24 v5, 205, v4
    v_lshrrev_b32 v5, 10, v5
    v_mul_u32_u24 v6, 5, v5
    v_sub_u32 v6, v4, v6
    v_cmp_lt_u32 vcc, 2, v6
    v_cmp_eq_u32 s[76:77], 2, v6
    v_lshlrev_b32 v4, 1, v5
    v_cndmask_b32 v7, 0, 1, vcc
    v_add_u32 v4, v4, v7
    v_mul_u32_u24 v7, 3, v7
    v_sub_u32 v6, v6, v7
    v_mul_u32_u24 v4, s83, v4
    v_lshl_add_u32 v4, v6, 9, v4
    v_lshl_add_u32 v5, v15, 4, v4
    v_lshl_add_u32 v6, v15, 3, v4
    v_or_b32 v6, 0x80000000, v6
    v_cndmask_b32 v251, v5, v6, s[76:77]
    s_cmp_lg_u64 s[76:77], 0
    s_cselect_b32 s34, 8, 0
    s_or_b32 s88, s88, s34
L_sja:
    s_cmp_ge_u32 s96, 20
    s_cselect_b32 s34, 20, 10
    s_cmp_ge_u32 s96, 10
    s_cselect_b32 s34, s34, 0
    s_sub_u32 s82, s96, s34
    s_cmp_ge_u32 s82, 5
    s_cselect_b32 s34, 0, 1
    s_xor_b32 s34, s34, s29
    s_and_b32 s34, s34, 1
    s_lshl_b32 s34, s34, 3
    s_and_b32 s35, s29, 6
    s_add_u32 s34, s34, s35
    s_lshr_b32 s35, s30, 4
    s_add_u32 s34, s34, s35
    s_lshl_b32 s34, s34, 2
    s_add_u32 s34, s34, s28
    s_mul_i32 s80, s34, 2560
    s_add_u32 s80, s80, 2621440
    s_lshl_b32 s64, s96, 4
    s_add_u32 s64, s64, s84
    s_lshl_b32 s64, s64, 5
    s_add_u32 s64, s64, s28
    s_lshl_b32 s64, s64, 2
    s_add_u32 s64, s64, 28114944
    s_mov_b32 s83, 163840
    s_cmp_ge_u32 s96, 20
    s_cbranch_scc1 L_svb
    v_and_b32 v15, 0x13, v11
    v_bfe_u32 v5, v11, 2, 1
    v_lshl_or_b32 v15, v5, 3, v15
    v_bfe_u32 v5, v11, 3, 1
    v_lshl_or_b32 v15, v5, 2, v15
    s_cmp_ge_u32 s96, 10
    s_cbranch_scc1 L_sk
    v_mov_b32 v15, v11
    s_lshl_b32 s34, s84, 2
    s_add_u32 s34, s34, s28
    s_mul_i32 s80, s34, 110592
    s_add_u32 s80, s80, 13238272
    s_lshl_b32 s64, s34, 5
    s_add_u32 s64, s64, s82
    s_lshl_b32 s64, s64, 2
    s_add_u32 s64, s64, 28069888
    s_mov_b32 s83, 1280
L_sk:
    s_add_u32 s81, s80, s83
    s_lshl_b32 s82, s82, 3
    s_mov_b32 s89, 0
    v_add3_u32 v4, s82, v12, 0
    v_mul_u32_u24 v5, 205, v4
    v_lshrrev_b32 v5, 10, v5
    v_mul_u32_u24 v6, 5, v5
    v_sub_u32 v6, v4, v6
    v_cmp_lt_u32 vcc, 2, v6
    v_cmp_eq_u32 s[76:77], 2, v6
    v_lshlrev_b32 v4, 1, v5
    v_cndmask_b32 v7, 0, 1, vcc
    v_add_u32 v4, v4, v7
    v_mul_u32_u24 v7, 3, v7
    v_sub_u32 v6, v6, v7
    v_mul_u32_u24 v4, s83, v4
    v_lshl_add_u32 v4, v6, 9, v4
    v_lshl_add_u32 v5, v15, 4, v4
    v_lshl_add_u32 v6, v15, 3, v4
    v_or_b32 v6, 0x80000000, v6
    v_cndmask_b32 v252, v5, v6, s[76:77]
    s_cmp_lg_u64 s[76:77], 0
    s_cselect_b32 s34, 1, 0
    s_or_b32 s89, s89, s34
    v_add3_u32 v4, s82, v12, 2
    v_mul_u32_u24 v5, 205, v4
    v_lshrrev_b32 v5, 10, v5
    v_mul_u32_u24 v6, 5, v5
    v_sub_u32 v6, v4, v6
    v_cmp_lt_u32 vcc, 2, v6
    v_cmp_eq_u32 s[76:77], 2, v6
    v_lshlrev_b32 v4, 1, v5
    v_cndmask_b32 v7, 0, 1, vcc
    v_add_u32 v4, v4, v7
    v_mul_u32_u24 v7, 3, v7
    v_sub_u32 v6, v6, v7
    v_mul_u32_u24 v4, s83, v4
    v_lshl_add_u32 v4, v6, 9, v4
    v_lshl_add_u32 v5, v15, 4, v4
    v_lshl_add_u32 v6, v15, 3, v4
    v_or_b32 v6, 0x80000000, v6
    v_cndmask_b32 v253, v5, v6, s[76:77]
    s_cmp_lg_u64 s[76:77], 0
    s_cselect_b32 s34, 2, 0
    s_or_b32 s89, s89, s34
    v_add3_u32 v4, s82, v12, 4
    v_mul_u32_u24 v5, 205, v4
    v_lshrrev_b32 v5, 10, v5
    v_mul_u32_u24 v6, 5, v5
    v_sub_u32 v6, v4, v6
    v_cmp_lt_u32 vcc, 2, v6
    v_cmp_eq_u32 s[76:77], 2, v6
    v_lshlrev_b32 v4, 1, v5
    v_cndmask_b32 v7, 0, 1, vcc
    v_add_u32 v4, v4, v7
    v_mul_u32_u24 v7, 3, v7
    v_sub_u32 v6, v6, v7
    v_mul_u32_u24 v4, s83, v4
    v_lshl_add_u32 v4, v6, 9, v4
    v_lshl_add_u32 v5, v15, 4, v4
    v_lshl_add_u32 v6, v15, 3, v4
    v_or_b32 v6, 0x80000000, v6
    v_cndmask_b32 v254, v5, v6, s[76:77]
    s_cmp_lg_u64 s[76:77], 0
    s_cselect_b32 s34, 4, 0
    s_or_b32 s89, s89, s34
    v_add3_u32 v4, s82, v12, 6
    v_mul_u32_u24 v5, 205, v4
    v_lshrrev_b32 v5, 10, v5
    v_mul_u32_u24 v6, 5, v5
    v_sub_u32 v6, v4, v6
    v_cmp_lt_u32 vcc, 2, v6
    v_cmp_eq_u32 s[76:77], 2, v6
    v_lshlrev_b32 v4, 1, v5
    v_cndmask_b32 v7, 0, 1, vcc
    v_add_u32 v4, v4, v7
    v_mul_u32_u24 v7, 3, v7
    v_sub_u32 v6, v6, v7
    v_mul_u32_u24 v4, s83, v4
    v_lshl_add_u32 v4, v6, 9, v4
    v_lshl_add_u32 v5, v15, 4, v4
    v_lshl_add_u32 v6, v15, 3, v4
    v_or_b32 v6, 0x80000000, v6
    v_cndmask_b32 v255, v5, v6, s[76:77]
    s_cmp_lg_u64 s[76:77], 0
    s_cselect_b32 s34, 8, 0
    s_or_b32 s89, s89, s34
L_sjb:
    s_lshl_b32 s82, s84, 2
    s_add_u32 s82, s82, s28
    s_lshl_b32 s82, s82, 8
    s_add_u32 s82, s82, 28200960
    v_lshlrev_b32 v15, 3, v11
    s_mov_b32 s56, 400000
    s_cmp_lt_u32 s96, 10
    s_cselect_b32 s91, 0x3ea52b5c, 1.0
    s_waitcnt lgkmcnt(0)
    s_mov_b32 s95, 2
    s_mov_b32 s16, s54
    s_mov_b32 s17, s55
    s_mov_b32 s18, 31457280
    s_mov_b32 s19, 0x00020000
    s_cmp_ge_u32 s86, 20
    s_cbranch_scc1 L_p1v
    s_barrier
    ds_read_b128 v[124:127], v2 offset:0
    ds_read_b64_tr_b16 v[20:21], v16 offset:0
    ds_read_b64_tr_b16 v[22:23], v16 offset:512
    ds_read_b64_tr_b16 v[24:25], v17 offset:0
    ds_read_b64_tr_b16 v[26:27], v17 offset:512
    ds_read_b128 v[128:131], v3 offset:0
    ds_read_b64_tr_b16 v[28:29], v16 offset:2048
    ds_read_b64_tr_b16 v[30:31], v16 offset:2560
    ds_read_b64_tr_b16 v[32:33], v17 offset:2048
    ds_read_b64_tr_b16 v[34:35], v17 offset:2560
    s_waitcnt lgkmcnt(5)
    v_mfma_f32_32x32x16_bf16 v[60:75], v[20:23], v[124:127], 0
    ds_read_b128 v[132:135], v13 offset:0
    ds_read_b64_tr_b16 v[36:37], v16 offset:4096
    v_mfma_f32_32x32x16_bf16 v[76:91], v[24:27], v[124:127], 0
    ds_read_b64_tr_b16 v[38:39], v16 offset:4608
    ds_read_b64_tr_b16 v[40:41], v17 offset:4096
    ds_read_b64_tr_b16 v[42:43], v17 offset:4608
    v_smfmac_f32_16x16x64_bf16 v[236:239], v[92:95], v[20:27], v96
    s_waitcnt lgkmcnt(5)
    v_mfma_f32_32x32x16_bf16 v[60:75], v[28:31], v[128:131], v[60:75]
    ds_read_b128 v[136:139], v14 offset:0
    ds_read_b64_tr_b16 v[20:21], v16 offset:6144
    v_mfma_f32_32x32x16_bf16 v[76:91], v[32:35], v[128:131], v[76:91]
    ds_read_b64_tr_b16 v[22:23], v16 offset:6656
    ds_read_b64_tr_b16 v[24:25], v17 offset:6144
    ds_read_b64_tr_b16 v[26:27], v17 offset:6656
    v_smfmac_f32_16x16x64_bf16 v[236:239], v[92:95], v[28:35], v96
    s_waitcnt lgkmcnt(5)
    v_mfma_f32_32x32x16_bf16 v[60:75], v[36:39], v[132:135], v[60:75]
    s_waitcnt lgkmcnt(0)
    s_barrier
    ds_read_b128 v[140:143], v2 offset:16384
    ds_read_b64_tr_b16 v[28:29], v16 offset:8192
    v_mfma_f32_32x32x16_bf16 v[76:91], v[40:43], v[132:135], v[76:91]
    ds_read_b64_tr_b16 v[30:31], v16 offset:8704
    ds_read_b64_tr_b16 v[32:33], v17 offset:8192
    ds_read_b64_tr_b16 v[34:35], v17 offset:8704
    v_smfmac_f32_16x16x64_bf16 v[236:239], v[92:95], v[36:43], v96
    v_mfma_f32_32x32x16_bf16 v[60:75], v[20:23], v[136:139], v[60:75]
    ds_read_b128 v[144:147], v3 offset:16384
    ds_read_b64_tr_b16 v[36:37], v16 offset:10240
    v_mfma_f32_32x32x16_bf16 v[76:91], v[24:27], v[136:139], v[76:91]
    ds_read_b64_tr_b16 v[38:39], v16 offset:10752
    ds_read_b64_tr_b16 v[40:41], v17 offset:10240
    ds_read_b64_tr_b16 v[42:43], v17 offset:10752
    v_smfmac_f32_16x16x64_bf16 v[236:239], v[92:95], v[20:27], v96
    s_waitcnt lgkmcnt(5)
    v_mfma_f32_32x32x16_bf16 v[60:75], v[28:31], v[140:143], v[60:75]
    ds_read_b128 v[148:151], v13 offset:16384
    ds_read_b64_tr_b16 v[20:21], v16 offset:12288
    v_mfma_f32_32x32x16_bf16 v[76:91], v[32:35], v[140:143], v[76:91]
    ds_read_b64_tr_b16 v[22:23], v16 offset:12800
    ds_read_b64_tr_b16 v[24:25], v17 offset:12288
    ds_read_b64_tr_b16 v[26:27], v17 offset:12800
    v_smfmac_f32_16x16x64_bf16 v[236:239], v[92:95], v[28:35], v96
    s_waitcnt lgkmcnt(5)
    v_mfma_f32_32x32x16_bf16 v[60:75], v[36:39], v[144:147], v[60:75]
    ds_read_b128 v[152:155], v14 offset:16384
    ds_read_b64_tr_b16 v[28:29], v16 offset:14336
    v_mfma_f32_32x32x16_bf16 v[76:91], v[40:43], v[144:147], v[76:91]
    ds_read_b64_tr_b16 v[30:31], v16 offset:14848
    ds_read_b64_tr_b16 v[32:33], v17 offset:14336
    ds_read_b64_tr_b16 v[34:35], v17 offset:14848
    v_smfmac_f32_16x16x64_bf16 v[236:239], v[92:95], v[36:43], v96
    s_waitcnt lgkmcnt(5)
    v_mfma_f32_32x32x16_bf16 v[60:75], v[20:23], v[148:151], v[60:75]
    s_waitcnt lgkmcnt(0)
    s_barrier
    ds_read_b128 v[156:159], v2 offset:32768
    ds_read_b64_tr_b16 v[36:37], v16 offset:16384
    v_mfma_f32_32x32x16_bf16 v[76:91], v[24:27], v[148:151], v[76:91]
    ds_read_b64_tr_b16 v[38:39], v16 offset:16896
    ds_read_b64_tr_b16 v[40:41], v17 offset:16384
    ds_read_b64_tr_b16 v[42:43], v17 offset:16896
    v_smfmac_f32_16x16x64_bf16 v[236:239], v[92:95], v[20:27], v96
    v_mfma_f32_32x32x16_bf16 v[60:75], v[28:31], v[152:155], v[60:75]
    ds_read_b128 v[160:163], v3 offset:32768
    ds_read_b64_tr_b16 v[20:21], v16 offset:18432
    v_mfma_f32_32x32x16_bf16 v[76:91], v[32:35], v[152:155], v[76:91]
    ds_read_b64_tr_b16 v[22:23], v16 offset:18944
    ds_read_b64_tr_b16 v[24:25], v17 offset:18432
    ds_read_b64_tr_b16 v[26:27], v17 offset:18944
    v_smfmac_f32_16x16x64_bf16 v[236:239], v[92:95], v[28:35], v96
    s_waitcnt lgkmcnt(5)
    v_mfma_f32_32x32x16_bf16 v[60:75], v[36:39], v[156:159], v[60:75]
    ds_read_b128 v[164:167], v13 offset:32768
    ds_read_b64_tr_b16 v[28:29], v16 offset:20480
    v_mfma_f32_32x32x16_bf16 v[76:91], v[40:43], v[156:159], v[76:91]
    ds_read_b64_tr_b16 v[30:31], v16 offset:20992
    ds_read_b64_tr_b16 v[32:33], v17 offset:20480
    ds_read_b64_tr_b16 v[34:35], v17 offset:20992
    v_smfmac_f32_16x16x64_bf16 v[236:239], v[92:95], v[36:43], v96
    s_waitcnt lgkmcnt(5)
    v_mfma_f32_32x32x16_bf16 v[60:75], v[20:23], v[160:163], v[60:75]
    ds_read_b128 v[168:171], v14 offset:32768
    ds_read_b64_tr_b16 v[36:37], v16 offset:22528
    v_mfma_f32_32x32x16_bf16 v[76:91], v[24:27], v[160:163], v[76:91]
    ds_read_b64_tr_b16 v[38:39], v16 offset:23040
    ds_read_b64_tr_b16 v[40:41], v17 offset:22528
    ds_read_b64_tr_b16 v[42:43], v17 offset:23040
    v_smfmac_f32_16x16x64_bf16 v[236:239], v[92:95], v[20:27], v96
    s_waitcnt lgkmcnt(5)
    v_mfma_f32_32x32x16_bf16 v[60:75], v[28:31], v[164:167], v[60:75]
    s_waitcnt lgkmcnt(0)
    s_barrier
    ds_read_b128 v[172:175], v2 offset:49152
    ds_read_b64_tr_b16 v[20:21], v16 offset:24576
    v_mfma_f32_32x32x16_bf16 v[76:91], v[32:35], v[164:167], v[76:91]
    ds_read_b64_tr_b16 v[22:23], v16 offset:25088
    ds_read_b64_tr_b16 v[24:25], v17 offset:24576
    ds_read_b64_tr_b16 v[26:27], v17 offset:25088
    v_smfmac_f32_16x16x64_bf16 v[236:239], v[92:95], v[28:35], v96
    v_mfma_f32_32x32x16_bf16 v[60:75], v[36:39], v[168:171], v[60:75]
    ds_read_b128 v[176:179], v3 offset:49152
    ds_read_b64_tr_b16 v[28:29], v16 offset:26624
    v_mfma_f32_32x32x16_bf16 v[76:91], v[40:43], v[168:171], v[76:91]
    ds_read_b64_tr_b16 v[30:31], v16 offset:27136
    ds_read_b64_tr_b16 v[32:33], v17 offset:26624
    ds_read_b64_tr_b16 v[34:35], v17 offset:27136
    v_smfmac_f32_16x16x64_bf16 v[236:239], v[92:95], v[36:43], v96
    s_waitcnt lgkmcnt(5)
    v_mfma_f32_32x32x16_bf16 v[60:75], v[20:23], v[172:175], v[60:75]
    ds_read_b128 v[180:183], v13 offset:49152
    ds_read_b64_tr_b16 v[36:37], v16 offset:28672
    v_mfma_f32_32x32x16_bf16 v[76:91], v[24:27], v[172:175], v[76:91]
    ds_read_b64_tr_b16 v[38:39], v16 offset:29184
    ds_read_b64_tr_b16 v[40:41], v17 offset:28672
    ds_read_b64_tr_b16 v[42:43], v17 offset:29184
    v_smfmac_f32_16x16x64_bf16 v[236:239], v[92:95], v[20:27], v96
    s_waitcnt lgkmcnt(5)
    v_mfma_f32_32x32x16_bf16 v[60:75], v[28:31], v[176:179], v[60:75]
    ds_read_b128 v[184:187], v14 offset:49152
    ds_read_b64_tr_b16 v[20:21], v16 offset:30720
    v_mfma_f32_32x32x16_bf16 v[76:91], v[32:35], v[176:179], v[76:91]
    ds_read_b64_tr_b16 v[22:23], v16 offset:31232
    ds_read_b64_tr_b16 v[24:25], v17 offset:30720
    ds_read_b64_tr_b16 v[26:27], v17 offset:31232
    v_smfmac_f32_16x16x64_bf16 v[236:239], v[92:95], v[28:35], v96
    s_waitcnt lgkmcnt(5)
    v_mfma_f32_32x32x16_bf16 v[60:75], v[36:39], v[180:183], v[60:75]
    s_waitcnt lgkmcnt(0)
    s_barrier
    ds_read_b128 v[188:191], v2 offset:0
    ds_read_b64_tr_b16 v[28:29], v16 offset:0
    v_mfma_f32_32x32x16_bf16 v[76:91], v[40:43], v[180:183], v[76:91]
    ds_read_b64_tr_b16 v[30:31], v16 offset:512
    ds_read_b64_tr_b16 v[32:33], v17 offset:0
    ds_read_b64_tr_b16 v[34:35], v17 offset:512
    v_smfmac_f32_16x16x64_bf16 v[236:239], v[92:95], v[36:43], v96
    v_mfma_f32_32x32x16_bf16 v[60:75], v[20:23], v[184:187], v[60:75]
    ds_read_b128 v[192:195], v3 offset:0
    ds_read_b64_tr_b16 v[36:37], v16 offset:2048
    v_mfma_f32_32x32x16_bf16 v[76:91], v[24:27], v[184:187], v[76:91]
    ds_read_b64_tr_b16 v[38:39], v16 offset:2560
    ds_read_b64_tr_b16 v[40:41], v17 offset:2048
    ds_read_b64_tr_b16 v[42:43], v17 offset:2560
    v_smfmac_f32_16x16x64_bf16 v[236:239], v[92:95], v[20:27], v96
    s_waitcnt lgkmcnt(5)
    v_mfma_f32_32x32x16_bf16 v[60:75], v[28:31], v[188:191], v[60:75]
    ds_read_b128 v[196:199], v13 offset:0
    ds_read_b64_tr_b16 v[20:21], v16 offset:4096
    v_mfma_f32_32x32x16_bf16 v[76:91], v[32:35], v[188:191], v[76:91]
    ds_read_b64_tr_b16 v[22:23], v16 offset:4608
    ds_read_b64_tr_b16 v[24:25], v17 offset:4096
    ds_read_b64_tr_b16 v[26:27], v17 offset:4608
    v_smfmac_f32_16x16x64_bf16 v[236:239], v[92:95], v[28:35], v96
    s_waitcnt lgkmcnt(5)
    v_mfma_f32_32x32x16_bf16 v[60:75], v[36:39], v[192:195], v[60:75]
    ds_read_b128 v[200:203], v14 offset:0
    ds_read_b64_tr_b16 v[28:29], v16 offset:6144
    v_mfma_f32_32x32x16_bf16 v[76:91], v[40:43], v[192:195], v[76:91]
    ds_read_b64_tr_b16 v[30:31], v16 offset:6656
    ds_read_b64_tr_b16 v[32:33], v17 offset:6144
    ds_read_b64_tr_b16 v[34:35], v17 offset:6656
    v_smfmac_f32_16x16x64_bf16 v[236:239], v[92:95], v[36:43], v96
    s_waitcnt lgkmcnt(5)
    v_mfma_f32_32x32x16_bf16 v[60:75], v[20:23], v[196:199], v[60:75]
    s_waitcnt lgkmcnt(0)
    s_barrier
    ds_read_b128 v[204:207], v2 offset:16384
    ds_read_b64_tr_b16 v[36:37], v16 offset:8192
    v_mfma_f32_32x32x16_bf16 v[76:91], v[24:27], v[196:199], v[76:91]
    ds_read_b64_tr_b16 v[38:39], v16 offset:8704
    ds_read_b64_tr_b16 v[40:41], v17 offset:8192
    ds_read_b64_tr_b16 v[42:43], v17 offset:8704
    v_smfmac_f32_16x16x64_bf16 v[236:239], v[92:95], v[20:27], v96
    v_mfma_f32_32x32x16_bf16 v[60:75], v[28:31], v[200:203], v[60:75]
    ds_read_b128 v[208:211], v3 offset:16384
    ds_read_b64_tr_b16 v[20:21], v16 offset:10240
    v_mfma_f32_32x32x16_bf16 v[76:91], v[32:35], v[200:203], v[76:91]
    ds_read_b64_tr_b16 v[22:23], v16 offset:10752
    ds_read_b64_tr_b16 v[24:25], v17 offset:10240
    ds_read_b64_tr_b16 v[26:27], v17 offset:10752
    v_smfmac_f32_16x16x64_bf16 v[236:239], v[92:95], v[28:35], v96
    s_waitcnt lgkmcnt(5)
    v_mfma_f32_32x32x16_bf16 v[60:75], v[36:39], v[204:207], v[60:75]
    ds_read_b128 v[212:215], v13 offset:16384
    ds_read_b64_tr_b16 v[28:29], v16 offset:12288
    v_mfma_f32_32x32x16_bf16 v[76:91], v[40:43], v[204:207], v[76:91]
    ds_read_b64_tr_b16 v[30:31], v16 offset:12800
    ds_read_b64_tr_b16 v[32:33], v17 offset:12288
    ds_read_b64_tr_b16 v[34:35], v17 offset:12800
    v_smfmac_f32_16x16x64_bf16 v[236:239], v[92:95], v[36:43], v96
    s_waitcnt lgkmcnt(5)
    v_mfma_f32_32x32x16_bf16 v[60:75], v[20:23], v[208:211], v[60:75]
    ds_read_b128 v[216:219], v14 offset:16384
    ds_read_b64_tr_b16 v[36:37], v16 offset:14336
    v_mfma_f32_32x32x16_bf16 v[76:91], v[24:27], v[208:211], v[76:91]
    ds_read_b64_tr_b16 v[38:39], v16 offset:14848
    ds_read_b64_tr_b16 v[40:41], v17 offset:14336
    ds_read_b64_tr_b16 v[42:43], v17 offset:14848
    v_smfmac_f32_16x16x64_bf16 v[236:239], v[92:95], v[20:27], v96
    s_waitcnt lgkmcnt(5)
    v_mfma_f32_32x32x16_bf16 v[60:75], v[28:31], v[212:215], v[60:75]
    s_waitcnt lgkmcnt(0)
    s_barrier
    ds_read_b128 v[220:223], v2 offset:32768
    ds_read_b64_tr_b16 v[20:21], v16 offset:16384
    v_mfma_f32_32x32x16_bf16 v[76:91], v[32:35], v[212:215], v[76:91]
    ds_read_b64_tr_b16 v[22:23], v16 offset:16896
    ds_read_b64_tr_b16 v[24:25], v17 offset:16384
    ds_read_b64_tr_b16 v[26:27], v17 offset:16896
    v_smfmac_f32_16x16x64_bf16 v[236:239], v[92:95], v[28:35], v96
    v_mfma_f32_32x32x16_bf16 v[60:75], v[36:39], v[216:219], v[60:75]
    ds_read_b128 v[224:227], v3 offset:32768
    ds_read_b64_tr_b16 v[28:29], v16 offset:18432
    v_mfma_f32_32x32x16_bf16 v[76:91], v[40:43], v[216:219], v[76:91]
    ds_read_b64_tr_b16 v[30:31], v16 offset:18944
    ds_read_b64_tr_b16 v[32:33], v17 offset:18432
    ds_read_b64_tr_b16 v[34:35], v17 offset:18944
    v_smfmac_f32_16x16x64_bf16 v[236:239], v[92:95], v[36:43], v96
    s_waitcnt lgkmcnt(5)
    v_mfma_f32_32x32x16_bf16 v[60:75], v[20:23], v[220:223], v[60:75]
    ds_read_b128 v[228:231], v13 offset:32768
    ds_read_b64_tr_b16 v[36:37], v16 offset:20480
    v_mfma_f32_32x32x16_bf16 v[76:91], v[24:27], v[220:223], v[76:91]
    ds_read_b64_tr_b16 v[38:39], v16 offset:20992
    ds_read_b64_tr_b16 v[40:41], v17 offset:20480
    ds_read_b64_tr_b16 v[42:43], v17 offset:20992
    v_smfmac_f32_16x16x64_bf16 v[236:239], v[92:95], v[20:27], v96
    s_waitcnt lgkmcnt(5)
    v_mfma_f32_32x32x16_bf16 v[60:75], v[28:31], v[224:227], v[60:75]
    ds_read_b128 v[232:235], v14 offset:32768
    ds_read_b64_tr_b16 v[20:21], v16 offset:22528
    v_mfma_f32_32x32x16_bf16 v[76:91], v[32:35], v[224:227], v[76:91]
    ds_read_b64_tr_b16 v[22:23], v16 offset:23040
    ds_read_b64_tr_b16 v[24:25], v17 offset:22528
    ds_read_b64_tr_b16 v[26:27], v17 offset:23040
    v_smfmac_f32_16x16x64_bf16 v[236:239], v[92:95], v[28:35], v96
    s_waitcnt lgkmcnt(5)
    v_mfma_f32_32x32x16_bf16 v[60:75], v[36:39], v[228:231], v[60:75]
    s_waitcnt lgkmcnt(0)
    s_barrier
    ds_read_b128 v[44:47], v2 offset:49152
    ds_read_b64_tr_b16 v[28:29], v16 offset:24576
    v_mfma_f32_32x32x16_bf16 v[76:91], v[40:43], v[228:231], v[76:91]
    ds_read_b64_tr_b16 v[30:31], v16 offset:25088
    ds_read_b64_tr_b16 v[32:33], v17 offset:24576
    ds_read_b64_tr_b16 v[34:35], v17 offset:25088
    v_smfmac_f32_16x16x64_bf16 v[236:239], v[92:95], v[36:43], v96
    v_mfma_f32_32x32x16_bf16 v[60:75], v[20:23], v[232:235], v[60:75]
    ds_read_b128 v[48:51], v3 offset:49152
    ds_read_b64_tr_b16 v[36:37], v16 offset:26624
    v_mfma_f32_32x32x16_bf16 v[76:91], v[24:27], v[232:235], v[76:91]
    ds_read_b64_tr_b16 v[38:39], v16 offset:27136
    ds_read_b64_tr_b16 v[40:41], v17 offset:26624
    ds_read_b64_tr_b16 v[42:43], v17 offset:27136
    v_smfmac_f32_16x16x64_bf16 v[236:239], v[92:95], v[20:27], v96
    s_waitcnt lgkmcnt(5)
    v_mfma_f32_32x32x16_bf16 v[60:75], v[28:31], v[44:47], v[60:75]
    ds_read_b128 v[52:55], v13 offset:49152
    ds_read_b64_tr_b16 v[20:21], v16 offset:28672
    v_mfma_f32_32x32x16_bf16 v[76:91], v[32:35], v[44:47], v[76:91]
    ds_read_b64_tr_b16 v[22:23], v16 offset:29184
    ds_read_b64_tr_b16 v[24:25], v17 offset:28672
    ds_read_b64_tr_b16 v[26:27], v17 offset:29184
    v_smfmac_f32_16x16x64_bf16 v[236:239], v[92:95], v[28:35], v96
    s_waitcnt lgkmcnt(5)
    v_mfma_f32_32x32x16_bf16 v[60:75], v[36:39], v[48:51], v[60:75]
    ds_read_b128 v[56:59], v14 offset:49152
    ds_read_b64_tr_b16 v[28:29], v16 offset:30720
    v_mfma_f32_32x32x16_bf16 v[76:91], v[40:43], v[48:51], v[76:91]
    ds_read_b64_tr_b16 v[30:31], v16 offset:31232
    ds_read_b64_tr_b16 v[32:33], v17 offset:30720
    ds_read_b64_tr_b16 v[34:35], v17 offset:31232
    v_smfmac_f32_16x16x64_bf16 v[236:239], v[92:95], v[36:43], v96
    s_waitcnt lgkmcnt(5)
    v_mfma_f32_32x32x16_bf16 v[60:75], v[20:23], v[52:55], v[60:75]
    s_waitcnt lgkmcnt(0)
    s_barrier
    ds_read_b128 v[44:47], v2 offset:0
    ds_read_b64_tr_b16 v[36:37], v16 offset:0
    v_mfma_f32_32x32x16_bf16 v[76:91], v[24:27], v[52:55], v[76:91]
    ds_read_b64_tr_b16 v[38:39], v16 offset:512
    ds_read_b64_tr_b16 v[40:41], v17 offset:0
    ds_read_b64_tr_b16 v[42:43], v17 offset:512
    v_smfmac_f32_16x16x64_bf16 v[236:239], v[92:95], v[20:27], v96
    v_mfma_f32_32x32x16_bf16 v[60:75], v[28:31], v[56:59], v[60:75]
    ds_read_b128 v[48:51], v3 offset:0
    ds_read_b64_tr_b16 v[20:21], v16 offset:2048
    v_mfma_f32_32x32x16_bf16 v[76:91], v[32:35], v[56:59], v[76:91]
    ds_read_b64_tr_b16 v[22:23], v16 offset:2560
    ds_read_b64_tr_b16 v[24:25], v17 offset:2048
    ds_read_b64_tr_b16 v[26:27], v17 offset:2560
    v_smfmac_f32_16x16x64_bf16 v[236:239], v[92:95], v[28:35], v96
    s_waitcnt lgkmcnt(5)
    v_mfma_f32_32x32x16_bf16 v[60:75], v[36:39], v[44:47], v[60:75]
    ds_read_b128 v[52:55], v13 offset:0
    ds_read_b64_tr_b16 v[28:29], v16 offset:4096
    v_mfma_f32_32x32x16_bf16 v[76:91], v[40:43], v[44:47], v[76:91]
    ds_read_b64_tr_b16 v[30:31], v16 offset:4608
    ds_read_b64_tr_b16 v[32:33], v17 offset:4096
    ds_read_b64_tr_b16 v[34:35], v17 offset:4608
    v_smfmac_f32_16x16x64_bf16 v[236:239], v[92:95], v[36:43], v96
    s_waitcnt lgkmcnt(5)
    v_mfma_f32_32x32x16_bf16 v[60:75], v[20:23], v[48:51], v[60:75]
    ds_read_b128 v[56:59], v14 offset:0
    ds_read_b64_tr_b16 v[36:37], v16 offset:6144
    v_mfma_f32_32x32x16_bf16 v[76:91], v[24:27], v[48:51], v[76:91]
    ds_read_b64_tr_b16 v[38:39], v16 offset:6656
    ds_read_b64_tr_b16 v[40:41], v17 offset:6144
    ds_read_b64_tr_b16 v[42:43], v17 offset:6656
    v_smfmac_f32_16x16x64_bf16 v[236:239], v[92:95], v[20:27], v96
    s_waitcnt lgkmcnt(5)
    v_mfma_f32_32x32x16_bf16 v[60:75], v[28:31], v[52:55], v[60:75]
    s_waitcnt lgkmcnt(0)
    s_barrier
    ds_read_b128 v[44:47], v2 offset:16384
    ds_read_b64_tr_b16 v[20:21], v16 offset:8192
    v_mfma_f32_32x32x16_bf16 v[76:91], v[32:35], v[52:55], v[76:91]
    ds_read_b64_tr_b16 v[22:23], v16 offset:8704
    ds_read_b64_tr_b16 v[24:25], v17 offset:8192
    ds_read_b64_tr_b16 v[26:27], v17 offset:8704
    v_smfmac_f32_16x16x64_bf16 v[236:239], v[92:95], v[28:35], v96
    v_mfma_f32_32x32x16_bf16 v[60:75], v[36:39], v[56:59], v[60:75]
    ds_read_b128 v[48:51], v3 offset:16384
    ds_read_b64_tr_b16 v[28:29], v16 offset:10240
    v_mfma_f32_32x32x16_bf16 v[76:91], v[40:43], v[56:59], v[76:91]
    ds_read_b64_tr_b16 v[30:31], v16 offset:10752
    ds_read_b64_tr_b16 v[32:33], v17 offset:10240
    ds_read_b64_tr_b16 v[34:35], v17 offset:10752
    v_smfmac_f32_16x16x64_bf16 v[236:239], v[92:95], v[36:43], v96
    s_waitcnt lgkmcnt(5)
    v_mfma_f32_32x32x16_bf16 v[60:75], v[20:23], v[44:47], v[60:75]
    ds_read_b128 v[52:55], v13 offset:16384
    ds_read_b64_tr_b16 v[36:37], v16 offset:12288
    v_mfma_f32_32x32x16_bf16 v[76:91], v[24:27], v[44:47], v[76:91]
    ds_read_b64_tr_b16 v[38:39], v16 offset:12800
    ds_read_b64_tr_b16 v[40:41], v17 offset:12288
    ds_read_b64_tr_b16 v[42:43], v17 offset:12800
    v_smfmac_f32_16x16x64_bf16 v[236:239], v[92:95], v[20:27], v96
    buffer_load_dwordx2 v[6:7], v15, s[16:19], s82 offen sc1
    s_waitcnt lgkmcnt(5)
    v_mfma_f32_32x32x16_bf16 v[60:75], v[28:31], v[48:51], v[60:75]
    ds_read_b128 v[56:59], v14 offset:16384
    ds_read_b64_tr_b16 v[20:21], v16 offset:14336
    v_mfma_f32_32x32x16_bf16 v[76:91], v[32:35], v[48:51], v[76:91]
    ds_read_b64_tr_b16 v[22:23], v16 offset:14848
    ds_read_b64_tr_b16 v[24:25], v17 offset:14336
    ds_read_b64_tr_b16 v[26:27], v17 offset:14848
    v_smfmac_f32_16x16x64_bf16 v[236:239], v[92:95], v[28:35], v96
    s_waitcnt lgkmcnt(5)
    v_mfma_f32_32x32x16_bf16 v[60:75], v[36:39], v[52:55], v[60:75]
    s_waitcnt lgkmcnt(0)
    s_barrier
    ds_read_b64_tr_b16 v[28:29], v18 offset:0
    ds_read_b64_tr_b16 v[30:31], v18 offset:512
    v_mfma_f32_32x32x16_bf16 v[76:91], v[40:43], v[52:55], v[76:91]
    ds_read_b64_tr_b16 v[32:33], v19 offset:0
    ds_read_b64_tr_b16 v[34:35], v19 offset:512
    v_smfmac_f32_16x16x64_bf16 v[236:239], v[92:95], v[36:43], v96
    v_mfma_f32_32x32x16_bf16 v[60:75], v[20:23], v[56:59], v[60:75]
    ds_read_b64_tr_b16 v[36:37], v18 offset:2048
    ds_read_b64_tr_b16 v[38:39], v18 offset:2560
    v_mfma_f32_32x32x16_bf16 v[76:91], v[24:27], v[56:59], v[76:91]
    ds_read_b64_tr_b16 v[40:41], v19 offset:2048
    ds_read_b64_tr_b16 v[42:43], v19 offset:2560
    v_smfmac_f32_16x16x64_bf16 v[236:239], v[92:95], v[20:27], v96
    s_waitcnt lgkmcnt(4)
    v_mfma_f32_32x32x16_bf16 v[92:107], v[28:31], v[124:127], 0
    ds_read_b64_tr_b16 v[20:21], v18 offset:4096
    ds_read_b64_tr_b16 v[22:23], v18 offset:4608
    v_mfma_f32_32x32x16_bf16 v[108:123], v[32:35], v[124:127], 0
    ds_read_b64_tr_b16 v[24:25], v19 offset:4096
    ds_read_b64_tr_b16 v[26:27], v19 offset:4608
    s_waitcnt lgkmcnt(4)
    v_mfma_f32_32x32x16_bf16 v[92:107], v[36:39], v[128:131], v[92:107]
    ds_read_b64_tr_b16 v[28:29], v18 offset:6144
    ds_read_b64_tr_b16 v[30:31], v18 offset:6656
    v_add_f32 v8, v236, v237
    v_cvt_pk_bf16_f32 v237, v8, 0
    v_lshlrev_b32 v9, 16, v237
    v_mfma_f32_32x32x16_bf16 v[108:123], v[40:43], v[128:131], v[108:123]
    ds_read_b64_tr_b16 v[32:33], v19 offset:6144
    ds_read_b64_tr_b16 v[34:35], v19 offset:6656
    v_sub_f32 v9, v8, v9
    v_cvt_pk_bf16_f32 v236, v8, v9
    s_waitcnt lgkmcnt(4)
    v_mfma_f32_32x32x16_bf16 v[92:107], v[20:23], v[132:135], v[92:107]
    s_barrier
    ds_read_b64_tr_b16 v[36:37], v18 offset:8192
    ds_read_b64_tr_b16 v[38:39], v18 offset:8704
    v_mfma_f32_32x32x16_bf16 v[108:123], v[24:27], v[132:135], v[108:123]
    ds_read_b64_tr_b16 v[40:41], v19 offset:8192
    ds_read_b64_tr_b16 v[42:43], v19 offset:8704
L_xc5:
    s_waitcnt vmcnt(0)
    v_min_u32 v4, v6, v7
    v_cmp_eq_u32 vcc, 0, v4
    v_cvt_pk_bf16_f32 v240, v6, v6
    s_cbranch_vccnz L_xr5
L_xo5:
    v_and_b32 v5, 0xffff0000, v240
    v_mov_b32 v238, v7
    s_waitcnt lgkmcnt(4)
    v_mfma_f32_32x32x16_bf16 v[92:107], v[28:31], v[136:139], v[92:107]
    ds_read_b64_tr_b16 v[20:21], v18 offset:10240
    ds_read_b64_tr_b16 v[22:23], v18 offset:10752
    v_sub_f32 v5, v6, v5
    v_cndmask_b32 v244, v240, 0, s[72:73]
    v_cvt_pk_bf16_f32 v241, v5, 0
    v_mfma_f32_32x32x16_bf16 v[108:123], v[32:35], v[136:139], v[108:123]
    ds_read_b64_tr_b16 v[24:25], v19 offset:10240
    ds_read_b64_tr_b16 v[26:27], v19 offset:10752
    v_cndmask_b32 v246, 0, v240, s[72:73]
    v_cndmask_b32 v245, v241, 0, s[72:73]
    v_cndmask_b32 v247, 0, v241, s[72:73]
    s_waitcnt lgkmcnt(4)
    v_mfma_f32_32x32x16_bf16 v[92:107], v[36:39], v[140:143], v[92:107]
    ds_read_b64_tr_b16 v[28:29], v18 offset:12288
    ds_read_b64_tr_b16 v[30:31], v18 offset:12800
    v_mfma_f32_32x32x8_bf16 v[60:75], v[236:237], v[244:245], v[60:75]
    v_mfma_f32_32x32x8_bf16 v[76:91], v[236:237], v[246:247], v[76:91]
    v_mfma_f32_32x32x16_bf16 v[108:123], v[40:43], v[140:143], v[108:123]
    ds_read_b64_tr_b16 v[32:33], v19 offset:12288
    ds_read_b64_tr_b16 v[34:35], v19 offset:12800
    s_waitcnt lgkmcnt(4)
    v_mfma_f32_32x32x16_bf16 v[92:107], v[20:23], v[144:147], v[92:107]
    ds_read_b64_tr_b16 v[36:37], v18 offset:14336
    ds_read_b64_tr_b16 v[38:39], v18 offset:14848
    v_mfma_f32_32x32x16_bf16 v[108:123], v[24:27], v[144:147], v[108:123]
    ds_read_b64_tr_b16 v[40:41], v19 offset:14336
    ds_read_b64_tr_b16 v[42:43], v19 offset:14848
    s_waitcnt lgkmcnt(4)
    v_mfma_f32_32x32x16_bf16 v[92:107], v[28:31], v[148:151], v[92:107]
    ds_read_b128 v[44:47], v2 offset:49152
    ds_read_b64_tr_b16 v[20:21], v18 offset:16384
    v_mul_f32 v60, v60, v238
    v_mul_f32 v61, v61, v238
    v_mul_f32 v62, v62, v238
    v_mfma_f32_32x32x16_bf16 v[108:123], v[32:35], v[148:151], v[108:123]
    ds_read_b64_tr_b16 v[22:23], v18 offset:16896
    ds_read_b64_tr_b16 v[24:25], v19 offset:16384
    ds_read_b64_tr_b16 v[26:27], v19 offset:16896
    v_mul_f32 v63, v63, v238
    v_mul_f32 v64, v64, v238
    v_mul_f32 v65, v65, v238
    v_mul_f32 v66, v66, v238
    s_waitcnt lgkmcnt(5)
    v_mfma_f32_32x32x16_bf16 v[92:107], v[36:39], v[152:155], v[92:107]
    ds_read_b128 v[48:51], v3 offset:49152
    ds_read_b64_tr_b16 v[28:29], v18 offset:18432
    v_mul_f32 v67, v67, v238
    v_cvt_pk_bf16_f32 v60, v60, v61
    v_cvt_pk_bf16_f32 v61, v62, v63
    v_mfma_f32_32x32x16_bf16 v[108:123], v[40:43], v[152:155], v[108:123]
    ds_read_b64_tr_b16 v[30:31], v18 offset:18944
    ds_read_b64_tr_b16 v[32:33], v19 offset:18432
    ds_read_b64_tr_b16 v[34:35], v19 offset:18944
    v_cvt_pk_bf16_f32 v62, v64, v65
    v_cvt_pk_bf16_f32 v63, v66, v67
    buffer_store_dwordx4 v[60:63], v248, s[16:19], s78 offen sc1
    s_bitcmp0_b32 s88, 0
    s_cbranch_scc1 L_nr6
    v_xor_b32 v248, 0x80000000, v248
    buffer_store_dwordx2 v[60:61], v248, s[16:19], s78 offen sc1
    buffer_store_dwordx2 v[62:63], v248, s[16:19], s79 offen sc1
L_nr6:
    s_waitcnt lgkmcnt(5)
    v_mfma_f32_32x32x16_bf16 v[92:107], v[20:23], v[44:47], v[92:107]
    ds_read_b128 v[52:55], v13 offset:49152
    ds_read_b64_tr_b16 v[36:37], v18 offset:20480
    v_mul_f32 v68, v68, v238
    v_mul_f32 v69, v69, v238
    v_mul_f32 v70, v70, v238
    v_mfma_f32_32x32x16_bf16 v[108:123], v[24:27], v[44:47], v[108:123]
    ds_read_b64_tr_b16 v[38:39], v18 offset:20992
    ds_read_b64_tr_b16 v[40:41], v19 offset:20480
    ds_read_b64_tr_b16 v[42:43], v19 offset:20992
    v_mul_f32 v71, v71, v238
    v_mul_f32 v72, v72, v238
    v_mul_f32 v73, v73, v238
    v_mul_f32 v74, v74, v238
    s_waitcnt lgkmcnt(5)
    v_mfma_f32_32x32x16_bf16 v[92:107], v[28:31], v[48:51], v[92:107]
    ds_read_b128 v[56:59], v14 offset:49152
    ds_read_b64_tr_b16 v[20:21], v18 offset:22528
    v_mul_f32 v75, v75, v238
    v_cvt_pk_bf16_f32 v68, v68, v69
    v_cvt_pk_bf16_f32 v69, v70, v71
    v_mfma_f32_32x32x16_bf16 v[108:123], v[32:35], v[48:51], v[108:123]
    ds_read_b64_tr_b16 v[22:23], v18 offset:23040
    ds_read_b64_tr_b16 v[24:25], v19 offset:22528
    ds_read_b64_tr_b16 v[26:27], v19 offset:23040
    v_cvt_pk_bf16_f32 v70, v72, v73
    v_cvt_pk_bf16_f32 v71, v74, v75
    buffer_store_dwordx4 v[68:71], v249, s[16:19], s78 offen sc1
    s_bitcmp0_b32 s88, 1
    s_cbranch_scc1 L_nr7
    v_xor_b32 v249, 0x80000000, v249
    buffer_store_dwordx2 v[68:69], v249, s[16:19], s78 offen sc1
    buffer_store_dwordx2 v[70:71], v249, s[16:19], s79 offen sc1
L_nr7:
    s_waitcnt lgkmcnt(5)
    v_mfma_f32_32x32x16_bf16 v[92:107], v[36:39], v[52:55], v[92:107]
    s_barrier
    ds_read_b128 v[44:47], v2 offset:0
    ds_read_b64_tr_b16 v[28:29], v18 offset:24576
    v_mul_f32 v76, v76, v238
    v_mul_f32 v77, v77, v238
    v_mul_f32 v78, v78, v238
    v_mfma_f32_32x32x16_bf16 v[108:123], v[40:43], v[52:55], v[108:123]
    ds_read_b64_tr_b16 v[30:31], v18 offset:25088
    ds_read_b64_tr_b16 v[32:33], v19 offset:24576
    ds_read_b64_tr_b16 v[34:35], v19 offset:25088
    v_mul_f32 v79, v79, v238
    v_mul_f32 v80, v80, v238
    v_mul_f32 v81, v81, v238
    v_mul_f32 v82, v82, v238
    s_waitcnt lgkmcnt(5)
    v_mfma_f32_32x32x16_bf16 v[92:107], v[20:23], v[56:59], v[92:107]
    ds_read_b128 v[48:51], v3 offset:0
    ds_read_b64_tr_b16 v[36:37], v18 offset:26624
    v_mul_f32 v83, v83, v238
    v_cvt_pk_bf16_f32 v76, v76, v77
    v_cvt_pk_bf16_f32 v77, v78, v79
    v_mfma_f32_32x32x16_bf16 v[108:123], v[24:27], v[56:59], v[108:123]
    ds_read_b64_tr_b16 v[38:39], v18 offset:27136
    ds_read_b64_tr_b16 v[40:41], v19 offset:26624
    ds_read_b64_tr_b16 v[42:43], v19 offset:27136
    v_cvt_pk_bf16_f32 v78, v80, v81
    v_cvt_pk_bf16_f32 v79, v82, v83
    buffer_store_dwordx4 v[76:79], v250, s[16:19], s78 offen sc1
    s_bitcmp0_b32 s88, 2
    s_cbranch_scc1 L_nr8
    v_xor_b32 v250, 0x80000000, v250
    buffer_store_dwordx2 v[76:77], v250, s[16:19], s78 offen sc1
    buffer_store_dwordx2 v[78:79], v250, s[16:19], s79 offen sc1
L_nr8:
    s_waitcnt lgkmcnt(5)
    v_mfma_f32_32x32x16_bf16 v[92:107], v[28:31], v[44:47], v[92:107]
    ds_read_b128 v[52:55], v13 offset:0
    ds_read_b64_tr_b16 v[20:21], v18 offset:28672
    v_mul_f32 v84, v84, v238
    v_mul_f32 v85, v85, v238
    v_mul_f32 v86, v86, v238
    v_mfma_f32_32x32x16_bf16 v[108:123], v[32:35], v[44:47], v[108:123]
    ds_read_b64_tr_b16 v[22:23], v18 offset:29184
    ds_read_b64_tr_b16 v[24:25], v19 offset:28672
    ds_read_b64_tr_b16 v[26:27], v19 offset:29184
    v_mul_f32 v87, v87, v238
    v_mul_f32 v88, v88, v238
    v_mul_f32 v89, v89, v238
    v_mul_f32 v90, v90, v238
    s_waitcnt lgkmcnt(5)
    v_mfma_f32_32x32x16_bf16 v[92:107], v[36:39], v[48:51], v[92:107]
    ds_read_b128 v[56:59], v14 offset:0
    ds_read_b64_tr_b16 v[28:29], v18 offset:30720
    v_mul_f32 v91, v91, v238
    v_cvt_pk_bf16_f32 v84, v84, v85
    v_cvt_pk_bf16_f32 v85, v86, v87
    v_mfma_f32_32x32x16_bf16 v[108:123], v[40:43], v[48:51], v[108:123]
    ds_read_b64_tr_b16 v[30:31], v18 offset:31232
    ds_read_b64_tr_b16 v[32:33], v19 offset:30720
    ds_read_b64_tr_b16 v[34:35], v19 offset:31232
    v_cvt_pk_bf16_f32 v86, v88, v89
    v_cvt_pk_bf16_f32 v87, v90, v91
    buffer_store_dwordx4 v[84:87], v251, s[16:19], s78 offen sc1
    s_bitcmp0_b32 s88, 3
    s_cbranch_scc1 L_nr9
    v_xor_b32 v251, 0x80000000, v251
    buffer_store_dwordx2 v[84:85], v251, s[16:19], s78 offen sc1
    buffer_store_dwordx2 v[86:87], v251, s[16:19], s79 offen sc1
L_nr9:
    s_waitcnt lgkmcnt(5)
    v_mfma_f32_32x32x16_bf16 v[92:107], v[20:23], v[52:55], v[92:107]
    ds_read_b128 v[44:47], v2 offset:16384
    ds_read_b64_tr_b16 v[36:37], v18 offset:32768
    v_mul_f32 v238, s91, v238
    v_lshlrev_b32 v4, 3, v10
    v_mov_b32 v239, v238
    v_mfma_f32_32x32x16_bf16 v[108:123], v[24:27], v[52:55], v[108:123]
    ds_read_b64_tr_b16 v[38:39], v18 offset:33280
    ds_read_b64_tr_b16 v[40:41], v19 offset:32768
    ds_read_b64_tr_b16 v[42:43], v19 offset:33280
    v_add_u32 v4, 32768, v4
    v_mov_b32 v5, 34304
    v_mov_b32 v7, 1
    s_waitcnt lgkmcnt(5)
    v_mfma_f32_32x32x16_bf16 v[92:107], v[28:31], v[56:59], v[92:107]
    ds_read_b128 v[48:51], v3 offset:16384
    ds_read_b64_tr_b16 v[20:21], v18 offset:34816
    v_mfma_f32_32x32x16_bf16 v[108:123], v[32:35], v[56:59], v[108:123]
    ds_read_b64_tr_b16 v[22:23], v18 offset:35328
    ds_read_b64_tr_b16 v[24:25], v19 offset:34816
    ds_read_b64_tr_b16 v[26:27], v19 offset:35328
    s_waitcnt lgkmcnt(5)
    v_mfma_f32_32x32x16_bf16 v[92:107], v[36:39], v[44:47], v[92:107]
    ds_read_b128 v[52:55], v13 offset:16384
    ds_read_b64_tr_b16 v[28:29], v18 offset:36864
    v_mfma_f32_32x32x16_bf16 v[108:123], v[40:43], v[44:47], v[108:123]
    ds_read_b64_tr_b16 v[30:31], v18 offset:37376
    ds_read_b64_tr_b16 v[32:33], v19 offset:36864
    ds_read_b64_tr_b16 v[34:35], v19 offset:37376
    s_waitcnt lgkmcnt(5)
    v_mfma_f32_32x32x16_bf16 v[92:107], v[20:23], v[48:51], v[92:107]
    ds_read_b128 v[56:59], v14 offset:16384
    ds_read_b64_tr_b16 v[36:37], v18 offset:38912
    v_mfma_f32_32x32x16_bf16 v[108:123], v[24:27], v[48:51], v[108:123]
    ds_read_b64_tr_b16 v[38:39], v18 offset:39424
    ds_read_b64_tr_b16 v[40:41], v19 offset:38912
    ds_read_b64_tr_b16 v[42:43], v19 offset:39424
    s_waitcnt lgkmcnt(5)
    v_mfma_f32_32x32x16_bf16 v[92:107], v[28:31], v[52:55], v[92:107]
    s_waitcnt lgkmcnt(0)
    s_barrier
    ds_read_b64_tr_b16 v[20:21], v18 offset:40960
    ds_read_b64_tr_b16 v[22:23], v18 offset:41472
    v_mfma_f32_32x32x16_bf16 v[108:123], v[32:35], v[52:55], v[108:123]
    ds_read_b64_tr_b16 v[24:25], v19 offset:40960
    ds_read_b64_tr_b16 v[26:27], v19 offset:41472
    v_mfma_f32_32x32x16_bf16 v[92:107], v[36:39], v[56:59], v[92:107]
    ds_read_b64_tr_b16 v[28:29], v18 offset:43008
    ds_read_b64_tr_b16 v[30:31], v18 offset:43520
    v_mfma_f32_32x32x16_bf16 v[108:123], v[40:43], v[56:59], v[108:123]
    ds_read_b64_tr_b16 v[32:33], v19 offset:43008
    ds_read_b64_tr_b16 v[34:35], v19 offset:43520
    s_waitcnt lgkmcnt(4)
    v_mfma_f32_32x32x16_bf16 v[92:107], v[20:23], v[156:159], v[92:107]
    ds_read_b64_tr_b16 v[36:37], v18 offset:45056
    ds_read_b64_tr_b16 v[38:39], v18 offset:45568
    v_mfma_f32_32x32x16_bf16 v[108:123], v[24:27], v[156:159], v[108:123]
    ds_read_b64_tr_b16 v[40:41], v19 offset:45056
    ds_read_b64_tr_b16 v[42:43], v19 offset:45568
    s_waitcnt lgkmcnt(4)
    v_mfma_f32_32x32x16_bf16 v[92:107], v[28:31], v[160:163], v[92:107]
    ds_read_b64_tr_b16 v[20:21], v18 offset:47104
    ds_read_b64_tr_b16 v[22:23], v18 offset:47616
    v_mfma_f32_32x32x16_bf16 v[108:123], v[32:35], v[160:163], v[108:123]
    ds_read_b64_tr_b16 v[24:25], v19 offset:47104
    ds_read_b64_tr_b16 v[26:27], v19 offset:47616
    s_waitcnt lgkmcnt(4)
    v_mfma_f32_32x32x16_bf16 v[92:107], v[36:39], v[164:167], v[92:107]
    ds_read_b64_tr_b16 v[28:29], v18 offset:49152
    ds_read_b64_tr_b16 v[30:31], v18 offset:49664
    v_mfma_f32_32x32x16_bf16 v[108:123], v[40:43], v[164:167], v[108:123]
    ds_read_b64_tr_b16 v[32:33], v19 offset:49152
    ds_read_b64_tr_b16 v[34:35], v19 offset:49664
    s_waitcnt lgkmcnt(4)
    v_mfma_f32_32x32x16_bf16 v[92:107], v[20:23], v[168:171], v[92:107]
    ds_read_b64_tr_b16 v[36:37], v18 offset:51200
    ds_read_b64_tr_b16 v[38:39], v18 offset:51712
    v_mfma_f32_32x32x16_bf16 v[108:123], v[24:27], v[168:171], v[108:123]
    ds_read_b64_tr_b16 v[40:41], v19 offset:51200
    ds_read_b64_tr_b16 v[42:43], v19 offset:51712
    s_waitcnt lgkmcnt(4)
    v_mfma_f32_32x32x16_bf16 v[92:107], v[28:31], v[172:175], v[92:107]
    ds_read_b64_tr_b16 v[20:21], v18 offset:53248
    ds_read_b64_tr_b16 v[22:23], v18 offset:53760
    v_mfma_f32_32x32x16_bf16 v[108:123], v[32:35], v[172:175], v[108:123]
    ds_read_b64_tr_b16 v[24:25], v19 offset:53248
    ds_read_b64_tr_b16 v[26:27], v19 offset:53760
    s_waitcnt vmcnt(0)
    buffer_store_dword v7, off, s[16:19], s98 sc1
    s_waitcnt lgkmcnt(4)
    v_mfma_f32_32x32x16_bf16 v[92:107], v[36:39], v[176:179], v[92:107]
    ds_read_b64_tr_b16 v[28:29], v18 offset:55296
    ds_read_b64_tr_b16 v[30:31], v18 offset:55808
    v_mfma_f32_32x32x16_bf16 v[108:123], v[40:43], v[176:179], v[108:123]
    ds_read_b64_tr_b16 v[32:33], v19 offset:55296
    ds_read_b64_tr_b16 v[34:35], v19 offset:55808
    s_waitcnt lgkmcnt(4)
    v_mfma_f32_32x32x16_bf16 v[92:107], v[20:23], v[180:183], v[92:107]
    s_barrier
    ds_read_b64_tr_b16 v[36:37], v18 offset:57344
    ds_read_b64_tr_b16 v[38:39], v18 offset:57856
    v_mfma_f32_32x32x16_bf16 v[108:123], v[24:27], v[180:183], v[108:123]
    ds_read_b64_tr_b16 v[40:41], v19 offset:57344
    ds_read_b64_tr_b16 v[42:43], v19 offset:57856
    s_waitcnt lgkmcnt(4)
    v_mfma_f32_32x32x16_bf16 v[92:107], v[28:31], v[184:187], v[92:107]
    ds_read_b64_tr_b16 v[20:21], v18 offset:59392
    ds_read_b64_tr_b16 v[22:23], v18 offset:59904
    v_mfma_f32_32x32x16_bf16 v[108:123], v[32:35], v[184:187], v[108:123]
    ds_read_b64_tr_b16 v[24:25], v19 offset:59392
    ds_read_b64_tr_b16 v[26:27], v19 offset:59904
    s_waitcnt lgkmcnt(4)
    v_mfma_f32_32x32x16_bf16 v[92:107], v[36:39], v[188:191], v[92:107]
    ds_read_b64_tr_b16 v[28:29], v18 offset:61440
    ds_read_b64_tr_b16 v[30:31], v18 offset:61952
    v_mfma_f32_32x32x16_bf16 v[108:123], v[40:43], v[188:191], v[108:123]
    ds_read_b64_tr_b16 v[32:33], v19 offset:61440
    ds_read_b64_tr_b16 v[34:35], v19 offset:61952
    s_waitcnt lgkmcnt(4)
    v_mfma_f32_32x32x16_bf16 v[92:107], v[20:23], v[192:195], v[92:107]
    ds_read_b64_tr_b16 v[36:37], v18 offset:63488
    ds_read_b64_tr_b16 v[38:39], v18 offset:64000
    v_mfma_f32_32x32x16_bf16 v[108:123], v[24:27], v[192:195], v[108:123]
    ds_read_b64_tr_b16 v[40:41], v19 offset:63488
    ds_read_b64_tr_b16 v[42:43], v19 offset:64000
    s_waitcnt lgkmcnt(4)
    v_subrev_u32 v18, 16384, v18
    v_subrev_u32 v19, 16384, v19
    v_mfma_f32_32x32x16_bf16 v[92:107], v[28:31], v[196:199], v[92:107]
    s_barrier
    ds_read_b64_tr_b16 v[20:21], v18 offset:0
    ds_read_b64_tr_b16 v[22:23], v18 offset:512
    v_mfma_f32_32x32x16_bf16 v[108:123], v[32:35], v[196:199], v[108:123]
    ds_read_b64_tr_b16 v[24:25], v19 offset:0
    ds_read_b64_tr_b16 v[26:27], v19 offset:512
    ds_read_b64 v[140:141], v4 offset:0
    ds_read_b64 v[142:143], v4 offset:512
    ds_read_b32 v6, v5
    s_waitcnt lgkmcnt(7)
    v_mfma_f32_32x32x16_bf16 v[92:107], v[36:39], v[200:203], v[92:107]
    ds_read_b64_tr_b16 v[28:29], v18 offset:2048
    ds_read_b64_tr_b16 v[30:31], v18 offset:2560
    v_mfma_f32_32x32x16_bf16 v[108:123], v[40:43], v[200:203], v[108:123]
    ds_read_b64_tr_b16 v[32:33], v19 offset:2048
    ds_read_b64_tr_b16 v[34:35], v19 offset:2560
    s_waitcnt lgkmcnt(7)
    v_mfma_f32_32x32x16_bf16 v[92:107], v[20:23], v[204:207], v[92:107]
    ds_read_b64_tr_b16 v[36:37], v18 offset:4096
    ds_read_b64_tr_b16 v[38:39], v18 offset:4608
    v_mfma_f32_32x32x16_bf16 v[108:123], v[24:27], v[204:207], v[108:123]
    ds_read_b64_tr_b16 v[40:41], v19 offset:4096
    ds_read_b64_tr_b16 v[42:43], v19 offset:4608
    s_waitcnt lgkmcnt(4)
    v_mfma_f32_32x32x16_bf16 v[92:107], v[28:31], v[208:211], v[92:107]
    ds_read_b64_tr_b16 v[20:21], v18 offset:6144
    ds_read_b64_tr_b16 v[22:23], v18 offset:6656
    v_mfma_f32_32x32x16_bf16 v[108:123], v[32:35], v[208:211], v[108:123]
    ds_read_b64_tr_b16 v[24:25], v19 offset:6144
    ds_read_b64_tr_b16 v[26:27], v19 offset:6656
    s_waitcnt lgkmcnt(4)
    v_mfma_f32_32x32x16_bf16 v[92:107], v[36:39], v[212:215], v[92:107]
    ds_read_b64_tr_b16 v[28:29], v18 offset:8192
    ds_read_b64_tr_b16 v[30:31], v18 offset:8704
    v_mfma_f32_32x32x16_bf16 v[108:123], v[40:43], v[212:215], v[108:123]
    ds_read_b64_tr_b16 v[32:33], v19 offset:8192
    ds_read_b64_tr_b16 v[34:35], v19 offset:8704
    s_waitcnt lgkmcnt(4)
    v_mfma_f32_32x32x16_bf16 v[92:107], v[20:23], v[216:219], v[92:107]
    ds_read_b64_tr_b16 v[36:37], v18 offset:10240
    ds_read_b64_tr_b16 v[38:39], v18 offset:10752
    v_mfma_f32_32x32x16_bf16 v[108:123], v[24:27], v[216:219], v[108:123]
    ds_read_b64_tr_b16 v[40:41], v19 offset:10240
    ds_read_b64_tr_b16 v[42:43], v19 offset:10752
    s_waitcnt lgkmcnt(4)
    v_mfma_f32_32x32x16_bf16 v[92:107], v[28:31], v[220:223], v[92:107]
    ds_read_b64_tr_b16 v[20:21], v18 offset:12288
    ds_read_b64_tr_b16 v[22:23], v18 offset:12800
    v_mfma_f32_32x32x16_bf16 v[108:123], v[32:35], v[220:223], v[108:123]
    ds_read_b64_tr_b16 v[24:25], v19 offset:12288
    ds_read_b64_tr_b16 v[26:27], v19 offset:12800
    s_waitcnt lgkmcnt(4)
    v_mfma_f32_32x32x16_bf16 v[92:107], v[36:39], v[224:227], v[92:107]
    ds_read_b64_tr_b16 v[28:29], v18 offset:14336
    ds_read_b64_tr_b16 v[30:31], v18 offset:14848
    v_mfma_f32_32x32x16_bf16 v[108:123], v[40:43], v[224:227], v[108:123]
    ds_read_b64_tr_b16 v[32:33], v19 offset:14336
    ds_read_b64_tr_b16 v[34:35], v19 offset:14848
    s_waitcnt lgkmcnt(4)
    v_mfma_f32_32x32x16_bf16 v[92:107], v[20:23], v[228:231], v[92:107]
    v_mfma_f32_32x32x16_bf16 v[108:123], v[24:27], v[228:231], v[108:123]
    v_readfirstlane_b32 s31, v6
    s_waitcnt lgkmcnt(0)
    v_mfma_f32_32x32x16_bf16 v[92:107], v[28:31], v[232:235], v[92:107]
    v_mfma_f32_32x32x16_bf16 v[108:123], v[32:35], v[232:235], v[108:123]
    v_mfma_f32_32x32x8_bf16 v[92:107], v[140:141], v[240:241], v[92:107]
    v_mfma_f32_32x32x8_bf16 v[108:123], v[142:143], v[240:241], v[108:123]
    s_cmp_lt_u32 s96, 10
    s_cselect_b32 s97, s31, 1
    s_nop 8
    v_pk_mul_f32 v[92:93], v[92:93], v[238:239]
    v_pk_mul_f32 v[94:95], v[94:95], v[238:239]
    v_pk_mul_f32 v[96:97], v[96:97], v[238:239]
    v_pk_mul_f32 v[98:99], v[98:99], v[238:239]
    v_cvt_pk_bf16_f32 v92, v92, v93
    v_cvt_pk_bf16_f32 v93, v94, v95
    v_cvt_pk_bf16_f32 v94, v96, v97
    v_cvt_pk_bf16_f32 v95, v98, v99
    s_cmp_lg_u32 s97, 0
    s_cbranch_scc1 L_ms10
    buffer_store_dwordx4 v[92:95], v252, s[16:19], s80 offen
L_mb10:
    s_bitcmp0_b32 s89, 0
    s_cbranch_scc1 L_nr11
    v_xor_b32 v252, 0x80000000, v252
    s_cmp_lg_u32 s97, 0
    s_cbranch_scc1 L_ms12
    buffer_store_dwordx2 v[92:93], v252, s[16:19], s80 offen
L_mb12:
    s_cmp_lg_u32 s97, 0
    s_cbranch_scc1 L_ms13
    buffer_store_dwordx2 v[94:95], v252, s[16:19], s81 offen
L_mb13:
L_nr11:
    v_pk_mul_f32 v[100:101], v[100:101], v[238:239]
    v_pk_mul_f32 v[102:103], v[102:103], v[238:239]
    v_pk_mul_f32 v[104:105], v[104:105], v[238:239]
    v_pk_mul_f32 v[106:107], v[106:107], v[238:239]
    v_cvt_pk_bf16_f32 v100, v100, v101
    v_cvt_pk_bf16_f32 v101, v102, v103
    v_cvt_pk_bf16_f32 v102, v104, v105
    v_cvt_pk_bf16_f32 v103, v106, v107
    s_cmp_lg_u32 s97, 0
    s_cbranch_scc1 L_ms14
    buffer_store_dwordx4 v[100:103], v253, s[16:19], s80 offen
L_mb14:
    s_bitcmp0_b32 s89, 1
    s_cbranch_scc1 L_nr15
    v_xor_b32 v253, 0x80000000, v253
    s_cmp_lg_u32 s97, 0
    s_cbranch_scc1 L_ms16
    buffer_store_dwordx2 v[100:101], v253, s[16:19], s80 offen
L_mb16:
    s_cmp_lg_u32 s97, 0
    s_cbranch_scc1 L_ms17
    buffer_store_dwordx2 v[102:103], v253, s[16:19], s81 offen
L_mb17:
L_nr15:
    v_pk_mul_f32 v[108:109], v[108:109], v[238:239]
    v_pk_mul_f32 v[110:111], v[110:111], v[238:239]
    v_pk_mul_f32 v[112:113], v[112:113], v[238:239]
    v_pk_mul_f32 v[114:115], v[114:115], v[238:239]
    v_cvt_pk_bf16_f32 v108, v108, v109
    v_cvt_pk_bf16_f32 v109, v110, v111
    v_cvt_pk_bf16_f32 v110, v112, v113
    v_cvt_pk_bf16_f32 v111, v114, v115
    s_cmp_lg_u32 s97, 0
    s_cbranch_scc1 L_ms18
    buffer_store_dwordx4 v[108:111], v254, s[16:19], s80 offen
L_mb18:
    s_bitcmp0_b32 s89, 2
    s_cbranch_scc1 L_nr19
    v_xor_b32 v254, 0x80000000, v254
    s_cmp_lg_u32 s97, 0
    s_cbranch_scc1 L_ms20
    buffer_store_dwordx2 v[108:109], v254, s[16:19], s80 offen
L_mb20:
    s_cmp_lg_u32 s97, 0
    s_cbranch_scc1 L_ms21
    buffer_store_dwordx2 v[110:111], v254, s[16:19], s81 offen
L_mb21:
L_nr19:
    v_pk_mul_f32 v[116:117], v[116:117], v[238:239]
    v_pk_mul_f32 v[118:119], v[118:119], v[238:239]
    v_pk_mul_f32 v[120:121], v[120:121], v[238:239]
    v_pk_mul_f32 v[122:123], v[122:123], v[238:239]
    v_cvt_pk_bf16_f32 v116, v116, v117
    v_cvt_pk_bf16_f32 v117, v118, v119
    v_cvt_pk_bf16_f32 v118, v120, v121
    v_cvt_pk_bf16_f32 v119, v122, v123
    s_cmp_lg_u32 s97, 0
    s_cbranch_scc1 L_ms22
    buffer_store_dwordx4 v[116:119], v255, s[16:19], s80 offen
L_mb22:
    s_bitcmp0_b32 s89, 3
    s_cbranch_scc1 L_nr23
    v_xor_b32 v255, 0x80000000, v255
    s_cmp_lg_u32 s97, 0
    s_cbranch_scc1 L_ms24
    buffer_store_dwordx2 v[116:117], v255, s[16:19], s80 offen
L_mb24:
    s_cmp_lg_u32 s97, 0
    s_cbranch_scc1 L_ms25
    buffer_store_dwordx2 v[118:119], v255, s[16:19], s81 offen
L_mb25:
L_nr23:
    s_branch L_setup
L_p1v:
    s_barrier
    ds_read_b128 v[124:127], v2 offset:0
    ds_read_b64_tr_b16 v[20:21], v16 offset:0
    ds_read_b64_tr_b16 v[22:23], v16 offset:512
    ds_read_b64_tr_b16 v[24:25], v17 offset:0
    ds_read_b64_tr_b16 v[26:27], v17 offset:512
    ds_read_b128 v[128:131], v3 offset:0
    ds_read_b64_tr_b16 v[28:29], v16 offset:2048
    ds_read_b64_tr_b16 v[30:31], v16 offset:2560
    ds_read_b64_tr_b16 v[32:33], v17 offset:2048
    ds_read_b64_tr_b16 v[34:35], v17 offset:2560
    s_waitcnt lgkmcnt(5)
    v_mfma_f32_32x32x16_bf16 v[60:75], v[124:127], v[20:23], 0
    ds_read_b128 v[132:135], v13 offset:0
    ds_read_b64_tr_b16 v[36:37], v16 offset:4096
    v_mfma_f32_32x32x16_bf16 v[76:91], v[124:127], v[24:27], 0
    ds_read_b64_tr_b16 v[38:39], v16 offset:4608
    ds_read_b64_tr_b16 v[40:41], v17 offset:4096
    ds_read_b64_tr_b16 v[42:43], v17 offset:4608
    v_smfmac_f32_16x16x64_bf16 v[236:239], v[92:95], v[20:27], v96
    s_waitcnt lgkmcnt(5)
    v_mfma_f32_32x32x16_bf16 v[60:75], v[128:131], v[28:31], v[60:75]
    ds_read_b128 v[136:139], v14 offset:0
    ds_read_b64_tr_b16 v[20:21], v16 offset:6144
    v_mfma_f32_32x32x16_bf16 v[76:91], v[128:131], v[32:35], v[76:91]
    ds_read_b64_tr_b16 v[22:23], v16 offset:6656
    ds_read_b64_tr_b16 v[24:25], v17 offset:6144
    ds_read_b64_tr_b16 v[26:27], v17 offset:6656
    v_smfmac_f32_16x16x64_bf16 v[236:239], v[92:95], v[28:35], v96
    s_waitcnt lgkmcnt(5)
    v_mfma_f32_32x32x16_bf16 v[60:75], v[132:135], v[36:39], v[60:75]
    s_waitcnt lgkmcnt(0)
    s_barrier
    ds_read_b128 v[140:143], v2 offset:16384
    ds_read_b64_tr_b16 v[28:29], v16 offset:8192
    v_mfma_f32_32x32x16_bf16 v[76:91], v[132:135], v[40:43], v[76:91]
    ds_read_b64_tr_b16 v[30:31], v16 offset:8704
    ds_read_b64_tr_b16 v[32:33], v17 offset:8192
    ds_read_b64_tr_b16 v[34:35], v17 offset:8704
    v_smfmac_f32_16x16x64_bf16 v[236:239], v[92:95], v[36:43], v96
    v_mfma_f32_32x32x16_bf16 v[60:75], v[136:139], v[20:23], v[60:75]
    ds_read_b128 v[144:147], v3 offset:16384
    ds_read_b64_tr_b16 v[36:37], v16 offset:10240
    v_mfma_f32_32x32x16_bf16 v[76:91], v[136:139], v[24:27], v[76:91]
    ds_read_b64_tr_b16 v[38:39], v16 offset:10752
    ds_read_b64_tr_b16 v[40:41], v17 offset:10240
    ds_read_b64_tr_b16 v[42:43], v17 offset:10752
    v_smfmac_f32_16x16x64_bf16 v[236:239], v[92:95], v[20:27], v96
    s_waitcnt lgkmcnt(5)
    v_mfma_f32_32x32x16_bf16 v[60:75], v[140:143], v[28:31], v[60:75]
    ds_read_b128 v[148:151], v13 offset:16384
    ds_read_b64_tr_b16 v[20:21], v16 offset:12288
    v_mfma_f32_32x32x16_bf16 v[76:91], v[140:143], v[32:35], v[76:91]
    ds_read_b64_tr_b16 v[22:23], v16 offset:12800
    ds_read_b64_tr_b16 v[24:25], v17 offset:12288
    ds_read_b64_tr_b16 v[26:27], v17 offset:12800
    v_smfmac_f32_16x16x64_bf16 v[236:239], v[92:95], v[28:35], v96
    s_waitcnt lgkmcnt(5)
    v_mfma_f32_32x32x16_bf16 v[60:75], v[144:147], v[36:39], v[60:75]
    ds_read_b128 v[152:155], v14 offset:16384
    ds_read_b64_tr_b16 v[28:29], v16 offset:14336
    v_mfma_f32_32x32x16_bf16 v[76:91], v[144:147], v[40:43], v[76:91]
    ds_read_b64_tr_b16 v[30:31], v16 offset:14848
    ds_read_b64_tr_b16 v[32:33], v17 offset:14336
    ds_read_b64_tr_b16 v[34:35], v17 offset:14848
    v_smfmac_f32_16x16x64_bf16 v[236:239], v[92:95], v[36:43], v96
    s_waitcnt lgkmcnt(5)
    v_mfma_f32_32x32x16_bf16 v[60:75], v[148:151], v[20:23], v[60:75]
    s_waitcnt lgkmcnt(0)
    s_barrier
    ds_read_b128 v[156:159], v2 offset:32768
    ds_read_b64_tr_b16 v[36:37], v16 offset:16384
    v_mfma_f32_32x32x16_bf16 v[76:91], v[148:151], v[24:27], v[76:91]
    ds_read_b64_tr_b16 v[38:39], v16 offset:16896
    ds_read_b64_tr_b16 v[40:41], v17 offset:16384
    ds_read_b64_tr_b16 v[42:43], v17 offset:16896
    v_smfmac_f32_16x16x64_bf16 v[236:239], v[92:95], v[20:27], v96
    v_mfma_f32_32x32x16_bf16 v[60:75], v[152:155], v[28:31], v[60:75]
    ds_read_b128 v[160:163], v3 offset:32768
    ds_read_b64_tr_b16 v[20:21], v16 offset:18432
    v_mfma_f32_32x32x16_bf16 v[76:91], v[152:155], v[32:35], v[76:91]
    ds_read_b64_tr_b16 v[22:23], v16 offset:18944
    ds_read_b64_tr_b16 v[24:25], v17 offset:18432
    ds_read_b64_tr_b16 v[26:27], v17 offset:18944
    v_smfmac_f32_16x16x64_bf16 v[236:239], v[92:95], v[28:35], v96
    s_waitcnt lgkmcnt(5)
    v_mfma_f32_32x32x16_bf16 v[60:75], v[156:159], v[36:39], v[60:75]
    ds_read_b128 v[164:167], v13 offset:32768
    ds_read_b64_tr_b16 v[28:29], v16 offset:20480
    v_mfma_f32_32x32x16_bf16 v[76:91], v[156:159], v[40:43], v[76:91]
    ds_read_b64_tr_b16 v[30:31], v16 offset:20992
    ds_read_b64_tr_b16 v[32:33], v17 offset:20480
    ds_read_b64_tr_b16 v[34:35], v17 offset:20992
    v_smfmac_f32_16x16x64_bf16 v[236:239], v[92:95], v[36:43], v96
    s_waitcnt lgkmcnt(5)
    v_mfma_f32_32x32x16_bf16 v[60:75], v[160:163], v[20:23], v[60:75]
    ds_read_b128 v[168:171], v14 offset:32768
    ds_read_b64_tr_b16 v[36:37], v16 offset:22528
    v_mfma_f32_32x32x16_bf16 v[76:91], v[160:163], v[24:27], v[76:91]
    ds_read_b64_tr_b16 v[38:39], v16 offset:23040
    ds_read_b64_tr_b16 v[40:41], v17 offset:22528
    ds_read_b64_tr_b16 v[42:43], v17 offset:23040
    v_smfmac_f32_16x16x64_bf16 v[236:239], v[92:95], v[20:27], v96
    s_waitcnt lgkmcnt(5)
    v_mfma_f32_32x32x16_bf16 v[60:75], v[164:167], v[28:31], v[60:75]
    s_waitcnt lgkmcnt(0)
    s_barrier
    ds_read_b128 v[172:175], v2 offset:49152
    ds_read_b64_tr_b16 v[20:21], v16 offset:24576
    v_mfma_f32_32x32x16_bf16 v[76:91], v[164:167], v[32:35], v[76:91]
    ds_read_b64_tr_b16 v[22:23], v16 offset:25088
    ds_read_b64_tr_b16 v[24:25], v17 offset:24576
    ds_read_b64_tr_b16 v[26:27], v17 offset:25088
    v_smfmac_f32_16x16x64_bf16 v[236:239], v[92:95], v[28:35], v96
    v_mfma_f32_32x32x16_bf16 v[60:75], v[168:171], v[36:39], v[60:75]
    ds_read_b128 v[176:179], v3 offset:49152
    ds_read_b64_tr_b16 v[28:29], v16 offset:26624
    v_mfma_f32_32x32x16_bf16 v[76:91], v[168:171], v[40:43], v[76:91]
    ds_read_b64_tr_b16 v[30:31], v16 offset:27136
    ds_read_b64_tr_b16 v[32:33], v17 offset:26624
    ds_read_b64_tr_b16 v[34:35], v17 offset:27136
    v_smfmac_f32_16x16x64_bf16 v[236:239], v[92:95], v[36:43], v96
    s_waitcnt lgkmcnt(5)
    v_mfma_f32_32x32x16_bf16 v[60:75], v[172:175], v[20:23], v[60:75]
    ds_read_b128 v[180:183], v13 offset:49152
    ds_read_b64_tr_b16 v[36:37], v16 offset:28672
    v_mfma_f32_32x32x16_bf16 v[76:91], v[172:175], v[24:27], v[76:91]
    ds_read_b64_tr_b16 v[38:39], v16 offset:29184
    ds_read_b64_tr_b16 v[40:41], v17 offset:28672
    ds_read_b64_tr_b16 v[42:43], v17 offset:29184
    v_smfmac_f32_16x16x64_bf16 v[236:239], v[92:95], v[20:27], v96
    s_waitcnt lgkmcnt(5)
    v_mfma_f32_32x32x16_bf16 v[60:75], v[176:179], v[28:31], v[60:75]
    ds_read_b128 v[184:187], v14 offset:49152
    ds_read_b64_tr_b16 v[20:21], v16 offset:30720
    v_mfma_f32_32x32x16_bf16 v[76:91], v[176:179], v[32:35], v[76:91]
    ds_read_b64_tr_b16 v[22:23], v16 offset:31232
    ds_read_b64_tr_b16 v[24:25], v17 offset:30720
    ds_read_b64_tr_b16 v[26:27], v17 offset:31232
    v_smfmac_f32_16x16x64_bf16 v[236:239], v[92:95], v[28:35], v96
    s_waitcnt lgkmcnt(5)
    v_mfma_f32_32x32x16_bf16 v[60:75], v[180:183], v[36:39], v[60:75]
    s_waitcnt lgkmcnt(0)
    s_barrier
    ds_read_b128 v[188:191], v2 offset:0
    ds_read_b64_tr_b16 v[28:29], v16 offset:0
    v_mfma_f32_32x32x16_bf16 v[76:91], v[180:183], v[40:43], v[76:91]
    ds_read_b64_tr_b16 v[30:31], v16 offset:512
    ds_read_b64_tr_b16 v[32:33], v17 offset:0
    ds_read_b64_tr_b16 v[34:35], v17 offset:512
    v_smfmac_f32_16x16x64_bf16 v[236:239], v[92:95], v[36:43], v96
    v_mfma_f32_32x32x16_bf16 v[60:75], v[184:187], v[20:23], v[60:75]
    ds_read_b128 v[192:195], v3 offset:0
    ds_read_b64_tr_b16 v[36:37], v16 offset:2048
    v_mfma_f32_32x32x16_bf16 v[76:91], v[184:187], v[24:27], v[76:91]
    ds_read_b64_tr_b16 v[38:39], v16 offset:2560
    ds_read_b64_tr_b16 v[40:41], v17 offset:2048
    ds_read_b64_tr_b16 v[42:43], v17 offset:2560
    v_smfmac_f32_16x16x64_bf16 v[236:239], v[92:95], v[20:27], v96
    s_waitcnt lgkmcnt(5)
    v_mfma_f32_32x32x16_bf16 v[60:75], v[188:191], v[28:31], v[60:75]
    ds_read_b128 v[196:199], v13 offset:0
    ds_read_b64_tr_b16 v[20:21], v16 offset:4096
    v_mfma_f32_32x32x16_bf16 v[76:91], v[188:191], v[32:35], v[76:91]
    ds_read_b64_tr_b16 v[22:23], v16 offset:4608
    ds_read_b64_tr_b16 v[24:25], v17 offset:4096
    ds_read_b64_tr_b16 v[26:27], v17 offset:4608
    v_smfmac_f32_16x16x64_bf16 v[236:239], v[92:95], v[28:35], v96
    s_waitcnt lgkmcnt(5)
    v_mfma_f32_32x32x16_bf16 v[60:75], v[192:195], v[36:39], v[60:75]
    ds_read_b128 v[200:203], v14 offset:0
    ds_read_b64_tr_b16 v[28:29], v16 offset:6144
    v_mfma_f32_32x32x16_bf16 v[76:91], v[192:195], v[40:43], v[76:91]
    ds_read_b64_tr_b16 v[30:31], v16 offset:6656
    ds_read_b64_tr_b16 v[32:33], v17 offset:6144
    ds_read_b64_tr_b16 v[34:35], v17 offset:6656
    v_smfmac_f32_16x16x64_bf16 v[236:239], v[92:95], v[36:43], v96
    s_waitcnt lgkmcnt(5)
    v_mfma_f32_32x32x16_bf16 v[60:75], v[196:199], v[20:23], v[60:75]
    s_waitcnt lgkmcnt(0)
    s_barrier
    ds_read_b128 v[204:207], v2 offset:16384
    ds_read_b64_tr_b16 v[36:37], v16 offset:8192
    v_mfma_f32_32x32x16_bf16 v[76:91], v[196:199], v[24:27], v[76:91]
    ds_read_b64_tr_b16 v[38:39], v16 offset:8704
    ds_read_b64_tr_b16 v[40:41], v17 offset:8192
    ds_read_b64_tr_b16 v[42:43], v17 offset:8704
    v_smfmac_f32_16x16x64_bf16 v[236:239], v[92:95], v[20:27], v96
    v_mfma_f32_32x32x16_bf16 v[60:75], v[200:203], v[28:31], v[60:75]
    ds_read_b128 v[208:211], v3 offset:16384
    ds_read_b64_tr_b16 v[20:21], v16 offset:10240
    v_mfma_f32_32x32x16_bf16 v[76:91], v[200:203], v[32:35], v[76:91]
    ds_read_b64_tr_b16 v[22:23], v16 offset:10752
    ds_read_b64_tr_b16 v[24:25], v17 offset:10240
    ds_read_b64_tr_b16 v[26:27], v17 offset:10752
    v_smfmac_f32_16x16x64_bf16 v[236:239], v[92:95], v[28:35], v96
    s_waitcnt lgkmcnt(5)
    v_mfma_f32_32x32x16_bf16 v[60:75], v[204:207], v[36:39], v[60:75]
    ds_read_b128 v[212:215], v13 offset:16384
    ds_read_b64_tr_b16 v[28:29], v16 offset:12288
    v_mfma_f32_32x32x16_bf16 v[76:91], v[204:207], v[40:43], v[76:91]
    ds_read_b64_tr_b16 v[30:31], v16 offset:12800
    ds_read_b64_tr_b16 v[32:33], v17 offset:12288
    ds_read_b64_tr_b16 v[34:35], v17 offset:12800
    v_smfmac_f32_16x16x64_bf16 v[236:239], v[92:95], v[36:43], v96
    s_waitcnt lgkmcnt(5)
    v_mfma_f32_32x32x16_bf16 v[60:75], v[208:211], v[20:23], v[60:75]
    ds_read_b128 v[216:219], v14 offset:16384
    ds_read_b64_tr_b16 v[36:37], v16 offset:14336
    v_mfma_f32_32x32x16_bf16 v[76:91], v[208:211], v[24:27], v[76:91]
    ds_read_b64_tr_b16 v[38:39], v16 offset:14848
    ds_read_b64_tr_b16 v[40:41], v17 offset:14336
    ds_read_b64_tr_b16 v[42:43], v17 offset:14848
    v_smfmac_f32_16x16x64_bf16 v[236:239], v[92:95], v[20:27], v96
    s_waitcnt lgkmcnt(5)
    v_mfma_f32_32x32x16_bf16 v[60:75], v[212:215], v[28:31], v[60:75]
    s_waitcnt lgkmcnt(0)
    s_barrier
    ds_read_b128 v[220:223], v2 offset:32768
    ds_read_b64_tr_b16 v[20:21], v16 offset:16384
    v_mfma_f32_32x32x16_bf16 v[76:91], v[212:215], v[32:35], v[76:91]
    ds_read_b64_tr_b16 v[22:23], v16 offset:16896
    ds_read_b64_tr_b16 v[24:25], v17 offset:16384
    ds_read_b64_tr_b16 v[26:27], v17 offset:16896
    v_smfmac_f32_16x16x64_bf16 v[236:239], v[92:95], v[28:35], v96
    v_mfma_f32_32x32x16_bf16 v[60:75], v[216:219], v[36:39], v[60:75]
    ds_read_b128 v[224:227], v3 offset:32768
    ds_read_b64_tr_b16 v[28:29], v16 offset:18432
    v_mfma_f32_32x32x16_bf16 v[76:91], v[216:219], v[40:43], v[76:91]
    ds_read_b64_tr_b16 v[30:31], v16 offset:18944
    ds_read_b64_tr_b16 v[32:33], v17 offset:18432
    ds_read_b64_tr_b16 v[34:35], v17 offset:18944
    v_smfmac_f32_16x16x64_bf16 v[236:239], v[92:95], v[36:43], v96
    s_waitcnt lgkmcnt(5)
    v_mfma_f32_32x32x16_bf16 v[60:75], v[220:223], v[20:23], v[60:75]
    ds_read_b128 v[228:231], v13 offset:32768
    ds_read_b64_tr_b16 v[36:37], v16 offset:20480
    v_mfma_f32_32x32x16_bf16 v[76:91], v[220:223], v[24:27], v[76:91]
    ds_read_b64_tr_b16 v[38:39], v16 offset:20992
    ds_read_b64_tr_b16 v[40:41], v17 offset:20480
    ds_read_b64_tr_b16 v[42:43], v17 offset:20992
    v_smfmac_f32_16x16x64_bf16 v[236:239], v[92:95], v[20:27], v96
    s_waitcnt lgkmcnt(5)
    v_mfma_f32_32x32x16_bf16 v[60:75], v[224:227], v[28:31], v[60:75]
    ds_read_b128 v[232:235], v14 offset:32768
    ds_read_b64_tr_b16 v[20:21], v16 offset:22528
    v_mfma_f32_32x32x16_bf16 v[76:91], v[224:227], v[32:35], v[76:91]
    ds_read_b64_tr_b16 v[22:23], v16 offset:23040
    ds_read_b64_tr_b16 v[24:25], v17 offset:22528
    ds_read_b64_tr_b16 v[26:27], v17 offset:23040
    v_smfmac_f32_16x16x64_bf16 v[236:239], v[92:95], v[28:35], v96
    s_waitcnt lgkmcnt(5)
    v_mfma_f32_32x32x16_bf16 v[60:75], v[228:231], v[36:39], v[60:75]
    s_waitcnt lgkmcnt(0)
    s_barrier
    ds_read_b128 v[44:47], v2 offset:49152
    ds_read_b64_tr_b16 v[28:29], v16 offset:24576
    v_mfma_f32_32x32x16_bf16 v[76:91], v[228:231], v[40:43], v[76:91]
    ds_read_b64_tr_b16 v[30:31], v16 offset:25088
    ds_read_b64_tr_b16 v[32:33], v17 offset:24576
    ds_read_b64_tr_b16 v[34:35], v17 offset:25088
    v_smfmac_f32_16x16x64_bf16 v[236:239], v[92:95], v[36:43], v96
    v_mfma_f32_32x32x16_bf16 v[60:75], v[232:235], v[20:23], v[60:75]
    ds_read_b128 v[48:51], v3 offset:49152
    ds_read_b64_tr_b16 v[36:37], v16 offset:26624
    v_mfma_f32_32x32x16_bf16 v[76:91], v[232:235], v[24:27], v[76:91]
    ds_read_b64_tr_b16 v[38:39], v16 offset:27136
    ds_read_b64_tr_b16 v[40:41], v17 offset:26624
    ds_read_b64_tr_b16 v[42:43], v17 offset:27136
    v_smfmac_f32_16x16x64_bf16 v[236:239], v[92:95], v[20:27], v96
    s_waitcnt lgkmcnt(5)
    v_mfma_f32_32x32x16_bf16 v[60:75], v[44:47], v[28:31], v[60:75]
    ds_read_b128 v[52:55], v13 offset:49152
    ds_read_b64_tr_b16 v[20:21], v16 offset:28672
    v_mfma_f32_32x32x16_bf16 v[76:91], v[44:47], v[32:35], v[76:91]
    ds_read_b64_tr_b16 v[22:23], v16 offset:29184
    ds_read_b64_tr_b16 v[24:25], v17 offset:28672
    ds_read_b64_tr_b16 v[26:27], v17 offset:29184
    v_smfmac_f32_16x16x64_bf16 v[236:239], v[92:95], v[28:35], v96
    s_waitcnt lgkmcnt(5)
    v_mfma_f32_32x32x16_bf16 v[60:75], v[48:51], v[36:39], v[60:75]
    ds_read_b128 v[56:59], v14 offset:49152
    ds_read_b64_tr_b16 v[28:29], v16 offset:30720
    v_mfma_f32_32x32x16_bf16 v[76:91], v[48:51], v[40:43], v[76:91]
    ds_read_b64_tr_b16 v[30:31], v16 offset:31232
    ds_read_b64_tr_b16 v[32:33], v17 offset:30720
    ds_read_b64_tr_b16 v[34:35], v17 offset:31232
    v_smfmac_f32_16x16x64_bf16 v[236:239], v[92:95], v[36:43], v96
    s_waitcnt lgkmcnt(5)
    v_mfma_f32_32x32x16_bf16 v[60:75], v[52:55], v[20:23], v[60:75]
    s_waitcnt lgkmcnt(0)
    s_barrier
    ds_read_b128 v[44:47], v2 offset:0
    ds_read_b64_tr_b16 v[36:37], v16 offset:0
    v_mfma_f32_32x32x16_bf16 v[76:91], v[52:55], v[24:27], v[76:91]
    ds_read_b64_tr_b16 v[38:39], v16 offset:512
    ds_read_b64_tr_b16 v[40:41], v17 offset:0
    ds_read_b64_tr_b16 v[42:43], v17 offset:512
    v_smfmac_f32_16x16x64_bf16 v[236:239], v[92:95], v[20:27], v96
    v_mfma_f32_32x32x16_bf16 v[60:75], v[56:59], v[28:31], v[60:75]
    ds_read_b128 v[48:51], v3 offset:0
    ds_read_b64_tr_b16 v[20:21], v16 offset:2048
    v_mfma_f32_32x32x16_bf16 v[76:91], v[56:59], v[32:35], v[76:91]
    ds_read_b64_tr_b16 v[22:23], v16 offset:2560
    ds_read_b64_tr_b16 v[24:25], v17 offset:2048
    ds_read_b64_tr_b16 v[26:27], v17 offset:2560
    v_smfmac_f32_16x16x64_bf16 v[236:239], v[92:95], v[28:35], v96
    s_waitcnt lgkmcnt(5)
    v_mfma_f32_32x32x16_bf16 v[60:75], v[44:47], v[36:39], v[60:75]
    ds_read_b128 v[52:55], v13 offset:0
    ds_read_b64_tr_b16 v[28:29], v16 offset:4096
    v_mfma_f32_32x32x16_bf16 v[76:91], v[44:47], v[40:43], v[76:91]
    ds_read_b64_tr_b16 v[30:31], v16 offset:4608
    ds_read_b64_tr_b16 v[32:33], v17 offset:4096
    ds_read_b64_tr_b16 v[34:35], v17 offset:4608
    v_smfmac_f32_16x16x64_bf16 v[236:239], v[92:95], v[36:43], v96
    s_waitcnt lgkmcnt(5)
    v_mfma_f32_32x32x16_bf16 v[60:75], v[48:51], v[20:23], v[60:75]
    ds_read_b128 v[56:59], v14 offset:0
    ds_read_b64_tr_b16 v[36:37], v16 offset:6144
    v_mfma_f32_32x32x16_bf16 v[76:91], v[48:51], v[24:27], v[76:91]
    ds_read_b64_tr_b16 v[38:39], v16 offset:6656
    ds_read_b64_tr_b16 v[40:41], v17 offset:6144
    ds_read_b64_tr_b16 v[42:43], v17 offset:6656
    v_smfmac_f32_16x16x64_bf16 v[236:239], v[92:95], v[20:27], v96
    s_waitcnt lgkmcnt(5)
    v_mfma_f32_32x32x16_bf16 v[60:75], v[52:55], v[28:31], v[60:75]
    s_waitcnt lgkmcnt(0)
    s_barrier
    ds_read_b128 v[44:47], v2 offset:16384
    ds_read_b64_tr_b16 v[20:21], v16 offset:8192
    v_mfma_f32_32x32x16_bf16 v[76:91], v[52:55], v[32:35], v[76:91]
    ds_read_b64_tr_b16 v[22:23], v16 offset:8704
    ds_read_b64_tr_b16 v[24:25], v17 offset:8192
    ds_read_b64_tr_b16 v[26:27], v17 offset:8704
    v_smfmac_f32_16x16x64_bf16 v[236:239], v[92:95], v[28:35], v96
    v_mfma_f32_32x32x16_bf16 v[60:75], v[56:59], v[36:39], v[60:75]
    ds_read_b128 v[48:51], v3 offset:16384
    ds_read_b64_tr_b16 v[28:29], v16 offset:10240
    v_mfma_f32_32x32x16_bf16 v[76:91], v[56:59], v[40:43], v[76:91]
    ds_read_b64_tr_b16 v[30:31], v16 offset:10752
    ds_read_b64_tr_b16 v[32:33], v17 offset:10240
    ds_read_b64_tr_b16 v[34:35], v17 offset:10752
    v_smfmac_f32_16x16x64_bf16 v[236:239], v[92:95], v[36:43], v96
    s_waitcnt lgkmcnt(5)
    v_mfma_f32_32x32x16_bf16 v[60:75], v[44:47], v[20:23], v[60:75]
    ds_read_b128 v[52:55], v13 offset:16384
    ds_read_b64_tr_b16 v[36:37], v16 offset:12288
    v_mfma_f32_32x32x16_bf16 v[76:91], v[44:47], v[24:27], v[76:91]
    ds_read_b64_tr_b16 v[38:39], v16 offset:12800
    ds_read_b64_tr_b16 v[40:41], v17 offset:12288
    ds_read_b64_tr_b16 v[42:43], v17 offset:12800
    v_smfmac_f32_16x16x64_bf16 v[236:239], v[92:95], v[20:27], v96
    buffer_load_dwordx2 v[6:7], v15, s[16:19], s82 offen sc1
    s_waitcnt lgkmcnt(5)
    v_mfma_f32_32x32x16_bf16 v[60:75], v[48:51], v[28:31], v[60:75]
    ds_read_b128 v[56:59], v14 offset:16384
    ds_read_b64_tr_b16 v[20:21], v16 offset:14336
    v_mfma_f32_32x32x16_bf16 v[76:91], v[48:51], v[32:35], v[76:91]
    ds_read_b64_tr_b16 v[22:23], v16 offset:14848
    ds_read_b64_tr_b16 v[24:25], v17 offset:14336
    ds_read_b64_tr_b16 v[26:27], v17 offset:14848
    v_smfmac_f32_16x16x64_bf16 v[236:239], v[92:95], v[28:35], v96
    s_waitcnt lgkmcnt(5)
    v_mfma_f32_32x32x16_bf16 v[60:75], v[52:55], v[36:39], v[60:75]
    s_waitcnt lgkmcnt(0)
    s_barrier
    ds_read_b64_tr_b16 v[28:29], v18 offset:0
    ds_read_b64_tr_b16 v[30:31], v18 offset:512
    v_mfma_f32_32x32x16_bf16 v[76:91], v[52:55], v[40:43], v[76:91]
    ds_read_b64_tr_b16 v[32:33], v19 offset:0
    ds_read_b64_tr_b16 v[34:35], v19 offset:512
    v_smfmac_f32_16x16x64_bf16 v[236:239], v[92:95], v[36:43], v96
    v_mfma_f32_32x32x16_bf16 v[60:75], v[56:59], v[20:23], v[60:75]
    ds_read_b64_tr_b16 v[36:37], v18 offset:2048
    ds_read_b64_tr_b16 v[38:39], v18 offset:2560
    v_mfma_f32_32x32x16_bf16 v[76:91], v[56:59], v[24:27], v[76:91]
    ds_read_b64_tr_b16 v[40:41], v19 offset:2048
    ds_read_b64_tr_b16 v[42:43], v19 offset:2560
    v_smfmac_f32_16x16x64_bf16 v[236:239], v[92:95], v[20:27], v96
    s_cmp_ge_u32 s96, 20
    s_cbranch_scc1 L_p1vv
    s_waitcnt lgkmcnt(4)
    v_mfma_f32_32x32x16_bf16 v[92:107], v[28:31], v[124:127], 0
    ds_read_b64_tr_b16 v[20:21], v18 offset:4096
    ds_read_b64_tr_b16 v[22:23], v18 offset:4608
    v_mfma_f32_32x32x16_bf16 v[108:123], v[32:35], v[124:127], 0
    ds_read_b64_tr_b16 v[24:25], v19 offset:4096
    ds_read_b64_tr_b16 v[26:27], v19 offset:4608
    s_waitcnt lgkmcnt(4)
    v_mfma_f32_32x32x16_bf16 v[92:107], v[36:39], v[128:131], v[92:107]
    ds_read_b64_tr_b16 v[28:29], v18 offset:6144
    ds_read_b64_tr_b16 v[30:31], v18 offset:6656
    v_add_f32 v8, v236, v237
    v_cvt_pk_bf16_f32 v237, v8, 0
    v_lshlrev_b32 v9, 16, v237
    v_mfma_f32_32x32x16_bf16 v[108:123], v[40:43], v[128:131], v[108:123]
    ds_read_b64_tr_b16 v[32:33], v19 offset:6144
    ds_read_b64_tr_b16 v[34:35], v19 offset:6656
    v_sub_f32 v9, v8, v9
    v_cvt_pk_bf16_f32 v236, v8, v9
    s_waitcnt lgkmcnt(4)
    v_mfma_f32_32x32x16_bf16 v[92:107], v[20:23], v[132:135], v[92:107]
    s_barrier
    ds_read_b64_tr_b16 v[36:37], v18 offset:8192
    ds_read_b64_tr_b16 v[38:39], v18 offset:8704
    v_mfma_f32_32x32x16_bf16 v[108:123], v[24:27], v[132:135], v[108:123]
    ds_read_b64_tr_b16 v[40:41], v19 offset:8192
    ds_read_b64_tr_b16 v[42:43], v19 offset:8704
L_xc26:
    s_waitcnt vmcnt(0)
    v_min_u32 v4, v6, v7
    v_cmp_eq_u32 vcc, 0, v4
    v_cvt_pk_bf16_f32 v240, v6, v6
    s_cbranch_vccnz L_xr26
L_xo26:
    v_and_b32 v5, 0xffff0000, v240
    v_mov_b32 v238, v7
    s_waitcnt lgkmcnt(4)
    v_mfma_f32_32x32x16_bf16 v[92:107], v[28:31], v[136:139], v[92:107]
    ds_read_b64_tr_b16 v[20:21], v18 offset:10240
    ds_read_b64_tr_b16 v[22:23], v18 offset:10752
    v_sub_f32 v5, v6, v5
    v_cndmask_b32 v244, v240, 0, s[72:73]
    v_cvt_pk_bf16_f32 v241, v5, 0
    v_mfma_f32_32x32x16_bf16 v[108:123], v[32:35], v[136:139], v[108:123]
    ds_read_b64_tr_b16 v[24:25], v19 offset:10240
    ds_read_b64_tr_b16 v[26:27], v19 offset:10752
    v_cndmask_b32 v246, 0, v240, s[72:73]
    v_cndmask_b32 v245, v241, 0, s[72:73]
    v_cndmask_b32 v247, 0, v241, s[72:73]
    s_lshl_b32 s34, s28, 7
    s_add_u32 s34, s34, 33792
    s_waitcnt lgkmcnt(4)
    v_mfma_f32_32x32x16_bf16 v[92:107], v[36:39], v[140:143], v[92:107]
    ds_read_b64_tr_b16 v[28:29], v18 offset:12288
    ds_read_b64_tr_b16 v[30:31], v18 offset:12800
    v_lshl_add_u32 v4, v11, 2, s34
    v_lshl_add_u32 v5, v12, 4, s34
    ds_write_b32 v4, v238
    v_mfma_f32_32x32x16_bf16 v[108:123], v[40:43], v[140:143], v[108:123]
    ds_read_b64_tr_b16 v[32:33], v19 offset:12288
    ds_read_b64_tr_b16 v[34:35], v19 offset:12800
    ds_read_b128 v[124:127], v5 offset:0
    ds_read_b128 v[128:131], v5 offset:32
    ds_read_b128 v[132:135], v5 offset:64
    ds_read_b128 v[136:139], v5 offset:96
    s_waitcnt lgkmcnt(9)
    v_mfma_f32_32x32x16_bf16 v[92:107], v[20:23], v[144:147], v[92:107]
    ds_read_b64_tr_b16 v[36:37], v18 offset:14336
    ds_read_b64_tr_b16 v[38:39], v18 offset:14848
    v_mfma_f32_32x32x8_bf16 v[60:75], v[244:245], v[236:237], v[60:75]
    v_mfma_f32_32x32x8_bf16 v[76:91], v[246:247], v[236:237], v[76:91]
    v_mfma_f32_32x32x16_bf16 v[108:123], v[24:27], v[144:147], v[108:123]
    ds_read_b64_tr_b16 v[40:41], v19 offset:14336
    ds_read_b64_tr_b16 v[42:43], v19 offset:14848
    s_waitcnt lgkmcnt(8)
    v_mfma_f32_32x32x16_bf16 v[92:107], v[28:31], v[148:151], v[92:107]
    ds_read_b128 v[44:47], v2 offset:49152
    ds_read_b64_tr_b16 v[20:21], v18 offset:16384
    v_mfma_f32_32x32x16_bf16 v[108:123], v[32:35], v[148:151], v[108:123]
    ds_read_b64_tr_b16 v[22:23], v18 offset:16896
    ds_read_b64_tr_b16 v[24:25], v19 offset:16384
    ds_read_b64_tr_b16 v[26:27], v19 offset:16896
    s_waitcnt lgkmcnt(9)
    s_waitcnt lgkmcnt(5)
    v_mfma_f32_32x32x16_bf16 v[92:107], v[36:39], v[152:155], v[92:107]
    ds_read_b128 v[48:51], v3 offset:49152
    ds_read_b64_tr_b16 v[28:29], v18 offset:18432
    v_mul_f32 v60, v60, v124
    v_mul_f32 v61, v61, v125
    v_mul_f32 v62, v62, v126
    v_mfma_f32_32x32x16_bf16 v[108:123], v[40:43], v[152:155], v[108:123]
    ds_read_b64_tr_b16 v[30:31], v18 offset:18944
    ds_read_b64_tr_b16 v[32:33], v19 offset:18432
    ds_read_b64_tr_b16 v[34:35], v19 offset:18944
    v_mul_f32 v63, v63, v127
    v_mul_f32 v64, v64, v128
    v_mul_f32 v65, v65, v129
    v_mul_f32 v66, v66, v130
    s_waitcnt lgkmcnt(5)
    v_mfma_f32_32x32x16_bf16 v[92:107], v[20:23], v[44:47], v[92:107]
    ds_read_b128 v[52:55], v13 offset:49152
    ds_read_b64_tr_b16 v[36:37], v18 offset:20480
    v_mul_f32 v67, v67, v131
    v_cvt_pk_bf16_f32 v60, v60, v61
    v_cvt_pk_bf16_f32 v61, v62, v63
    v_mfma_f32_32x32x16_bf16 v[108:123], v[24:27], v[44:47], v[108:123]
    ds_read_b64_tr_b16 v[38:39], v18 offset:20992
    ds_read_b64_tr_b16 v[40:41], v19 offset:20480
    ds_read_b64_tr_b16 v[42:43], v19 offset:20992
    v_cvt_pk_bf16_f32 v62, v64, v65
    v_cvt_pk_bf16_f32 v63, v66, v67
    buffer_store_dwordx4 v[60:63], v248, s[16:19], s78 offen offset:0 sc1
    v_mul_f32 v68, v68, v132
    s_waitcnt lgkmcnt(5)
    v_mfma_f32_32x32x16_bf16 v[92:107], v[28:31], v[48:51], v[92:107]
    ds_read_b128 v[56:59], v14 offset:49152
    ds_read_b64_tr_b16 v[20:21], v18 offset:22528
    v_mul_f32 v69, v69, v133
    v_mul_f32 v70, v70, v134
    v_mul_f32 v71, v71, v135
    v_mfma_f32_32x32x16_bf16 v[108:123], v[32:35], v[48:51], v[108:123]
    ds_read_b64_tr_b16 v[22:23], v18 offset:23040
    ds_read_b64_tr_b16 v[24:25], v19 offset:22528
    ds_read_b64_tr_b16 v[26:27], v19 offset:23040
    v_mul_f32 v72, v72, v136
    v_mul_f32 v73, v73, v137
    v_mul_f32 v74, v74, v138
    v_mul_f32 v75, v75, v139
    s_waitcnt lgkmcnt(5)
    v_mfma_f32_32x32x16_bf16 v[92:107], v[36:39], v[52:55], v[92:107]
    s_barrier
    ds_read_b128 v[44:47], v2 offset:0
    ds_read_b64_tr_b16 v[28:29], v18 offset:24576
    v_cvt_pk_bf16_f32 v68, v68, v69
    v_cvt_pk_bf16_f32 v69, v70, v71
    v_cvt_pk_bf16_f32 v70, v72, v73
    v_mfma_f32_32x32x16_bf16 v[108:123], v[40:43], v[52:55], v[108:123]
    ds_read_b64_tr_b16 v[30:31], v18 offset:25088
    ds_read_b64_tr_b16 v[32:33], v19 offset:24576
    ds_read_b64_tr_b16 v[34:35], v19 offset:25088
    v_cvt_pk_bf16_f32 v71, v74, v75
    buffer_store_dwordx4 v[68:71], v248, s[16:19], s78 offen offset:640 sc1
    v_mul_f32 v76, v76, v124
    v_mul_f32 v77, v77, v125
    s_waitcnt lgkmcnt(5)
    v_mfma_f32_32x32x16_bf16 v[92:107], v[20:23], v[56:59], v[92:107]
    ds_read_b128 v[48:51], v3 offset:0
    ds_read_b64_tr_b16 v[36:37], v18 offset:26624
    v_mul_f32 v78, v78, v126
    v_mul_f32 v79, v79, v127
    v_mul_f32 v80, v80, v128
    v_mfma_f32_32x32x16_bf16 v[108:123], v[24:27], v[56:59], v[108:123]
    ds_read_b64_tr_b16 v[38:39], v18 offset:27136
    ds_read_b64_tr_b16 v[40:41], v19 offset:26624
    ds_read_b64_tr_b16 v[42:43], v19 offset:27136
    v_mul_f32 v81, v81, v129
    v_mul_f32 v82, v82, v130
    v_mul_f32 v83, v83, v131
    v_cvt_pk_bf16_f32 v76, v76, v77
    s_waitcnt lgkmcnt(5)
    v_mfma_f32_32x32x16_bf16 v[92:107], v[28:31], v[44:47], v[92:107]
    ds_read_b128 v[52:55], v13 offset:0
    ds_read_b64_tr_b16 v[20:21], v18 offset:28672
    v_cvt_pk_bf16_f32 v77, v78, v79
    v_cvt_pk_bf16_f32 v78, v80, v81
    v_cvt_pk_bf16_f32 v79, v82, v83
    v_mfma_f32_32x32x16_bf16 v[108:123], v[32:35], v[44:47], v[108:123]
    ds_read_b64_tr_b16 v[22:23], v18 offset:29184
    ds_read_b64_tr_b16 v[24:25], v19 offset:28672
    ds_read_b64_tr_b16 v[26:27], v19 offset:29184
    buffer_store_dwordx4 v[76:79], v249, s[16:19], s78 offen offset:0 sc1
    v_mul_f32 v84, v84, v132
    v_mul_f32 v85, v85, v133
    v_mul_f32 v86, v86, v134
    s_waitcnt lgkmcnt(5)
    v_mfma_f32_32x32x16_bf16 v[92:107], v[36:39], v[48:51], v[92:107]
    ds_read_b128 v[56:59], v14 offset:0
    ds_read_b64_tr_b16 v[28:29], v18 offset:30720
    v_mul_f32 v87, v87, v135
    v_mul_f32 v88, v88, v136
    v_mul_f32 v89, v89, v137
    v_mfma_f32_32x32x16_bf16 v[108:123], v[40:43], v[48:51], v[108:123]
    ds_read_b64_tr_b16 v[30:31], v18 offset:31232
    ds_read_b64_tr_b16 v[32:33], v19 offset:30720
    ds_read_b64_tr_b16 v[34:35], v19 offset:31232
    v_mul_f32 v90, v90, v138
    v_mul_f32 v91, v91, v139
    v_cvt_pk_bf16_f32 v84, v84, v85
    v_cvt_pk_bf16_f32 v85, v86, v87
    s_waitcnt lgkmcnt(5)
    v_mfma_f32_32x32x16_bf16 v[92:107], v[20:23], v[52:55], v[92:107]
    ds_read_b128 v[44:47], v2 offset:16384
    ds_read_b64_tr_b16 v[36:37], v18 offset:32768
    v_cvt_pk_bf16_f32 v86, v88, v89
    v_cvt_pk_bf16_f32 v87, v90, v91
    buffer_store_dwordx4 v[84:87], v249, s[16:19], s78 offen offset:640 sc1
    v_mfma_f32_32x32x16_bf16 v[108:123], v[24:27], v[52:55], v[108:123]
    ds_read_b64_tr_b16 v[38:39], v18 offset:33280
    ds_read_b64_tr_b16 v[40:41], v19 offset:32768
    ds_read_b64_tr_b16 v[42:43], v19 offset:33280
    v_mul_f32 v238, s91, v238
    v_lshlrev_b32 v4, 3, v10
    v_mov_b32 v239, v238
    v_add_u32 v4, 32768, v4
    s_waitcnt lgkmcnt(5)
    v_mfma_f32_32x32x16_bf16 v[92:107], v[28:31], v[56:59], v[92:107]
    ds_read_b128 v[48:51], v3 offset:16384
    ds_read_b64_tr_b16 v[20:21], v18 offset:34816
    v_mov_b32 v5, 34304
    v_mov_b32 v7, 1
    v_mfma_f32_32x32x16_bf16 v[108:123], v[32:35], v[56:59], v[108:123]
    ds_read_b64_tr_b16 v[22:23], v18 offset:35328
    ds_read_b64_tr_b16 v[24:25], v19 offset:34816
    ds_read_b64_tr_b16 v[26:27], v19 offset:35328
    s_waitcnt lgkmcnt(5)
    v_mfma_f32_32x32x16_bf16 v[92:107], v[36:39], v[44:47], v[92:107]
    ds_read_b128 v[52:55], v13 offset:16384
    ds_read_b64_tr_b16 v[28:29], v18 offset:36864
    v_mfma_f32_32x32x16_bf16 v[108:123], v[40:43], v[44:47], v[108:123]
    ds_read_b64_tr_b16 v[30:31], v18 offset:37376
    ds_read_b64_tr_b16 v[32:33], v19 offset:36864
    ds_read_b64_tr_b16 v[34:35], v19 offset:37376
    s_waitcnt lgkmcnt(5)
    v_mfma_f32_32x32x16_bf16 v[92:107], v[20:23], v[48:51], v[92:107]
    ds_read_b128 v[56:59], v14 offset:16384
    ds_read_b64_tr_b16 v[36:37], v18 offset:38912
    v_mfma_f32_32x32x16_bf16 v[108:123], v[24:27], v[48:51], v[108:123]
    ds_read_b64_tr_b16 v[38:39], v18 offset:39424
    ds_read_b64_tr_b16 v[40:41], v19 offset:38912
    ds_read_b64_tr_b16 v[42:43], v19 offset:39424
    s_waitcnt lgkmcnt(5)
    v_mfma_f32_32x32x16_bf16 v[92:107], v[28:31], v[52:55], v[92:107]
    s_waitcnt lgkmcnt(0)
    s_barrier
    ds_read_b64_tr_b16 v[20:21], v18 offset:40960
    ds_read_b64_tr_b16 v[22:23], v18 offset:41472
    v_mfma_f32_32x32x16_bf16 v[108:123], v[32:35], v[52:55], v[108:123]
    ds_read_b64_tr_b16 v[24:25], v19 offset:40960
    ds_read_b64_tr_b16 v[26:27], v19 offset:41472
    v_mfma_f32_32x32x16_bf16 v[92:107], v[36:39], v[56:59], v[92:107]
    ds_read_b64_tr_b16 v[28:29], v18 offset:43008
    ds_read_b64_tr_b16 v[30:31], v18 offset:43520
    v_mfma_f32_32x32x16_bf16 v[108:123], v[40:43], v[56:59], v[108:123]
    ds_read_b64_tr_b16 v[32:33], v19 offset:43008
    ds_read_b64_tr_b16 v[34:35], v19 offset:43520
    s_waitcnt lgkmcnt(4)
    v_mfma_f32_32x32x16_bf16 v[92:107], v[20:23], v[156:159], v[92:107]
    ds_read_b64_tr_b16 v[36:37], v18 offset:45056
    ds_read_b64_tr_b16 v[38:39], v18 offset:45568
    v_mfma_f32_32x32x16_bf16 v[108:123], v[24:27], v[156:159], v[108:123]
    ds_read_b64_tr_b16 v[40:41], v19 offset:45056
    ds_read_b64_tr_b16 v[42:43], v19 offset:45568
    s_waitcnt lgkmcnt(4)
    v_mfma_f32_32x32x16_bf16 v[92:107], v[28:31], v[160:163], v[92:107]
    ds_read_b64_tr_b16 v[20:21], v18 offset:47104
    ds_read_b64_tr_b16 v[22:23], v18 offset:47616
    v_mfma_f32_32x32x16_bf16 v[108:123], v[32:35], v[160:163], v[108:123]
    ds_read_b64_tr_b16 v[24:25], v19 offset:47104
    ds_read_b64_tr_b16 v[26:27], v19 offset:47616
    s_waitcnt lgkmcnt(4)
    v_mfma_f32_32x32x16_bf16 v[92:107], v[36:39], v[164:167], v[92:107]
    ds_read_b64_tr_b16 v[28:29], v18 offset:49152
    ds_read_b64_tr_b16 v[30:31], v18 offset:49664
    v_mfma_f32_32x32x16_bf16 v[108:123], v[40:43], v[164:167], v[108:123]
    ds_read_b64_tr_b16 v[32:33], v19 offset:49152
    ds_read_b64_tr_b16 v[34:35], v19 offset:49664
    s_waitcnt lgkmcnt(4)
    v_mfma_f32_32x32x16_bf16 v[92:107], v[20:23], v[168:171], v[92:107]
    ds_read_b64_tr_b16 v[36:37], v18 offset:51200
    ds_read_b64_tr_b16 v[38:39], v18 offset:51712
    v_mfma_f32_32x32x16_bf16 v[108:123], v[24:27], v[168:171], v[108:123]
    ds_read_b64_tr_b16 v[40:41], v19 offset:51200
    ds_read_b64_tr_b16 v[42:43], v19 offset:51712
    s_waitcnt lgkmcnt(4)
    v_mfma_f32_32x32x16_bf16 v[92:107], v[28:31], v[172:175], v[92:107]
    ds_read_b64_tr_b16 v[20:21], v18 offset:53248
    ds_read_b64_tr_b16 v[22:23], v18 offset:53760
    v_mfma_f32_32x32x16_bf16 v[108:123], v[32:35], v[172:175], v[108:123]
    ds_read_b64_tr_b16 v[24:25], v19 offset:53248
    ds_read_b64_tr_b16 v[26:27], v19 offset:53760
    s_waitcnt vmcnt(0)
    buffer_store_dword v7, off, s[16:19], s98 sc1
    s_waitcnt lgkmcnt(4)
    v_mfma_f32_32x32x16_bf16 v[92:107], v[36:39], v[176:179], v[92:107]
    ds_read_b64_tr_b16 v[28:29], v18 offset:55296
    ds_read_b64_tr_b16 v[30:31], v18 offset:55808
    v_mfma_f32_32x32x16_bf16 v[108:123], v[40:43], v[176:179], v[108:123]
    ds_read_b64_tr_b16 v[32:33], v19 offset:55296
    ds_read_b64_tr_b16 v[34:35], v19 offset:55808
    s_waitcnt lgkmcnt(4)
    v_mfma_f32_32x32x16_bf16 v[92:107], v[20:23], v[180:183], v[92:107]
    s_barrier
    ds_read_b64_tr_b16 v[36:37], v18 offset:57344
    ds_read_b64_tr_b16 v[38:39], v18 offset:57856
    v_mfma_f32_32x32x16_bf16 v[108:123], v[24:27], v[180:183], v[108:123]
    ds_read_b64_tr_b16 v[40:41], v19 offset:57344
    ds_read_b64_tr_b16 v[42:43], v19 offset:57856
    s_waitcnt lgkmcnt(4)
    v_mfma_f32_32x32x16_bf16 v[92:107], v[28:31], v[184:187], v[92:107]
    ds_read_b64_tr_b16 v[20:21], v18 offset:59392
    ds_read_b64_tr_b16 v[22:23], v18 offset:59904
    v_mfma_f32_32x32x16_bf16 v[108:123], v[32:35], v[184:187], v[108:123]
    ds_read_b64_tr_b16 v[24:25], v19 offset:59392
    ds_read_b64_tr_b16 v[26:27], v19 offset:59904
    s_waitcnt lgkmcnt(4)
    v_mfma_f32_32x32x16_bf16 v[92:107], v[36:39], v[188:191], v[92:107]
    ds_read_b64_tr_b16 v[28:29], v18 offset:61440
    ds_read_b64_tr_b16 v[30:31], v18 offset:61952
    v_mfma_f32_32x32x16_bf16 v[108:123], v[40:43], v[188:191], v[108:123]
    ds_read_b64_tr_b16 v[32:33], v19 offset:61440
    ds_read_b64_tr_b16 v[34:35], v19 offset:61952
    s_waitcnt lgkmcnt(4)
    v_mfma_f32_32x32x16_bf16 v[92:107], v[20:23], v[192:195], v[92:107]
    ds_read_b64_tr_b16 v[36:37], v18 offset:63488
    ds_read_b64_tr_b16 v[38:39], v18 offset:64000
    v_mfma_f32_32x32x16_bf16 v[108:123], v[24:27], v[192:195], v[108:123]
    ds_read_b64_tr_b16 v[40:41], v19 offset:63488
    ds_read_b64_tr_b16 v[42:43], v19 offset:64000
    s_waitcnt lgkmcnt(4)
    v_subrev_u32 v18, 16384, v18
    v_subrev_u32 v19, 16384, v19
    v_mfma_f32_32x32x16_bf16 v[92:107], v[28:31], v[196:199], v[92:107]
    s_barrier
    ds_read_b64_tr_b16 v[20:21], v18 offset:0
    ds_read_b64_tr_b16 v[22:23], v18 offset:512
    v_mfma_f32_32x32x16_bf16 v[108:123], v[32:35], v[196:199], v[108:123]
    ds_read_b64_tr_b16 v[24:25], v19 offset:0
    ds_read_b64_tr_b16 v[26:27], v19 offset:512
    ds_read_b64 v[140:141], v4 offset:0
    ds_read_b64 v[142:143], v4 offset:512
    ds_read_b32 v6, v5
    s_waitcnt lgkmcnt(7)
    v_mfma_f32_32x32x16_bf16 v[92:107], v[36:39], v[200:203], v[92:107]
    ds_read_b64_tr_b16 v[28:29], v18 offset:2048
    ds_read_b64_tr_b16 v[30:31], v18 offset:2560
    v_mfma_f32_32x32x16_bf16 v[108:123], v[40:43], v[200:203], v[108:123]
    ds_read_b64_tr_b16 v[32:33], v19 offset:2048
    ds_read_b64_tr_b16 v[34:35], v19 offset:2560
    s_waitcnt lgkmcnt(7)
    v_mfma_f32_32x32x16_bf16 v[92:107], v[20:23], v[204:207], v[92:107]
    ds_read_b64_tr_b16 v[36:37], v18 offset:4096
    ds_read_b64_tr_b16 v[38:39], v18 offset:4608
    v_mfma_f32_32x32x16_bf16 v[108:123], v[24:27], v[204:207], v[108:123]
    ds_read_b64_tr_b16 v[40:41], v19 offset:4096
    ds_read_b64_tr_b16 v[42:43], v19 offset:4608
    s_waitcnt lgkmcnt(4)
    v_mfma_f32_32x32x16_bf16 v[92:107], v[28:31], v[208:211], v[92:107]
    ds_read_b64_tr_b16 v[20:21], v18 offset:6144
    ds_read_b64_tr_b16 v[22:23], v18 offset:6656
    v_mfma_f32_32x32x16_bf16 v[108:123], v[32:35], v[208:211], v[108:123]
    ds_read_b64_tr_b16 v[24:25], v19 offset:6144
    ds_read_b64_tr_b16 v[26:27], v19 offset:6656
    s_waitcnt lgkmcnt(4)
    v_mfma_f32_32x32x16_bf16 v[92:107], v[36:39], v[212:215], v[92:107]
    ds_read_b64_tr_b16 v[28:29], v18 offset:8192
    ds_read_b64_tr_b16 v[30:31], v18 offset:8704
    v_mfma_f32_32x32x16_bf16 v[108:123], v[40:43], v[212:215], v[108:123]
    ds_read_b64_tr_b16 v[32:33], v19 offset:8192
    ds_read_b64_tr_b16 v[34:35], v19 offset:8704
    s_waitcnt lgkmcnt(4)
    v_mfma_f32_32x32x16_bf16 v[92:107], v[20:23], v[216:219], v[92:107]
    ds_read_b64_tr_b16 v[36:37], v18 offset:10240
    ds_read_b64_tr_b16 v[38:39], v18 offset:10752
    v_mfma_f32_32x32x16_bf16 v[108:123], v[24:27], v[216:219], v[108:123]
    ds_read_b64_tr_b16 v[40:41], v19 offset:10240
    ds_read_b64_tr_b16 v[42:43], v19 offset:10752
    s_waitcnt lgkmcnt(4)
    v_mfma_f32_32x32x16_bf16 v[92:107], v[28:31], v[220:223], v[92:107]
    ds_read_b64_tr_b16 v[20:21], v18 offset:12288
    ds_read_b64_tr_b16 v[22:23], v18 offset:12800
    v_mfma_f32_32x32x16_bf16 v[108:123], v[32:35], v[220:223], v[108:123]
    ds_read_b64_tr_b16 v[24:25], v19 offset:12288
    ds_read_b64_tr_b16 v[26:27], v19 offset:12800
    s_waitcnt lgkmcnt(4)
    v_mfma_f32_32x32x16_bf16 v[92:107], v[36:39], v[224:227], v[92:107]
    ds_read_b64_tr_b16 v[28:29], v18 offset:14336
    ds_read_b64_tr_b16 v[30:31], v18 offset:14848
    v_mfma_f32_32x32x16_bf16 v[108:123], v[40:43], v[224:227], v[108:123]
    ds_read_b64_tr_b16 v[32:33], v19 offset:14336
    ds_read_b64_tr_b16 v[34:35], v19 offset:14848
    s_waitcnt lgkmcnt(4)
    v_mfma_f32_32x32x16_bf16 v[92:107], v[20:23], v[228:231], v[92:107]
    v_mfma_f32_32x32x16_bf16 v[108:123], v[24:27], v[228:231], v[108:123]
    v_readfirstlane_b32 s31, v6
    s_waitcnt lgkmcnt(0)
    v_mfma_f32_32x32x16_bf16 v[92:107], v[28:31], v[232:235], v[92:107]
    v_mfma_f32_32x32x16_bf16 v[108:123], v[32:35], v[232:235], v[108:123]
    v_mfma_f32_32x32x8_bf16 v[92:107], v[140:141], v[240:241], v[92:107]
    v_mfma_f32_32x32x8_bf16 v[108:123], v[142:143], v[240:241], v[108:123]
    s_cmp_lt_u32 s96, 10
    s_cselect_b32 s97, s31, 1
    s_nop 8
    v_pk_mul_f32 v[92:93], v[92:93], v[238:239]
    v_pk_mul_f32 v[94:95], v[94:95], v[238:239]
    v_pk_mul_f32 v[96:97], v[96:97], v[238:239]
    v_pk_mul_f32 v[98:99], v[98:99], v[238:239]
    v_cvt_pk_bf16_f32 v92, v92, v93
    v_cvt_pk_bf16_f32 v93, v94, v95
    v_cvt_pk_bf16_f32 v94, v96, v97
    v_cvt_pk_bf16_f32 v95, v98, v99
    s_cmp_lg_u32 s97, 0
    s_cbranch_scc1 L_ms27
    buffer_store_dwordx4 v[92:95], v252, s[16:19], s80 offen
L_mb27:
    s_bitcmp0_b32 s89, 0
    s_cbranch_scc1 L_nr28
    v_xor_b32 v252, 0x80000000, v252
    s_cmp_lg_u32 s97, 0
    s_cbranch_scc1 L_ms29
    buffer_store_dwordx2 v[92:93], v252, s[16:19], s80 offen
L_mb29:
    s_cmp_lg_u32 s97, 0
    s_cbranch_scc1 L_ms30
    buffer_store_dwordx2 v[94:95], v252, s[16:19], s81 offen
L_mb30:
L_nr28:
    v_pk_mul_f32 v[100:101], v[100:101], v[238:239]
    v_pk_mul_f32 v[102:103], v[102:103], v[238:239]
    v_pk_mul_f32 v[104:105], v[104:105], v[238:239]
    v_pk_mul_f32 v[106:107], v[106:107], v[238:239]
    v_cvt_pk_bf16_f32 v100, v100, v101
    v_cvt_pk_bf16_f32 v101, v102, v103
    v_cvt_pk_bf16_f32 v102, v104, v105
    v_cvt_pk_bf16_f32 v103, v106, v107
    s_cmp_lg_u32 s97, 0
    s_cbranch_scc1 L_ms31
    buffer_store_dwordx4 v[100:103], v253, s[16:19], s80 offen
L_mb31:
    s_bitcmp0_b32 s89, 1
    s_cbranch_scc1 L_nr32
    v_xor_b32 v253, 0x80000000, v253
    s_cmp_lg_u32 s97, 0
    s_cbranch_scc1 L_ms33
    buffer_store_dwordx2 v[100:101], v253, s[16:19], s80 offen
L_mb33:
    s_cmp_lg_u32 s97, 0
    s_cbranch_scc1 L_ms34
    buffer_store_dwordx2 v[102:103], v253, s[16:19], s81 offen
L_mb34:
L_nr32:
    v_pk_mul_f32 v[108:109], v[108:109], v[238:239]
    v_pk_mul_f32 v[110:111], v[110:111], v[238:239]
    v_pk_mul_f32 v[112:113], v[112:113], v[238:239]
    v_pk_mul_f32 v[114:115], v[114:115], v[238:239]
    v_cvt_pk_bf16_f32 v108, v108, v109
    v_cvt_pk_bf16_f32 v109, v110, v111
    v_cvt_pk_bf16_f32 v110, v112, v113
    v_cvt_pk_bf16_f32 v111, v114, v115
    s_cmp_lg_u32 s97, 0
    s_cbranch_scc1 L_ms35
    buffer_store_dwordx4 v[108:111], v254, s[16:19], s80 offen
L_mb35:
    s_bitcmp0_b32 s89, 2
    s_cbranch_scc1 L_nr36
    v_xor_b32 v254, 0x80000000, v254
    s_cmp_lg_u32 s97, 0
    s_cbranch_scc1 L_ms37
    buffer_store_dwordx2 v[108:109], v254, s[16:19], s80 offen
L_mb37:
    s_cmp_lg_u32 s97, 0
    s_cbranch_scc1 L_ms38
    buffer_store_dwordx2 v[110:111], v254, s[16:19], s81 offen
L_mb38:
L_nr36:
    v_pk_mul_f32 v[116:117], v[116:117], v[238:239]
    v_pk_mul_f32 v[118:119], v[118:119], v[238:239]
    v_pk_mul_f32 v[120:121], v[120:121], v[238:239]
    v_pk_mul_f32 v[122:123], v[122:123], v[238:239]
    v_cvt_pk_bf16_f32 v116, v116, v117
    v_cvt_pk_bf16_f32 v117, v118, v119
    v_cvt_pk_bf16_f32 v118, v120, v121
    v_cvt_pk_bf16_f32 v119, v122, v123
    s_cmp_lg_u32 s97, 0
    s_cbranch_scc1 L_ms39
    buffer_store_dwordx4 v[116:119], v255, s[16:19], s80 offen
L_mb39:
    s_bitcmp0_b32 s89, 3
    s_cbranch_scc1 L_nr40
    v_xor_b32 v255, 0x80000000, v255
    s_cmp_lg_u32 s97, 0
    s_cbranch_scc1 L_ms41
    buffer_store_dwordx2 v[116:117], v255, s[16:19], s80 offen
L_mb41:
    s_cmp_lg_u32 s97, 0
    s_cbranch_scc1 L_ms42
    buffer_store_dwordx2 v[118:119], v255, s[16:19], s81 offen
L_mb42:
L_nr40:
    s_branch L_setup
L_p1vv:
    s_waitcnt lgkmcnt(4)
    v_mfma_f32_32x32x16_bf16 v[92:107], v[124:127], v[28:31], 0
    ds_read_b64_tr_b16 v[20:21], v18 offset:4096
    ds_read_b64_tr_b16 v[22:23], v18 offset:4608
    v_mfma_f32_32x32x16_bf16 v[108:123], v[124:127], v[32:35], 0
    ds_read_b64_tr_b16 v[24:25], v19 offset:4096
    ds_read_b64_tr_b16 v[26:27], v19 offset:4608
    s_waitcnt lgkmcnt(4)
    v_mfma_f32_32x32x16_bf16 v[92:107], v[128:131], v[36:39], v[92:107]
    ds_read_b64_tr_b16 v[28:29], v18 offset:6144
    ds_read_b64_tr_b16 v[30:31], v18 offset:6656
    v_add_f32 v8, v236, v237
    v_cvt_pk_bf16_f32 v237, v8, 0
    v_lshlrev_b32 v9, 16, v237
    v_mfma_f32_32x32x16_bf16 v[108:123], v[128:131], v[40:43], v[108:123]
    ds_read_b64_tr_b16 v[32:33], v19 offset:6144
    ds_read_b64_tr_b16 v[34:35], v19 offset:6656
    v_sub_f32 v9, v8, v9
    v_cvt_pk_bf16_f32 v236, v8, v9
    s_waitcnt lgkmcnt(4)
    v_mfma_f32_32x32x16_bf16 v[92:107], v[132:135], v[20:23], v[92:107]
    s_barrier
    ds_read_b64_tr_b16 v[36:37], v18 offset:8192
    ds_read_b64_tr_b16 v[38:39], v18 offset:8704
    v_mfma_f32_32x32x16_bf16 v[108:123], v[132:135], v[24:27], v[108:123]
    ds_read_b64_tr_b16 v[40:41], v19 offset:8192
    ds_read_b64_tr_b16 v[42:43], v19 offset:8704
L_xc43:
    s_waitcnt vmcnt(0)
    v_min_u32 v4, v6, v7
    v_cmp_eq_u32 vcc, 0, v4
    v_cvt_pk_bf16_f32 v240, v6, v6
    s_cbranch_vccnz L_xr43
L_xo43:
    v_and_b32 v5, 0xffff0000, v240
    v_mov_b32 v238, v7
    s_waitcnt lgkmcnt(4)
    v_mfma_f32_32x32x16_bf16 v[92:107], v[136:139], v[28:31], v[92:107]
    ds_read_b64_tr_b16 v[20:21], v18 offset:10240
    ds_read_b64_tr_b16 v[22:23], v18 offset:10752
    v_sub_f32 v5, v6, v5
    v_cndmask_b32 v244, v240, 0, s[72:73]
    v_cvt_pk_bf16_f32 v241, v5, 0
    v_mfma_f32_32x32x16_bf16 v[108:123], v[136:139], v[32:35], v[108:123]
    ds_read_b64_tr_b16 v[24:25], v19 offset:10240
    ds_read_b64_tr_b16 v[26:27], v19 offset:10752
    v_cndmask_b32 v246, 0, v240, s[72:73]
    v_cndmask_b32 v245, v241, 0, s[72:73]
    v_cndmask_b32 v247, 0, v241, s[72:73]
    s_lshl_b32 s34, s28, 7
    s_add_u32 s34, s34, 33792
    s_waitcnt lgkmcnt(4)
    v_mfma_f32_32x32x16_bf16 v[92:107], v[140:143], v[36:39], v[92:107]
    ds_read_b64_tr_b16 v[28:29], v18 offset:12288
    ds_read_b64_tr_b16 v[30:31], v18 offset:12800
    v_lshl_add_u32 v4, v11, 2, s34
    v_lshl_add_u32 v5, v12, 4, s34
    ds_write_b32 v4, v238
    v_mfma_f32_32x32x16_bf16 v[108:123], v[140:143], v[40:43], v[108:123]
    ds_read_b64_tr_b16 v[32:33], v19 offset:12288
    ds_read_b64_tr_b16 v[34:35], v19 offset:12800
    ds_read_b128 v[124:127], v5 offset:0
    ds_read_b128 v[128:131], v5 offset:32
    ds_read_b128 v[132:135], v5 offset:64
    ds_read_b128 v[136:139], v5 offset:96
    s_waitcnt lgkmcnt(9)
    v_mfma_f32_32x32x16_bf16 v[92:107], v[144:147], v[20:23], v[92:107]
    ds_read_b64_tr_b16 v[36:37], v18 offset:14336
    ds_read_b64_tr_b16 v[38:39], v18 offset:14848
    v_mfma_f32_32x32x8_bf16 v[60:75], v[244:245], v[236:237], v[60:75]
    v_mfma_f32_32x32x8_bf16 v[76:91], v[246:247], v[236:237], v[76:91]
    v_mfma_f32_32x32x16_bf16 v[108:123], v[144:147], v[24:27], v[108:123]
    ds_read_b64_tr_b16 v[40:41], v19 offset:14336
    ds_read_b64_tr_b16 v[42:43], v19 offset:14848
    s_waitcnt lgkmcnt(8)
    v_mfma_f32_32x32x16_bf16 v[92:107], v[148:151], v[28:31], v[92:107]
    ds_read_b128 v[44:47], v2 offset:49152
    ds_read_b64_tr_b16 v[20:21], v18 offset:16384
    v_mfma_f32_32x32x16_bf16 v[108:123], v[148:151], v[32:35], v[108:123]
    ds_read_b64_tr_b16 v[22:23], v18 offset:16896
    ds_read_b64_tr_b16 v[24:25], v19 offset:16384
    ds_read_b64_tr_b16 v[26:27], v19 offset:16896
    s_waitcnt lgkmcnt(9)
    s_waitcnt lgkmcnt(5)
    v_mfma_f32_32x32x16_bf16 v[92:107], v[152:155], v[36:39], v[92:107]
    ds_read_b128 v[48:51], v3 offset:49152
    ds_read_b64_tr_b16 v[28:29], v18 offset:18432
    v_mul_f32 v60, v60, v124
    v_mul_f32 v61, v61, v125
    v_mul_f32 v62, v62, v126
    v_mfma_f32_32x32x16_bf16 v[108:123], v[152:155], v[40:43], v[108:123]
    ds_read_b64_tr_b16 v[30:31], v18 offset:18944
    ds_read_b64_tr_b16 v[32:33], v19 offset:18432
    ds_read_b64_tr_b16 v[34:35], v19 offset:18944
    v_mul_f32 v63, v63, v127
    v_mul_f32 v64, v64, v128
    v_mul_f32 v65, v65, v129
    v_mul_f32 v66, v66, v130
    s_waitcnt lgkmcnt(5)
    v_mfma_f32_32x32x16_bf16 v[92:107], v[44:47], v[20:23], v[92:107]
    ds_read_b128 v[52:55], v13 offset:49152
    ds_read_b64_tr_b16 v[36:37], v18 offset:20480
    v_mul_f32 v67, v67, v131
    v_cvt_pk_bf16_f32 v60, v60, v61
    v_cvt_pk_bf16_f32 v61, v62, v63
    v_mfma_f32_32x32x16_bf16 v[108:123], v[44:47], v[24:27], v[108:123]
    ds_read_b64_tr_b16 v[38:39], v18 offset:20992
    ds_read_b64_tr_b16 v[40:41], v19 offset:20480
    ds_read_b64_tr_b16 v[42:43], v19 offset:20992
    v_cvt_pk_bf16_f32 v62, v64, v65
    v_cvt_pk_bf16_f32 v63, v66, v67
    buffer_store_dwordx4 v[60:63], v248, s[16:19], s78 offen offset:0 sc1
    v_mul_f32 v68, v68, v132
    s_waitcnt lgkmcnt(5)
    v_mfma_f32_32x32x16_bf16 v[92:107], v[48:51], v[28:31], v[92:107]
    ds_read_b128 v[56:59], v14 offset:49152
    ds_read_b64_tr_b16 v[20:21], v18 offset:22528
    v_mul_f32 v69, v69, v133
    v_mul_f32 v70, v70, v134
    v_mul_f32 v71, v71, v135
    v_mfma_f32_32x32x16_bf16 v[108:123], v[48:51], v[32:35], v[108:123]
    ds_read_b64_tr_b16 v[22:23], v18 offset:23040
    ds_read_b64_tr_b16 v[24:25], v19 offset:22528
    ds_read_b64_tr_b16 v[26:27], v19 offset:23040
    v_mul_f32 v72, v72, v136
    v_mul_f32 v73, v73, v137
    v_mul_f32 v74, v74, v138
    v_mul_f32 v75, v75, v139
    s_waitcnt lgkmcnt(5)
    v_mfma_f32_32x32x16_bf16 v[92:107], v[52:55], v[36:39], v[92:107]
    s_barrier
    ds_read_b128 v[44:47], v2 offset:0
    ds_read_b64_tr_b16 v[28:29], v18 offset:24576
    v_cvt_pk_bf16_f32 v68, v68, v69
    v_cvt_pk_bf16_f32 v69, v70, v71
    v_cvt_pk_bf16_f32 v70, v72, v73
    v_mfma_f32_32x32x16_bf16 v[108:123], v[52:55], v[40:43], v[108:123]
    ds_read_b64_tr_b16 v[30:31], v18 offset:25088
    ds_read_b64_tr_b16 v[32:33], v19 offset:24576
    ds_read_b64_tr_b16 v[34:35], v19 offset:25088
    v_cvt_pk_bf16_f32 v71, v74, v75
    buffer_store_dwordx4 v[68:71], v248, s[16:19], s78 offen offset:640 sc1
    v_mul_f32 v76, v76, v124
    v_mul_f32 v77, v77, v125
    s_waitcnt lgkmcnt(5)
    v_mfma_f32_32x32x16_bf16 v[92:107], v[56:59], v[20:23], v[92:107]
    ds_read_b128 v[48:51], v3 offset:0
    ds_read_b64_tr_b16 v[36:37], v18 offset:26624
    v_mul_f32 v78, v78, v126
    v_mul_f32 v79, v79, v127
    v_mul_f32 v80, v80, v128
    v_mfma_f32_32x32x16_bf16 v[108:123], v[56:59], v[24:27], v[108:123]
    ds_read_b64_tr_b16 v[38:39], v18 offset:27136
    ds_read_b64_tr_b16 v[40:41], v19 offset:26624
    ds_read_b64_tr_b16 v[42:43], v19 offset:27136
    v_mul_f32 v81, v81, v129
    v_mul_f32 v82, v82, v130
    v_mul_f32 v83, v83, v131
    v_cvt_pk_bf16_f32 v76, v76, v77
    s_waitcnt lgkmcnt(5)
    v_mfma_f32_32x32x16_bf16 v[92:107], v[44:47], v[28:31], v[92:107]
    ds_read_b128 v[52:55], v13 offset:0
    ds_read_b64_tr_b16 v[20:21], v18 offset:28672
    v_cvt_pk_bf16_f32 v77, v78, v79
    v_cvt_pk_bf16_f32 v78, v80, v81
    v_cvt_pk_bf16_f32 v79, v82, v83
    v_mfma_f32_32x32x16_bf16 v[108:123], v[44:47], v[32:35], v[108:123]
    ds_read_b64_tr_b16 v[22:23], v18 offset:29184
    ds_read_b64_tr_b16 v[24:25], v19 offset:28672
    ds_read_b64_tr_b16 v[26:27], v19 offset:29184
    buffer_store_dwordx4 v[76:79], v249, s[16:19], s78 offen offset:0 sc1
    v_mul_f32 v84, v84, v132
    v_mul_f32 v85, v85, v133
    v_mul_f32 v86, v86, v134
    s_waitcnt lgkmcnt(5)
    v_mfma_f32_32x32x16_bf16 v[92:107], v[48:51], v[36:39], v[92:107]
    ds_read_b128 v[56:59], v14 offset:0
    ds_read_b64_tr_b16 v[28:29], v18 offset:30720
    v_mul_f32 v87, v87, v135
    v_mul_f32 v88, v88, v136
    v_mul_f32 v89, v89, v137
    v_mfma_f32_32x32x16_bf16 v[108:123], v[48:51], v[40:43], v[108:123]
    ds_read_b64_tr_b16 v[30:31], v18 offset:31232
    ds_read_b64_tr_b16 v[32:33], v19 offset:30720
    ds_read_b64_tr_b16 v[34:35], v19 offset:31232
    v_mul_f32 v90, v90, v138
    v_mul_f32 v91, v91, v139
    v_cvt_pk_bf16_f32 v84, v84, v85
    v_cvt_pk_bf16_f32 v85, v86, v87
    s_waitcnt lgkmcnt(5)
    v_mfma_f32_32x32x16_bf16 v[92:107], v[52:55], v[20:23], v[92:107]
    ds_read_b128 v[44:47], v2 offset:16384
    ds_read_b64_tr_b16 v[36:37], v18 offset:32768
    v_cvt_pk_bf16_f32 v86, v88, v89
    v_cvt_pk_bf16_f32 v87, v90, v91
    buffer_store_dwordx4 v[84:87], v249, s[16:19], s78 offen offset:640 sc1
    v_mfma_f32_32x32x16_bf16 v[108:123], v[52:55], v[24:27], v[108:123]
    ds_read_b64_tr_b16 v[38:39], v18 offset:33280
    ds_read_b64_tr_b16 v[40:41], v19 offset:32768
    ds_read_b64_tr_b16 v[42:43], v19 offset:33280
    v_mul_f32 v238, s91, v238
    v_lshlrev_b32 v4, 3, v10
    v_mov_b32 v239, v238
    v_add_u32 v4, 32768, v4
    s_waitcnt lgkmcnt(5)
    v_mfma_f32_32x32x16_bf16 v[92:107], v[56:59], v[28:31], v[92:107]
    ds_read_b128 v[48:51], v3 offset:16384
    ds_read_b64_tr_b16 v[20:21], v18 offset:34816
    v_mov_b32 v5, 34304
    v_mov_b32 v7, 1
    v_mfma_f32_32x32x16_bf16 v[108:123], v[56:59], v[32:35], v[108:123]
    ds_read_b64_tr_b16 v[22:23], v18 offset:35328
    ds_read_b64_tr_b16 v[24:25], v19 offset:34816
    ds_read_b64_tr_b16 v[26:27], v19 offset:35328
    s_waitcnt lgkmcnt(5)
    v_mfma_f32_32x32x16_bf16 v[92:107], v[44:47], v[36:39], v[92:107]
    ds_read_b128 v[52:55], v13 offset:16384
    ds_read_b64_tr_b16 v[28:29], v18 offset:36864
    v_mfma_f32_32x32x16_bf16 v[108:123], v[44:47], v[40:43], v[108:123]
    ds_read_b64_tr_b16 v[30:31], v18 offset:37376
    ds_read_b64_tr_b16 v[32:33], v19 offset:36864
    ds_read_b64_tr_b16 v[34:35], v19 offset:37376
    s_waitcnt lgkmcnt(5)
    v_mfma_f32_32x32x16_bf16 v[92:107], v[48:51], v[20:23], v[92:107]
    ds_read_b128 v[56:59], v14 offset:16384
    ds_read_b64_tr_b16 v[36:37], v18 offset:38912
    v_mfma_f32_32x32x16_bf16 v[108:123], v[48:51], v[24:27], v[108:123]
    ds_read_b64_tr_b16 v[38:39], v18 offset:39424
    ds_read_b64_tr_b16 v[40:41], v19 offset:38912
    ds_read_b64_tr_b16 v[42:43], v19 offset:39424
    s_waitcnt lgkmcnt(5)
    v_mfma_f32_32x32x16_bf16 v[92:107], v[52:55], v[28:31], v[92:107]
    s_waitcnt lgkmcnt(0)
    s_barrier
    ds_read_b64_tr_b16 v[20:21], v18 offset:40960
    ds_read_b64_tr_b16 v[22:23], v18 offset:41472
    v_mfma_f32_32x32x16_bf16 v[108:123], v[52:55], v[32:35], v[108:123]
    ds_read_b64_tr_b16 v[24:25], v19 offset:40960
    ds_read_b64_tr_b16 v[26:27], v19 offset:41472
    v_mfma_f32_32x32x16_bf16 v[92:107], v[56:59], v[36:39], v[92:107]
    ds_read_b64_tr_b16 v[28:29], v18 offset:43008
    ds_read_b64_tr_b16 v[30:31], v18 offset:43520
    v_mfma_f32_32x32x16_bf16 v[108:123], v[56:59], v[40:43], v[108:123]
    ds_read_b64_tr_b16 v[32:33], v19 offset:43008
    ds_read_b64_tr_b16 v[34:35], v19 offset:43520
    s_waitcnt lgkmcnt(4)
    v_mfma_f32_32x32x16_bf16 v[92:107], v[156:159], v[20:23], v[92:107]
    ds_read_b64_tr_b16 v[36:37], v18 offset:45056
    ds_read_b64_tr_b16 v[38:39], v18 offset:45568
    v_mfma_f32_32x32x16_bf16 v[108:123], v[156:159], v[24:27], v[108:123]
    ds_read_b64_tr_b16 v[40:41], v19 offset:45056
    ds_read_b64_tr_b16 v[42:43], v19 offset:45568
    s_waitcnt lgkmcnt(4)
    v_mfma_f32_32x32x16_bf16 v[92:107], v[160:163], v[28:31], v[92:107]
    ds_read_b64_tr_b16 v[20:21], v18 offset:47104
    ds_read_b64_tr_b16 v[22:23], v18 offset:47616
    v_mfma_f32_32x32x16_bf16 v[108:123], v[160:163], v[32:35], v[108:123]
    ds_read_b64_tr_b16 v[24:25], v19 offset:47104
    ds_read_b64_tr_b16 v[26:27], v19 offset:47616
    s_waitcnt lgkmcnt(4)
    v_mfma_f32_32x32x16_bf16 v[92:107], v[164:167], v[36:39], v[92:107]
    ds_read_b64_tr_b16 v[28:29], v18 offset:49152
    ds_read_b64_tr_b16 v[30:31], v18 offset:49664
    v_mfma_f32_32x32x16_bf16 v[108:123], v[164:167], v[40:43], v[108:123]
    ds_read_b64_tr_b16 v[32:33], v19 offset:49152
    ds_read_b64_tr_b16 v[34:35], v19 offset:49664
    s_waitcnt lgkmcnt(4)
    v_mfma_f32_32x32x16_bf16 v[92:107], v[168:171], v[20:23], v[92:107]
    ds_read_b64_tr_b16 v[36:37], v18 offset:51200
    ds_read_b64_tr_b16 v[38:39], v18 offset:51712
    v_mfma_f32_32x32x16_bf16 v[108:123], v[168:171], v[24:27], v[108:123]
    ds_read_b64_tr_b16 v[40:41], v19 offset:51200
    ds_read_b64_tr_b16 v[42:43], v19 offset:51712
    s_waitcnt lgkmcnt(4)
    v_mfma_f32_32x32x16_bf16 v[92:107], v[172:175], v[28:31], v[92:107]
    ds_read_b64_tr_b16 v[20:21], v18 offset:53248
    ds_read_b64_tr_b16 v[22:23], v18 offset:53760
    v_mfma_f32_32x32x16_bf16 v[108:123], v[172:175], v[32:35], v[108:123]
    ds_read_b64_tr_b16 v[24:25], v19 offset:53248
    ds_read_b64_tr_b16 v[26:27], v19 offset:53760
    s_waitcnt vmcnt(0)
    buffer_store_dword v7, off, s[16:19], s98 sc1
    s_waitcnt lgkmcnt(4)
    v_mfma_f32_32x32x16_bf16 v[92:107], v[176:179], v[36:39], v[92:107]
    ds_read_b64_tr_b16 v[28:29], v18 offset:55296
    ds_read_b64_tr_b16 v[30:31], v18 offset:55808
    v_mfma_f32_32x32x16_bf16 v[108:123], v[176:179], v[40:43], v[108:123]
    ds_read_b64_tr_b16 v[32:33], v19 offset:55296
    ds_read_b64_tr_b16 v[34:35], v19 offset:55808
    s_waitcnt lgkmcnt(4)
    v_mfma_f32_32x32x16_bf16 v[92:107], v[180:183], v[20:23], v[92:107]
    s_barrier
    ds_read_b64_tr_b16 v[36:37], v18 offset:57344
    ds_read_b64_tr_b16 v[38:39], v18 offset:57856
    v_mfma_f32_32x32x16_bf16 v[108:123], v[180:183], v[24:27], v[108:123]
    ds_read_b64_tr_b16 v[40:41], v19 offset:57344
    ds_read_b64_tr_b16 v[42:43], v19 offset:57856
    s_waitcnt lgkmcnt(4)
    v_mfma_f32_32x32x16_bf16 v[92:107], v[184:187], v[28:31], v[92:107]
    ds_read_b64_tr_b16 v[20:21], v18 offset:59392
    ds_read_b64_tr_b16 v[22:23], v18 offset:59904
    v_mfma_f32_32x32x16_bf16 v[108:123], v[184:187], v[32:35], v[108:123]
    ds_read_b64_tr_b16 v[24:25], v19 offset:59392
    ds_read_b64_tr_b16 v[26:27], v19 offset:59904
    s_waitcnt lgkmcnt(4)
    v_mfma_f32_32x32x16_bf16 v[92:107], v[188:191], v[36:39], v[92:107]
    ds_read_b64_tr_b16 v[28:29], v18 offset:61440
    ds_read_b64_tr_b16 v[30:31], v18 offset:61952
    v_mfma_f32_32x32x16_bf16 v[108:123], v[188:191], v[40:43], v[108:123]
    ds_read_b64_tr_b16 v[32:33], v19 offset:61440
    ds_read_b64_tr_b16 v[34:35], v19 offset:61952
    s_waitcnt lgkmcnt(4)
    v_mfma_f32_32x32x16_bf16 v[92:107], v[192:195], v[20:23], v[92:107]
    ds_read_b64_tr_b16 v[36:37], v18 offset:63488
    ds_read_b64_tr_b16 v[38:39], v18 offset:64000
    v_mfma_f32_32x32x16_bf16 v[108:123], v[192:195], v[24:27], v[108:123]
    ds_read_b64_tr_b16 v[40:41], v19 offset:63488
    ds_read_b64_tr_b16 v[42:43], v19 offset:64000
    s_waitcnt lgkmcnt(4)
    v_subrev_u32 v18, 16384, v18
    v_subrev_u32 v19, 16384, v19
    v_mfma_f32_32x32x16_bf16 v[92:107], v[196:199], v[28:31], v[92:107]
    s_barrier
    ds_read_b64_tr_b16 v[20:21], v18 offset:0
    ds_read_b64_tr_b16 v[22:23], v18 offset:512
    v_mfma_f32_32x32x16_bf16 v[108:123], v[196:199], v[32:35], v[108:123]
    ds_read_b64_tr_b16 v[24:25], v19 offset:0
    ds_read_b64_tr_b16 v[26:27], v19 offset:512
    ds_read_b64 v[140:141], v4 offset:0
    ds_read_b64 v[142:143], v4 offset:512
    ds_read_b32 v6, v5
    s_waitcnt lgkmcnt(7)
    v_mfma_f32_32x32x16_bf16 v[92:107], v[200:203], v[36:39], v[92:107]
    ds_read_b64_tr_b16 v[28:29], v18 offset:2048
    ds_read_b64_tr_b16 v[30:31], v18 offset:2560
    v_mfma_f32_32x32x16_bf16 v[108:123], v[200:203], v[40:43], v[108:123]
    ds_read_b64_tr_b16 v[32:33], v19 offset:2048
    ds_read_b64_tr_b16 v[34:35], v19 offset:2560
    s_waitcnt lgkmcnt(7)
    v_mfma_f32_32x32x16_bf16 v[92:107], v[204:207], v[20:23], v[92:107]
    ds_read_b64_tr_b16 v[36:37], v18 offset:4096
    ds_read_b64_tr_b16 v[38:39], v18 offset:4608
    v_mfma_f32_32x32x16_bf16 v[108:123], v[204:207], v[24:27], v[108:123]
    ds_read_b64_tr_b16 v[40:41], v19 offset:4096
    ds_read_b64_tr_b16 v[42:43], v19 offset:4608
    s_waitcnt lgkmcnt(4)
    v_mfma_f32_32x32x16_bf16 v[92:107], v[208:211], v[28:31], v[92:107]
    ds_read_b64_tr_b16 v[20:21], v18 offset:6144
    ds_read_b64_tr_b16 v[22:23], v18 offset:6656
    v_mfma_f32_32x32x16_bf16 v[108:123], v[208:211], v[32:35], v[108:123]
    ds_read_b64_tr_b16 v[24:25], v19 offset:6144
    ds_read_b64_tr_b16 v[26:27], v19 offset:6656
    s_waitcnt lgkmcnt(4)
    v_mfma_f32_32x32x16_bf16 v[92:107], v[212:215], v[36:39], v[92:107]
    ds_read_b64_tr_b16 v[28:29], v18 offset:8192
    ds_read_b64_tr_b16 v[30:31], v18 offset:8704
    v_mfma_f32_32x32x16_bf16 v[108:123], v[212:215], v[40:43], v[108:123]
    ds_read_b64_tr_b16 v[32:33], v19 offset:8192
    ds_read_b64_tr_b16 v[34:35], v19 offset:8704
    s_waitcnt lgkmcnt(4)
    v_mfma_f32_32x32x16_bf16 v[92:107], v[216:219], v[20:23], v[92:107]
    ds_read_b64_tr_b16 v[36:37], v18 offset:10240
    ds_read_b64_tr_b16 v[38:39], v18 offset:10752
    v_mfma_f32_32x32x16_bf16 v[108:123], v[216:219], v[24:27], v[108:123]
    ds_read_b64_tr_b16 v[40:41], v19 offset:10240
    ds_read_b64_tr_b16 v[42:43], v19 offset:10752
    s_waitcnt lgkmcnt(4)
    v_mfma_f32_32x32x16_bf16 v[92:107], v[220:223], v[28:31], v[92:107]
    ds_read_b64_tr_b16 v[20:21], v18 offset:12288
    ds_read_b64_tr_b16 v[22:23], v18 offset:12800
    v_mfma_f32_32x32x16_bf16 v[108:123], v[220:223], v[32:35], v[108:123]
    ds_read_b64_tr_b16 v[24:25], v19 offset:12288
    ds_read_b64_tr_b16 v[26:27], v19 offset:12800
    s_waitcnt lgkmcnt(4)
    v_mfma_f32_32x32x16_bf16 v[92:107], v[224:227], v[36:39], v[92:107]
    ds_read_b64_tr_b16 v[28:29], v18 offset:14336
    ds_read_b64_tr_b16 v[30:31], v18 offset:14848
    v_mfma_f32_32x32x16_bf16 v[108:123], v[224:227], v[40:43], v[108:123]
    ds_read_b64_tr_b16 v[32:33], v19 offset:14336
    ds_read_b64_tr_b16 v[34:35], v19 offset:14848
    s_waitcnt lgkmcnt(4)
    v_mfma_f32_32x32x16_bf16 v[92:107], v[228:231], v[20:23], v[92:107]
    v_mfma_f32_32x32x16_bf16 v[108:123], v[228:231], v[24:27], v[108:123]
    v_readfirstlane_b32 s31, v6
    s_waitcnt lgkmcnt(0)
    v_mfma_f32_32x32x16_bf16 v[92:107], v[232:235], v[28:31], v[92:107]
    v_mfma_f32_32x32x16_bf16 v[108:123], v[232:235], v[32:35], v[108:123]
    v_mfma_f32_32x32x8_bf16 v[92:107], v[240:241], v[140:141], v[92:107]
    v_mfma_f32_32x32x8_bf16 v[108:123], v[240:241], v[142:143], v[108:123]
    s_cmp_lt_u32 s96, 10
    s_cselect_b32 s97, s31, 1
    s_nop 8
    v_pk_mul_f32 v[92:93], v[92:93], v[124:125]
    v_pk_mul_f32 v[94:95], v[94:95], v[126:127]
    v_pk_mul_f32 v[96:97], v[96:97], v[128:129]
    v_pk_mul_f32 v[98:99], v[98:99], v[130:131]
    v_cvt_pk_bf16_f32 v92, v92, v93
    v_cvt_pk_bf16_f32 v93, v94, v95
    v_cvt_pk_bf16_f32 v94, v96, v97
    v_cvt_pk_bf16_f32 v95, v98, v99
    buffer_store_dwordx4 v[92:95], v252, s[16:19], s80 offen offset:0 sc1
    v_pk_mul_f32 v[100:101], v[100:101], v[132:133]
    v_pk_mul_f32 v[102:103], v[102:103], v[134:135]
    v_pk_mul_f32 v[104:105], v[104:105], v[136:137]
    v_pk_mul_f32 v[106:107], v[106:107], v[138:139]
    v_cvt_pk_bf16_f32 v100, v100, v101
    v_cvt_pk_bf16_f32 v101, v102, v103
    v_cvt_pk_bf16_f32 v102, v104, v105
    v_cvt_pk_bf16_f32 v103, v106, v107
    buffer_store_dwordx4 v[100:103], v252, s[16:19], s80 offen offset:640 sc1
    v_pk_mul_f32 v[108:109], v[108:109], v[124:125]
    v_pk_mul_f32 v[110:111], v[110:111], v[126:127]
    v_pk_mul_f32 v[112:113], v[112:113], v[128:129]
    v_pk_mul_f32 v[114:115], v[114:115], v[130:131]
    v_cvt_pk_bf16_f32 v108, v108, v109
    v_cvt_pk_bf16_f32 v109, v110, v111
    v_cvt_pk_bf16_f32 v110, v112, v113
    v_cvt_pk_bf16_f32 v111, v114, v115
    buffer_store_dwordx4 v[108:111], v253, s[16:19], s80 offen offset:0 sc1
    v_pk_mul_f32 v[116:117], v[116:117], v[132:133]
    v_pk_mul_f32 v[118:119], v[118:119], v[134:135]
    v_pk_mul_f32 v[120:121], v[120:121], v[136:137]
    v_pk_mul_f32 v[122:123], v[122:123], v[138:139]
    v_cvt_pk_bf16_f32 v116, v116, v117
    v_cvt_pk_bf16_f32 v117, v118, v119
    v_cvt_pk_bf16_f32 v118, v120, v121
    v_cvt_pk_bf16_f32 v119, v122, v123
    buffer_store_dwordx4 v[116:119], v253, s[16:19], s80 offen offset:640 sc1
    s_branch L_setup
L_spare:
    s_lshl_b32 s34, s30, 2
    s_add_u32 s34, s34, s87
    s_mul_i32 s34, s34, 640
    v_lshl_add_u32 v70, v10, 7, s34
    v_min_u32 v70, L_end-sequential_preLN__softmax_full_mha__glu_gated_bilinear__prompt_kernel-128, v70
    s_mov_b64 exec, 31
    global_load_dword v71, v70, s[74:75]
    s_mov_b64 exec, -1
    v_mov_b32 v16, 0
    v_mov_b32 v17, 0
    v_mov_b32 v18, 0
    v_mov_b32 v19, 0
    v_lshlrev_b32 v8, 4, v11
    v_lshl_add_u32 v8, v12, 13, v8
    s_lshl_b32 s78, s84, 9
    s_add_u32 s78, s78, 28069888
    s_add_u32 s79, s78, 16384
    s_lshl_b32 s82, s84, 11
    s_add_u32 s82, s82, 28102656
    s_lshl_b32 s83, s84, 7
    s_add_u32 s83, s83, 28135424
    v_lshrrev_b32 v4, 3, v10
    v_and_b32 v5, 0x70, v1
    v_lshl_add_u32 v21, v4, 11, v5
    v_add_u32 v22, 16384, v21
    v_add_u32 v23, 26624, v21
    s_lshl_b32 s80, s84, 10
    s_add_u32 s80, s80, 28200960
    v_mov_b32 v20, 1
    s_lshl_b32 s81, s84, 2
    s_waitcnt lgkmcnt(0)
    s_mov_b32 s95, 0
    s_mov_b32 s16, s54
    s_mov_b32 s17, s55
    s_mov_b32 s18, 31457280
    s_mov_b32 s19, 0x00020000
    s_mov_b32 s24, s52
    s_mov_b32 s25, s53
    s_mov_b32 s26, 256
    s_mov_b32 s27, 0x00020000
    s_cmp_eq_u32 s28, 0
    s_cbranch_scc0 L_nz
    buffer_store_dwordx4 v[16:19], v8, s[16:19], s78 offen sc1
    buffer_store_dwordx4 v[16:19], v8, s[16:19], s79 offen sc1
    buffer_store_dwordx4 v[16:19], v1, s[16:19], s82 offen sc1
    buffer_store_dwordx4 v[16:19], v1, s[16:19], s82 offen offset:1024 sc1
    buffer_store_dwordx4 v[16:19], v21, s[16:19], s83 offen sc1
    buffer_store_dwordx4 v[16:19], v22, s[16:19], s83 offen sc1
    buffer_store_dwordx4 v[16:19], v23, s[16:19], s83 offen sc1
    buffer_store_dwordx4 v[16:19], v1, s[16:19], s80 offen sc1
L_nz:
    s_cselect_b32 s81, s81, 256
    s_mov_b32 s4, s36
    s_mov_b32 s5, s37
    s_mov_b32 s6, 2621440
    s_mov_b32 s7, 0x00020000
    v_lshrrev_b32 v4, 3, v10
    v_mul_u32_u24 v5, 1280, v4
    v_and_b32 v6, 7, v10
    v_lshl_add_u32 v14, v6, 4, v5
    v_add_u32 v13, 10240, v14
    v_bfe_u32 v6, v10, 2, 1
    v_lshl_add_u32 v4, v6, 3, v4
    v_lshlrev_b32 v15, 3, v4
    s_lshl_b32 s82, s84, 3
    s_add_u32 s82, s82, s28
    s_mul_i32 s83, s82, 20480
    s_lshl_b32 s82, s82, 7
    s_add_u32 s82, s82, 28200960
    buffer_load_dwordx4 v[80:83], v14, s[4:7], s83 offen offset:0
    buffer_load_dwordx4 v[84:87], v14, s[4:7], s83 offen offset:128
    buffer_load_dwordx4 v[88:91], v14, s[4:7], s83 offen offset:256
    buffer_load_dwordx4 v[92:95], v14, s[4:7], s83 offen offset:384
    buffer_load_dwordx4 v[96:99], v14, s[4:7], s83 offen offset:512
    s_mov_b32 s24, s52
    s_mov_b32 s25, s53
    s_mov_b32 s26, 256
    s_mov_b32 s27, 0x00020000
    s_getreg_b32 s32, hwreg(HW_REG_XCC_ID, 0, 4)
    s_lshl_b32 s34, s29, 12
    s_add_u32 s34, s34, 28102660
    s_add_u32 s32, s32, 1
    v_lshl_add_u32 v75, v11, 7, s34
    v_mov_b32 v69, s32
    s_lshl_b32 s64, s30, 7
    s_add_u32 s64, s64, s34
    s_cmp_eq_u32 s28, 4
    s_cselect_b32 s64, s64, 2146435072
    v_and_b32 v76, 15, v10
    v_lshlrev_b32 v76, 2, v76
    s_lshl_b32 s34, s29, 3
    v_and_or_b32 v68, v76, 4, s34
    s_mov_b32 s12, s40
    s_mov_b32 s13, s41
    s_mov_b32 s14, 819200
    s_mov_b32 s15, 0x00020000
    s_mul_i32 s78, s28, 5120
    s_mul_i32 s79, s84, 51200
    s_mul_i32 s80, s84, 204800
    s_add_u32 s80, s80, 20480
    s_mul_i32 s35, s28, 320
    v_add_u32 v7, s35, v10
    v_add_u32 v4, 0, v7
    v_mul_u32_u24 v5, 52429, v4
    v_lshrrev_b32 v5, 22, v5
    v_mul_u32_u24 v6, 80, v5
    v_sub_u32 v4, v4, v6
    v_lshrrev_b32 v6, 4, v5
    v_lshl_add_u32 v6, v6, 2, v5
    v_mul_u32_u24 v6, 1280, v6
    v_lshl_add_u32 v24, v4, 4, v6
    v_lshrrev_b32 v6, 2, v5
    v_lshl_add_u32 v6, v6, 4, v5
    v_mul_u32_u24 v6, 1280, v6
    v_lshl_add_u32 v30, v4, 4, v6
    v_add_u32 v4, 64, v7
    v_mul_u32_u24 v5, 52429, v4
    v_lshrrev_b32 v5, 22, v5
    v_mul_u32_u24 v6, 80, v5
    v_sub_u32 v4, v4, v6
    v_lshrrev_b32 v6, 4, v5
    v_lshl_add_u32 v6, v6, 2, v5
    v_mul_u32_u24 v6, 1280, v6
    v_lshl_add_u32 v25, v4, 4, v6
    v_lshrrev_b32 v6, 2, v5
    v_lshl_add_u32 v6, v6, 4, v5
    v_mul_u32_u24 v6, 1280, v6
    v_lshl_add_u32 v31, v4, 4, v6
    v_add_u32 v4, 128, v7
    v_mul_u32_u24 v5, 52429, v4
    v_lshrrev_b32 v5, 22, v5
    v_mul_u32_u24 v6, 80, v5
    v_sub_u32 v4, v4, v6
    v_lshrrev_b32 v6, 4, v5
    v_lshl_add_u32 v6, v6, 2, v5
    v_mul_u32_u24 v6, 1280, v6
    v_lshl_add_u32 v26, v4, 4, v6
    v_lshrrev_b32 v6, 2, v5
    v_lshl_add_u32 v6, v6, 4, v5
    v_mul_u32_u24 v6, 1280, v6
    v_lshl_add_u32 v32, v4, 4, v6
    v_add_u32 v4, 192, v7
    v_mul_u32_u24 v5, 52429, v4
    v_lshrrev_b32 v5, 22, v5
    v_mul_u32_u24 v6, 80, v5
    v_sub_u32 v4, v4, v6
    v_lshrrev_b32 v6, 4, v5
    v_lshl_add_u32 v6, v6, 2, v5
    v_mul_u32_u24 v6, 1280, v6
    v_lshl_add_u32 v27, v4, 4, v6
    v_lshrrev_b32 v6, 2, v5
    v_lshl_add_u32 v6, v6, 4, v5
    v_mul_u32_u24 v6, 1280, v6
    v_lshl_add_u32 v33, v4, 4, v6
    v_add_u32 v4, 256, v7
    v_mul_u32_u24 v5, 52429, v4
    v_lshrrev_b32 v5, 22, v5
    v_mul_u32_u24 v6, 80, v5
    v_sub_u32 v4, v4, v6
    v_lshrrev_b32 v6, 4, v5
    v_lshl_add_u32 v6, v6, 2, v5
    v_mul_u32_u24 v6, 1280, v6
    v_lshl_add_u32 v28, v4, 4, v6
    v_lshrrev_b32 v6, 2, v5
    v_lshl_add_u32 v6, v6, 4, v5
    v_mul_u32_u24 v6, 1280, v6
    v_lshl_add_u32 v34, v4, 4, v6
    s_waitcnt vmcnt(5)
    buffer_store_dword v20, off, s[24:27], s81 sc1
    buffer_load_dwordx4 v[100:103], v14, s[4:7], s83 offen offset:640
    buffer_load_dwordx4 v[104:107], v14, s[4:7], s83 offen offset:768
    buffer_load_dwordx4 v[108:111], v14, s[4:7], s83 offen offset:896
    buffer_load_dwordx4 v[112:115], v14, s[4:7], s83 offen offset:1024
    buffer_load_dwordx4 v[116:119], v14, s[4:7], s83 offen offset:1152
    buffer_load_dwordx4 v[120:123], v13, s[4:7], s83 offen offset:0
    buffer_load_dwordx4 v[124:127], v13, s[4:7], s83 offen offset:128
    buffer_load_dwordx4 v[128:131], v13, s[4:7], s83 offen offset:256
    buffer_load_dwordx4 v[132:135], v13, s[4:7], s83 offen offset:384
    buffer_load_dwordx4 v[136:139], v13, s[4:7], s83 offen offset:512
    buffer_load_dwordx4 v[140:143], v13, s[4:7], s83 offen offset:640
    buffer_load_dwordx4 v[144:147], v13, s[4:7], s83 offen offset:768
    buffer_load_dwordx4 v[148:151], v13, s[4:7], s83 offen offset:896
    buffer_load_dwordx4 v[152:155], v13, s[4:7], s83 offen offset:1024
    buffer_load_dwordx4 v[156:159], v13, s[4:7], s83 offen offset:1152
    v_mov_b32 v4, 0x3f803f80
    s_waitcnt vmcnt(20)
    v_dot2c_f32_bf16 v16, v80, v4
    v_dot2c_f32_bf16 v17, v80, v80
    v_dot2c_f32_bf16 v16, v81, v4
    v_dot2c_f32_bf16 v17, v81, v81
    v_dot2c_f32_bf16 v16, v82, v4
    v_dot2c_f32_bf16 v17, v82, v82
    v_dot2c_f32_bf16 v16, v83, v4
    v_dot2c_f32_bf16 v17, v83, v83
    s_waitcnt vmcnt(19)
    v_dot2c_f32_bf16 v16, v84, v4
    v_dot2c_f32_bf16 v17, v84, v84
    v_dot2c_f32_bf16 v16, v85, v4
    v_dot2c_f32_bf16 v17, v85, v85
    v_dot2c_f32_bf16 v16, v86, v4
    v_dot2c_f32_bf16 v17, v86, v86
    v_dot2c_f32_bf16 v16, v87, v4
    v_dot2c_f32_bf16 v17, v87, v87
    s_waitcnt vmcnt(18)
    v_dot2c_f32_bf16 v16, v88, v4
    v_dot2c_f32_bf16 v17, v88, v88
    v_dot2c_f32_bf16 v16, v89, v4
    v_dot2c_f32_bf16 v17, v89, v89
    v_dot2c_f32_bf16 v16, v90, v4
    v_dot2c_f32_bf16 v17, v90, v90
    v_dot2c_f32_bf16 v16, v91, v4
    v_dot2c_f32_bf16 v17, v91, v91
    s_waitcnt vmcnt(17)
    v_dot2c_f32_bf16 v16, v92, v4
    v_dot2c_f32_bf16 v17, v92, v92
    v_dot2c_f32_bf16 v16, v93, v4
    v_dot2c_f32_bf16 v17, v93, v93
    v_dot2c_f32_bf16 v16, v94, v4
    v_dot2c_f32_bf16 v17, v94, v94
    v_dot2c_f32_bf16 v16, v95, v4
    v_dot2c_f32_bf16 v17, v95, v95
    s_waitcnt vmcnt(16)
    v_dot2c_f32_bf16 v16, v96, v4
    v_dot2c_f32_bf16 v17, v96, v96
    v_dot2c_f32_bf16 v16, v97, v4
    v_dot2c_f32_bf16 v17, v97, v97
    v_dot2c_f32_bf16 v16, v98, v4
    v_dot2c_f32_bf16 v17, v98, v98
    v_dot2c_f32_bf16 v16, v99, v4
    v_dot2c_f32_bf16 v17, v99, v99
    s_waitcnt vmcnt(14)
    v_dot2c_f32_bf16 v16, v100, v4
    v_dot2c_f32_bf16 v17, v100, v100
    v_dot2c_f32_bf16 v16, v101, v4
    v_dot2c_f32_bf16 v17, v101, v101
    v_dot2c_f32_bf16 v16, v102, v4
    v_dot2c_f32_bf16 v17, v102, v102
    v_dot2c_f32_bf16 v16, v103, v4
    v_dot2c_f32_bf16 v17, v103, v103
    s_waitcnt vmcnt(13)
    v_dot2c_f32_bf16 v16, v104, v4
    v_dot2c_f32_bf16 v17, v104, v104
    v_dot2c_f32_bf16 v16, v105, v4
    v_dot2c_f32_bf16 v17, v105, v105
    v_dot2c_f32_bf16 v16, v106, v4
    v_dot2c_f32_bf16 v17, v106, v106
    v_dot2c_f32_bf16 v16, v107, v4
    v_dot2c_f32_bf16 v17, v107, v107
    s_waitcnt vmcnt(12)
    v_dot2c_f32_bf16 v16, v108, v4
    v_dot2c_f32_bf16 v17, v108, v108
    v_dot2c_f32_bf16 v16, v109, v4
    v_dot2c_f32_bf16 v17, v109, v109
    v_dot2c_f32_bf16 v16, v110, v4
    v_dot2c_f32_bf16 v17, v110, v110
    v_dot2c_f32_bf16 v16, v111, v4
    v_dot2c_f32_bf16 v17, v111, v111
    s_waitcnt vmcnt(11)
    v_dot2c_f32_bf16 v16, v112, v4
    v_dot2c_f32_bf16 v17, v112, v112
    v_dot2c_f32_bf16 v16, v113, v4
    v_dot2c_f32_bf16 v17, v113, v113
    v_dot2c_f32_bf16 v16, v114, v4
    v_dot2c_f32_bf16 v17, v114, v114
    v_dot2c_f32_bf16 v16, v115, v4
    v_dot2c_f32_bf16 v17, v115, v115
    s_waitcnt vmcnt(10)
    v_dot2c_f32_bf16 v16, v116, v4
    v_dot2c_f32_bf16 v17, v116, v116
    v_dot2c_f32_bf16 v16, v117, v4
    v_dot2c_f32_bf16 v17, v117, v117
    v_dot2c_f32_bf16 v16, v118, v4
    v_dot2c_f32_bf16 v17, v118, v118
    v_dot2c_f32_bf16 v16, v119, v4
    v_dot2c_f32_bf16 v17, v119, v119
    s_waitcnt vmcnt(9)
    v_dot2c_f32_bf16 v18, v120, v4
    v_dot2c_f32_bf16 v19, v120, v120
    v_dot2c_f32_bf16 v18, v121, v4
    v_dot2c_f32_bf16 v19, v121, v121
    v_dot2c_f32_bf16 v18, v122, v4
    v_dot2c_f32_bf16 v19, v122, v122
    v_dot2c_f32_bf16 v18, v123, v4
    v_dot2c_f32_bf16 v19, v123, v123
    s_waitcnt vmcnt(8)
    v_dot2c_f32_bf16 v18, v124, v4
    v_dot2c_f32_bf16 v19, v124, v124
    v_dot2c_f32_bf16 v18, v125, v4
    v_dot2c_f32_bf16 v19, v125, v125
    v_dot2c_f32_bf16 v18, v126, v4
    v_dot2c_f32_bf16 v19, v126, v126
    v_dot2c_f32_bf16 v18, v127, v4
    v_dot2c_f32_bf16 v19, v127, v127
    s_waitcnt vmcnt(7)
    v_dot2c_f32_bf16 v18, v128, v4
    v_dot2c_f32_bf16 v19, v128, v128
    v_dot2c_f32_bf16 v18, v129, v4
    v_dot2c_f32_bf16 v19, v129, v129
    v_dot2c_f32_bf16 v18, v130, v4
    v_dot2c_f32_bf16 v19, v130, v130
    v_dot2c_f32_bf16 v18, v131, v4
    v_dot2c_f32_bf16 v19, v131, v131
    s_waitcnt vmcnt(6)
    v_dot2c_f32_bf16 v18, v132, v4
    v_dot2c_f32_bf16 v19, v132, v132
    v_dot2c_f32_bf16 v18, v133, v4
    v_dot2c_f32_bf16 v19, v133, v133
    v_dot2c_f32_bf16 v18, v134, v4
    v_dot2c_f32_bf16 v19, v134, v134
    v_dot2c_f32_bf16 v18, v135, v4
    v_dot2c_f32_bf16 v19, v135, v135
    s_waitcnt vmcnt(5)
    v_dot2c_f32_bf16 v18, v136, v4
    v_dot2c_f32_bf16 v19, v136, v136
    v_dot2c_f32_bf16 v18, v137, v4
    v_dot2c_f32_bf16 v19, v137, v137
    v_dot2c_f32_bf16 v18, v138, v4
    v_dot2c_f32_bf16 v19, v138, v138
    v_dot2c_f32_bf16 v18, v139, v4
    v_dot2c_f32_bf16 v19, v139, v139
    s_waitcnt vmcnt(4)
    v_dot2c_f32_bf16 v18, v140, v4
    v_dot2c_f32_bf16 v19, v140, v140
    v_dot2c_f32_bf16 v18, v141, v4
    v_dot2c_f32_bf16 v19, v141, v141
    v_dot2c_f32_bf16 v18, v142, v4
    v_dot2c_f32_bf16 v19, v142, v142
    v_dot2c_f32_bf16 v18, v143, v4
    v_dot2c_f32_bf16 v19, v143, v143
    s_waitcnt vmcnt(3)
    v_dot2c_f32_bf16 v18, v144, v4
    v_dot2c_f32_bf16 v19, v144, v144
    v_dot2c_f32_bf16 v18, v145, v4
    v_dot2c_f32_bf16 v19, v145, v145
    v_dot2c_f32_bf16 v18, v146, v4
    v_dot2c_f32_bf16 v19, v146, v146
    v_dot2c_f32_bf16 v18, v147, v4
    v_dot2c_f32_bf16 v19, v147, v147
    s_waitcnt vmcnt(2)
    v_dot2c_f32_bf16 v18, v148, v4
    v_dot2c_f32_bf16 v19, v148, v148
    v_dot2c_f32_bf16 v18, v149, v4
    v_dot2c_f32_bf16 v19, v149, v149
    v_dot2c_f32_bf16 v18, v150, v4
    v_dot2c_f32_bf16 v19, v150, v150
    v_dot2c_f32_bf16 v18, v151, v4
    v_dot2c_f32_bf16 v19, v151, v151
    s_waitcnt vmcnt(1)
    v_dot2c_f32_bf16 v18, v152, v4
    v_dot2c_f32_bf16 v19, v152, v152
    v_dot2c_f32_bf16 v18, v153, v4
    v_dot2c_f32_bf16 v19, v153, v153
    v_dot2c_f32_bf16 v18, v154, v4
    v_dot2c_f32_bf16 v19, v154, v154
    v_dot2c_f32_bf16 v18, v155, v4
    v_dot2c_f32_bf16 v19, v155, v155
    s_waitcnt vmcnt(0)
    v_dot2c_f32_bf16 v18, v156, v4
    v_dot2c_f32_bf16 v19, v156, v156
    v_dot2c_f32_bf16 v18, v157, v4
    v_dot2c_f32_bf16 v19, v157, v157
    v_dot2c_f32_bf16 v18, v158, v4
    v_dot2c_f32_bf16 v19, v158, v158
    v_dot2c_f32_bf16 v18, v159, v4
    v_dot2c_f32_bf16 v19, v159, v159
    s_mov_b32 s76, 0xf0f0f0f0
    s_mov_b32 s77, 0xf0f0f0f0
    s_nop 0
    v_add_f32_dpp v16, v16, v16 quad_perm:[1,0,3,2] row_mask:0xf bank_mask:0xf
    v_add_f32_dpp v17, v17, v17 quad_perm:[1,0,3,2] row_mask:0xf bank_mask:0xf
    v_add_f32_dpp v18, v18, v18 quad_perm:[1,0,3,2] row_mask:0xf bank_mask:0xf
    v_add_f32_dpp v19, v19, v19 quad_perm:[1,0,3,2] row_mask:0xf bank_mask:0xf
    v_add_f32_dpp v16, v16, v16 quad_perm:[2,3,0,1] row_mask:0xf bank_mask:0xf
    v_add_f32_dpp v17, v17, v17 quad_perm:[2,3,0,1] row_mask:0xf bank_mask:0xf
    v_add_f32_dpp v18, v18, v18 quad_perm:[2,3,0,1] row_mask:0xf bank_mask:0xf
    v_add_f32_dpp v19, v19, v19 quad_perm:[2,3,0,1] row_mask:0xf bank_mask:0xf
    v_add_f32_dpp v16, v16, v16 row_half_mirror row_mask:0xf bank_mask:0xf
    v_add_f32_dpp v17, v17, v17 row_half_mirror row_mask:0xf bank_mask:0xf
    v_add_f32_dpp v18, v18, v18 row_half_mirror row_mask:0xf bank_mask:0xf
    v_add_f32_dpp v19, v19, v19 row_half_mirror row_mask:0xf bank_mask:0xf
    v_cndmask_b32 v18, v16, v18, s[76:77]
    v_cndmask_b32 v19, v17, v19, s[76:77]
    v_mul_f32 v18, 0xbacccccd, v18
    v_mul_f32 v19, 0x3acccccd, v19
    v_fma_f32 v19, -v18, v18, v19
    v_max_f32 v19, 0, v19
    v_add_f32 v19, 0x3727c5ac, v19
    v_rsq_f32 v19, v19
    v_or_b32 v18, 1, v18
    v_or_b32 v19, 1, v19
    s_barrier
    s_mov_b32 exec_lo, 0x11111111
    s_mov_b32 exec_hi, 0x11111111
    buffer_store_dwordx2 v[18:19], v15, s[16:19], s82 offen sc1
    s_mov_b64 exec, -1
    buffer_store_dword v69, off, s[16:19], s64 sc1
    s_add_u32 m0, s78, 0
    s_nop 0
    buffer_load_dwordx4 v24, s[12:15], s79 offen lds
    s_add_u32 m0, s78, 1024
    s_nop 0
    buffer_load_dwordx4 v25, s[12:15], s79 offen lds
    s_add_u32 m0, s78, 2048
    s_nop 0
    buffer_load_dwordx4 v26, s[12:15], s79 offen lds
    s_add_u32 m0, s78, 3072
    s_nop 0
    buffer_load_dwordx4 v27, s[12:15], s79 offen lds
    s_add_u32 m0, s78, 4096
    s_nop 0
    buffer_load_dwordx4 v28, s[12:15], s79 offen lds
    s_cmp_lt_u32 s84, 4
    s_cbranch_scc0 L_sw1
    s_add_u32 m0, s78, 40960
    s_nop 0
    buffer_load_dwordx4 v30, s[12:15], s80 offen lds
    s_add_u32 m0, s78, 41984
    s_nop 0
    buffer_load_dwordx4 v31, s[12:15], s80 offen lds
    s_add_u32 m0, s78, 43008
    s_nop 0
    buffer_load_dwordx4 v32, s[12:15], s80 offen lds
    s_add_u32 m0, s78, 44032
    s_nop 0
    buffer_load_dwordx4 v33, s[12:15], s80 offen lds
    s_add_u32 m0, s78, 45056
    s_nop 0
    buffer_load_dwordx4 v34, s[12:15], s80 offen lds
L_sw1:
    s_lshl_b32 s34, s84, 2
    s_add_u32 s34, s34, s87
    s_lshl_b32 s34, s34, 7
    s_add_u32 s34, s34, 28069888
    buffer_load_dword v74, off, s[16:19], s34 sc1
    buffer_load_dword v67, v68, s[24:27], 0 offen sc1
    s_branch L_setup
L_spw:
    s_mul_i32 s36, s28, 160
    v_lshrrev_b32 v4, 4, v10
    v_bfe_u32 v5, v10, 2, 2
    v_lshl_add_u32 v4, v4, 3, v5
    v_mul_u32_u24 v4, 1280, v4
    v_add_u32 v4, s36, v4
    v_and_b32 v5, 3, v10
    v_lshl_add_u32 v60, v5, 4, v4
    v_lshl_add_u32 v61, v5, 3, v4
    s_mul_i32 s36, s28, 102400
    s_mul_i32 s37, s84, 5120
    s_add_u32 s36, s36, s37
    s_add_u32 s36, s36, 20316160
    s_add_u32 s38, s36, 81920
    s_add_u32 s37, s36, 4096
    s_add_u32 s39, s38, 4096
    s_lshl_b32 s64, s84, 5
    s_add_u32 s64, s64, s87
    s_lshl_b32 s64, s64, 2
    s_add_u32 s64, s64, 28176384
    s_waitcnt vmcnt(0)
    s_mov_b32 s56, 400000
L_dc44:
    v_cmp_eq_u32 vcc, 0, v67
    s_nop 0
    s_cbranch_vccnz L_dr44
L_do44:
    buffer_load_dword v67, v75, s[16:19], 0 offen sc1
    s_barrier
    ds_read_b64_tr_b16 v[20:21], v60 offset:0
    ds_read_b64_tr_b16 v[22:23], v60 offset:5120
    ds_read_b64_tr_b16 v[24:25], v60 offset:8
    ds_read_b64_tr_b16 v[26:27], v60 offset:5128
    ds_read_b64_tr_b16 v[28:29], v60 offset:64
    ds_read_b64_tr_b16 v[30:31], v60 offset:5184
    ds_read_b64_tr_b16 v[32:33], v60 offset:72
    ds_read_b64_tr_b16 v[34:35], v60 offset:5192
    ds_read_b64_tr_b16 v[36:37], v61 offset:128
    ds_read_b64_tr_b16 v[38:39], v61 offset:5248
    s_waitcnt lgkmcnt(8)
    buffer_store_dwordx4 v[20:23], v1, s[16:19], s36 offen offset:0 sc1
    s_waitcnt lgkmcnt(6)
    buffer_store_dwordx4 v[24:27], v1, s[16:19], s36 offen offset:1024 sc1
    s_waitcnt lgkmcnt(4)
    buffer_store_dwordx4 v[28:31], v1, s[16:19], s36 offen offset:2048 sc1
    s_waitcnt lgkmcnt(2)
    buffer_store_dwordx4 v[32:35], v1, s[16:19], s36 offen offset:3072 sc1
    s_waitcnt lgkmcnt(0)
    buffer_store_dwordx4 v[36:39], v1, s[16:19], s37 offen offset:0 sc1
    s_cmp_lt_u32 s84, 4
    s_cbranch_scc0 L_sw2
    ds_read_b64_tr_b16 v[40:41], v60 offset:40960
    ds_read_b64_tr_b16 v[42:43], v60 offset:46080
    ds_read_b64_tr_b16 v[44:45], v60 offset:40968
    ds_read_b64_tr_b16 v[46:47], v60 offset:46088
    ds_read_b64_tr_b16 v[48:49], v60 offset:41024
    ds_read_b64_tr_b16 v[50:51], v60 offset:46144
    ds_read_b64_tr_b16 v[52:53], v60 offset:41032
    ds_read_b64_tr_b16 v[54:55], v60 offset:46152
    ds_read_b64_tr_b16 v[56:57], v61 offset:41088
    ds_read_b64_tr_b16 v[58:59], v61 offset:46208
    s_waitcnt lgkmcnt(8)
    buffer_store_dwordx4 v[40:43], v1, s[16:19], s38 offen offset:0 sc1
    s_waitcnt lgkmcnt(6)
    buffer_store_dwordx4 v[44:47], v1, s[16:19], s38 offen offset:1024 sc1
    s_waitcnt lgkmcnt(4)
    buffer_store_dwordx4 v[48:51], v1, s[16:19], s38 offen offset:2048 sc1
    s_waitcnt lgkmcnt(2)
    buffer_store_dwordx4 v[52:55], v1, s[16:19], s38 offen offset:3072 sc1
    s_waitcnt lgkmcnt(0)
    buffer_store_dwordx4 v[56:59], v1, s[16:19], s39 offen offset:0 sc1
L_sw2:
    s_waitcnt vmcnt(0)
    s_mov_b32 s56, 400000
L_dc45:
    v_cmp_eq_u32 vcc, 0, v67
    s_nop 0
    s_cbranch_vccnz L_dr45
L_do45:
    v_cmp_ne_u32 vcc, s32, v67
    s_nop 0
    s_cmp_lg_u32 vcc_lo, 0
    s_cselect_b32 s31, 1, 0
    v_mov_b32 v4, 1
    buffer_load_dword v67, v76, s[24:27], 0 offen sc1
    s_barrier
    buffer_store_dword v4, off, s[16:19], s64 sc1
    s_branch L_keys
L_setup:
L_ch0:
    s_lshl_b32 s33, s28, 10
    s_mul_i32 s57, s30, 163840
    s_add_u32 s57, s57, s33
    s_add_u32 s57, s57, 2621440
    s_lshl_b32 s34, s29, 3
    s_add_u32 s34, s34, s28
    s_mul_i32 s63, s34, 110592
    s_mul_i32 s35, s30, 1280
    s_add_u32 s63, s63, s35
    s_add_u32 s63, s63, 13238272
    v_lshlrev_b32 v14, 3, v11
    v_add_u32 v2, 0x10000, v1
    v_add_u32 v3, 0x20000, v1
    v_mul_u32_u24 v5, 2560, v12
    v_add_u32 v5, v5, v14
    s_mov_b32 s4, s36
    s_mov_b32 s5, s37
    s_mov_b32 s6, 2621440
    s_mov_b32 s7, 0x00020000
    s_mov_b32 s8, s50
    s_mov_b32 s9, s51
    s_mov_b32 s10, 2621440
    s_mov_b32 s11, 0x00020000
    v_and_b32 v6, 0x13, v11
    v_bfe_u32 v7, v11, 2, 1
    v_lshl_or_b32 v6, v7, 3, v6
    v_bfe_u32 v7, v11, 3, 1
    v_lshl_or_b32 v6, v7, 2, v6
    v_mul_u32_u24 v7, 320, v12
    v_lshl_add_u32 v13, v6, 4, v7
    v_add_u32 v160, 0, v1
    v_add_u32 v163, 1024, v5
    v_add_u32 v166, 1280, v13
    v_add_u32 v161, 61440, v1
    v_add_u32 v164, 62464, v5
    v_add_u32 v167, 62720, v13
    v_add_u32 v162, 122880, v1
    v_add_u32 v165, 123904, v5
    v_add_u32 v168, 124160, v13
    s_cmp_eq_u32 s95, 1
    s_cbranch_scc1 L_hr0
L_ch1:
    s_mov_b32 s70, 0x000fffff
    s_mov_b32 s71, 0x000fffff
    s_mov_b32 s76, 0x01100000
    s_mov_b32 s77, 0x01100000
    v_mov_b32 v5, 0x3f803f80
    v_mov_b32 v114, 0xdddddddd
    v_cndmask_b32 v128, 0, v5, s[76:77]
    v_mov_b32 v129, v128
    v_mov_b64 v[130:131], v[128:129]
    v_mov_b64 v[132:133], v[128:129]
    v_mov_b64 v[134:135], v[128:129]
    v_mov_b64 v[136:137], v[128:129]
    v_mov_b64 v[138:139], v[128:129]
    v_mov_b64 v[140:141], v[128:129]
    v_mov_b64 v[142:143], v[128:129]
    v_mov_b64 v[144:145], v[128:129]
    v_mov_b64 v[146:147], v[128:129]
    v_mov_b64 v[148:149], v[128:129]
    v_mov_b64 v[150:151], v[128:129]
    v_mov_b64 v[152:153], v[128:129]
    v_mov_b64 v[154:155], v[128:129]
    v_mov_b64 v[156:157], v[128:129]
    v_mov_b64 v[158:159], v[128:129]
    v_mov_b64 v[80:81], 0
    v_mov_b64 v[82:83], 0
    v_mov_b64 v[84:85], 0
    v_mov_b64 v[86:87], 0
    v_mov_b64 v[88:89], 0
    v_mov_b64 v[90:91], 0
    v_mov_b64 v[92:93], 0
    v_mov_b64 v[94:95], 0
    s_lshl_b32 s34, s29, 3
    s_add_u32 s34, s34, s28
    s_mul_i32 s85, s30, 20
    s_add_u32 s86, s85, 19
    s_lshr_b32 s85, s85, 6
    s_lshr_b32 s86, s86, 6
    s_sub_u32 s86, s86, s85
    s_lshl_b32 s96, s34, 5
    s_add_u32 s96, s96, s85
    s_lshl_b32 s96, s96, 2
    s_add_u32 s96, s96, 28069888
    v_and_b32 v15, s86, v10
    v_lshlrev_b32 v15, 2, v15
    v_mov_b32 v127, 1
    s_cmp_eq_u32 s95, 2
    s_cbranch_scc0 L_nf
    s_cmp_lg_u32 s97, 0
    s_waitcnt vmcnt(0)
    s_cbranch_scc1 L_ms46
    buffer_store_dword v127, off, s[16:19], s64
L_mb46:
L_nf:
    s_cmp_eq_u32 s95, 1
    s_cbranch_scc1 L_hr1
L_ch2:
    v_mov_b32 v5, 0x3f803f80
    v_bfe_u32 v4, v10, 1, 1
    v_cmp_eq_u32 vcc, 0, v4
    v_and_b32 v4, 1, v10
    v_mul_u32_u24 v4, 0xaaaa, v4
    v_cndmask_b32 v204, 0, v5, vcc
    v_cndmask_b32 v205, 0, v5, vcc
    v_cndmask_b32 v206, 0, v5, vcc
    v_cndmask_b32 v207, 0, v5, vcc
    v_add_u32 v208, 0x4444, v4
    v_lshl_or_b32 v208, v208, 16, v208
    v_and_b32 v209, 0xf0, v1
    v_mov_b32 v200, 0
    v_mov_b32 v201, 0
    v_mov_b32 v202, 0
    v_mov_b32 v203, 0
    v_mov_b32 v210, 0
    v_mov_b32 v211, 0
    v_mov_b32 v212, 0
    v_mov_b32 v213, 0
    s_and_b32 s65, s30, 3
    s_lshl_b32 s65, s65, 2
    s_add_u32 s65, s65, s87
    s_lshl_b32 s35, s29, 4
    s_add_u32 s65, s65, s35
    s_lshr_b32 s67, s30, 2
    s_and_b32 s66, s30, 1
    s_lshl_b32 s66, s66, 2
    s_add_u32 s66, s66, s87
    s_lshl_b32 s35, s29, 3
    s_add_u32 s66, s66, s35
    s_lshr_b32 s68, s30, 1
    s_mul_i32 s62, s67, 102400
    s_add_u32 s62, s62, 20316160
    s_cmp_eq_u32 s95, 1
    s_cbranch_scc1 L_hr2
L_ch3:
    s_cmp_lt_u32 s2, 112
    s_cbranch_scc0 L_tb
    s_mov_b32 s58, 0
    s_cmp_lt_u32 s28, 4
    s_cselect_b32 s12, s44, s46
    s_cselect_b32 s13, s45, s47
    s_cmp_lt_u32 s2, 108
    s_cselect_b32 s14, 2211840, 0
    s_and_b32 s34, s2, 3
    s_lshl_b32 s34, s34, 2
    s_add_u32 s34, s34, s87
    s_mul_i32 s69, s34, 138240
    s_lshr_b32 s35, s2, 2
    s_lshl_b32 s35, s35, 7
    s_add_u32 s69, s69, s35
    v_lshrrev_b32 v4, 3, v10
    v_mul_u32_u24 v4, 3456, v4
    v_and_b32 v5, 7, v10
    v_bfe_u32 v6, v10, 4, 1
    v_lshlrev_b32 v6, 2, v6
    v_xor_b32 v5, v5, v6
    v_lshl_add_u32 v216, v5, 4, v4
    v_add_u32 v217, 27648, v216
    v_add_u32 v218, 55296, v216
    v_add_u32 v219, 82944, v216
    v_add_u32 v220, 110592, v216
L_tj0:
    s_cmp_eq_u32 s95, 1
    s_cbranch_scc1 L_hr3
    s_cmp_eq_u32 s95, 2
    s_cbranch_scc1 L_ch7
L_ch4:
    s_cmp_lt_u32 s2, 112
    s_cbranch_scc0 L_tb1
    s_and_b32 s34, s2, 0xfc
    s_add_u32 s34, s34, s87
    s_mul_i32 s3, s34, 147
    s_lshr_b32 s3, s3, 10
    s_mul_i32 s59, s3, 294912
    s_add_u32 s59, s59, 21135360
    s_mul_i32 s35, s3, 7
    s_sub_u32 s34, s34, s35
    s_and_b32 s3, s3, 1
    s_sub_u32 s34, s34, s3
    s_min_u32 s34, s34, 6
    s_and_b32 s35, s2, 3
    s_lshr_b32 s78, s28, 2
    s_lshl_b32 s61, s34, 2
    s_add_u32 s61, s61, s35
    s_lshl_b32 s61, s61, 5
    s_add_u32 s61, s61, s78
    s_lshl_b32 s61, s61, 3
    s_add_u32 s61, s61, s59
    s_add_u32 s61, s61, 286720
    s_mul_i32 s3, s35, 35
    s_add_u32 s3, s3, s34
    s_lshl_b32 s3, s3, 1
    s_add_u32 s3, s3, s78
    s_lshl_b32 s3, s3, 10
    s_add_u32 s59, s59, s3
    s_mov_b32 s60, 14336
    s_mul_i32 s78, s78, 20480
    s_and_b32 s3, s28, 1
    s_lshl_b32 s3, s3, 3
    s_add_u32 s78, s78, s3
    s_add_u32 s78, s78, 122880
    s_lshr_b32 s3, s87, 1
    v_lshrrev_b32 v4, 4, v10
    v_bfe_u32 v5, v10, 2, 2
    v_lshl_add_u32 v4, v4, 3, v5
    v_lshl_add_u32 v4, v4, 7, s78
    v_lshrrev_b32 v5, 1, v5
    v_xor_b32 v5, s3, v5
    v_lshl_add_u32 v4, v5, 6, v4
    v_and_b32 v5, 3, v10
    v_lshl_add_u32 v176, v5, 4, v4
L_tj:
    s_cmp_eq_u32 s95, 1
    s_cbranch_scc1 L_hr4
    s_cmp_eq_u32 s95, 2
    s_cbranch_scc1 L_cr4
L_ch5:
    s_lshl_b32 s34, s30, 2
    s_add_u32 s34, s34, s87
    s_mul_i32 s34, s34, 640
    v_lshl_add_u32 v175, v10, 7, s34
    v_min_u32 v175, L_end-sequential_preLN__softmax_full_mha__glu_gated_bilinear__prompt_kernel-128, v175
    s_lshl_b32 s34, s29, 5
    s_add_u32 s34, s34, s30
    s_lshl_b32 s92, s34, 7
    s_add_u32 s92, s92, 28102656
    s_cmp_eq_u32 s28, 0
    s_cselect_b32 s92, s92, 2146435072
    s_lshl_b32 s34, s34, 3
    s_add_u32 s34, s34, s28
    s_mul_i32 s35, s34, 3456
    s_add_u32 s35, s35, 13238272
    s_mul_i32 s34, s34, 1280
    s_add_u32 s34, s34, 10485760
    v_lshl_add_u32 v4, v11, 7, s35
    v_lshl_add_u32 v5, v11, 7, s34
    v_cndmask_b32 v4, v4, v5, s[72:73]
    s_mov_b32 s76, 0x07ffffff
    s_mov_b32 s77, 0x3ff
    v_mov_b32 v6, 2146435072
    v_cndmask_b32 v169, v6, v4, s[76:77]
    s_lshl_b32 s34, s30, 2
    s_add_u32 s34, s34, s87
    s_lshr_b32 s35, s34, 4
    s_lshl_b32 s35, s35, 14
    s_and_b32 s34, s34, 15
    s_lshl_b32 s34, s34, 7
    s_add_u32 s34, s34, s35
    s_lshl_b32 s35, s29, 11
    s_add_u32 s34, s34, s35
    s_add_u32 s34, s34, 13107200
    v_writelane_b32 v169, s34, 42
    s_cmp_eq_u32 s95, 1
    s_cbranch_scc1 L_hr5
    s_cmp_eq_u32 s95, 2
    s_cbranch_scc1 L_cr5
L_ch6:
    s_lshl_b32 s3, s29, 3
    s_add_u32 s3, s3, s28
    s_lshl_b32 s34, s3, 7
    s_add_u32 s34, s34, 28078080
    v_writelane_b32 v169, s34, 43
    s_lshl_b32 s35, s30, 2
    s_add_u32 s78, s34, s35
    s_add_u32 s34, s34, 8192
    v_writelane_b32 v169, s34, 44
    s_add_u32 s34, s34, 8192
    v_writelane_b32 v169, s34, 45
    s_mul_i32 s34, s3, 110592
    s_add_u32 s34, s34, 13238272
    s_lshl_b32 s35, s30, 9
    s_add_u32 s79, s34, s35
    s_lshr_b32 s35, s30, 1
    s_lshl_b32 s35, s35, 8
    s_add_u32 s34, s34, s35
    s_and_b32 s35, s30, 1
    s_lshl_b32 s35, s35, 3
    s_add_u32 s34, s34, s35
    s_add_u32 s80, s34, 16384
    s_cmp_eq_u32 s95, 1
    s_cbranch_scc1 L_hr6
    s_cmp_eq_u32 s95, 2
    s_cbranch_scc1 L_cr6
L_ch7:
    v_mov_b32 v6, 2146435072
    v_bfe_u32 v4, v10, 4, 1
    v_mul_u32_u24 v4, 20480, v4
    v_and_b32 v5, 15, v10
    v_lshl_add_u32 v4, v5, 4, v4
    v_lshl_add_u32 v173, v12, 8, v4
    v_cndmask_b32 v174, v4, v6, s[72:73]
    v_mul_u32_u24 v4, 1280, v5
    v_lshrrev_b32 v5, 4, v10
    v_lshl_add_u32 v171, v5, 4, v4
    v_lshl_add_u32 v172, v5, 3, v4
    s_mul_i32 s93, s65, 20480
    s_mul_i32 s35, s67, 160
    s_add_u32 s93, s93, s35
    s_cmp_lt_u32 s28, 4
    s_cselect_b32 s93, s93, 2146435072
    s_lshl_b32 s81, s28, 12
    v_lshl_add_u32 v170, v11, 7, s81
    s_mov_b32 s81, 28102656
    s_mov_b32 s83, 28135424
    s_mul_i32 s94, s68, 294912
    s_add_u32 s94, s94, 21032960
    s_lshl_b32 s34, s87, 10
    v_add_u32 v115, s34, v1
    s_mov_b32 s15, 0x00020000
    s_mul_i32 s90, s28, 5120
    s_cmp_eq_u32 s95, 1
    s_cbranch_scc1 L_hr7
L_ch8:
    s_mul_i32 s34, s30, 20
    s_add_u32 s35, s34, 19
    s_lshr_b32 s34, s34, 6
    s_lshr_b32 s35, s35, 6
    s_sub_u32 s35, s35, s34
    v_bfe_u32 v4, v10, 3, 1
    v_and_b32 v4, s35, v4
    v_bfe_u32 v5, v10, 4, 1
    v_mad_u32_u24 v4, v5, 10, v4
    v_add_lshl_u32 v4, v4, s34, 2
    v_bfe_u32 v5, v10, 1, 2
    v_add_lshl_u32 v4, v4, v5, 1
    s_lshr_b32 s34, s30, 4
    s_xor_b32 s34, s34, 1
    v_xor_b32 v5, s34, v12
    v_add_lshl_u32 v4, v4, v5, 1
    v_and_b32 v5, 1, v10
    v_add_lshl_u32 v179, v4, v5, 7
    v_and_b32 v5, 15, v10
    v_lshlrev_b32 v5, 7, v5
    v_add_u32 v5, 40960, v5
    v_cndmask_b32 v126, v5, v179, s[72:73]
    s_cmp_eq_u32 s95, 1
    s_cbranch_scc1 L_hr8
    s_cmp_eq_u32 s95, 2
    s_cbranch_scc1 L_kd
    s_branch L_spw
L_keys:
    s_cmp_eq_u32 s28, 4
    s_cbranch_scc0 L_kd
    s_mov_b32 s83, 28135424
    s_mul_i32 s82, s30, 163840
    s_waitcnt vmcnt(0)
    s_mov_b32 s56, 400000
L_dc47:
    v_cmp_eq_u32 vcc, 0, v67
    s_nop 0
    s_cbranch_vccnz L_dr47
L_do47:
    s_mov_b32 exec_hi, 0
    s_mov_b32 s56, 400000
    s_branch L_pin48
L_poll48:
    s_sleep 1
L_pin48:
    buffer_load_dwordx4 v[16:19], v179, s[16:19], s83 offen sc1
    s_sub_u32 s56, s56, 1
    s_waitcnt vmcnt(0)
    v_min3_u32 v16, v16, v17, v18
    v_min_u32 v16, v16, v19
    v_cmp_eq_u32 vcc, 0, v16
    s_cbranch_scc1 L_pout48
    s_cbranch_vccnz L_poll48
L_pout48:
    s_mov_b32 exec_hi, -1
    s_mov_b32 m0, 0
    s_add_u32 s34, s82, 2621440
    buffer_load_dwordx4 v1, s[16:19], s34 offen offset:0 sc1 lds
    buffer_load_dwordx4 v1, s[16:19], s34 offen offset:1024 sc1 lds
    buffer_load_dwordx4 v1, s[16:19], s34 offen offset:2048 sc1 lds
    buffer_load_dwordx4 v1, s[16:19], s34 offen offset:3072 sc1 lds
    s_mov_b32 m0, 4096
    s_add_u32 s34, s82, 2625536
    buffer_load_dwordx4 v1, s[16:19], s34 offen offset:0 sc1 lds
    buffer_load_dwordx4 v1, s[16:19], s34 offen offset:1024 sc1 lds
    buffer_load_dwordx4 v1, s[16:19], s34 offen offset:2048 sc1 lds
    buffer_load_dwordx4 v1, s[16:19], s34 offen offset:3072 sc1 lds
    s_mov_b32 m0, 8192
    s_add_u32 s34, s82, 2629632
    buffer_load_dwordx4 v1, s[16:19], s34 offen offset:0 sc1 lds
    buffer_load_dwordx4 v1, s[16:19], s34 offen offset:1024 sc1 lds
    buffer_load_dwordx4 v1, s[16:19], s34 offen offset:2048 sc1 lds
    buffer_load_dwordx4 v1, s[16:19], s34 offen offset:3072 sc1 lds
    s_mov_b32 m0, 12288
    s_add_u32 s34, s82, 2633728
    buffer_load_dwordx4 v1, s[16:19], s34 offen offset:0 sc1 lds
    buffer_load_dwordx4 v1, s[16:19], s34 offen offset:1024 sc1 lds
    buffer_load_dwordx4 v1, s[16:19], s34 offen offset:2048 sc1 lds
    buffer_load_dwordx4 v1, s[16:19], s34 offen offset:3072 sc1 lds
L_kd:
    s_mov_b32 s56, 400000
L_poll49:
    buffer_load_dword v8, v15, s[16:19], s96 offen sc1
    s_sub_u32 s56, s56, 1
    s_waitcnt vmcnt(0)
    v_cmp_eq_u32 vcc, 0, v8
    s_cbranch_scc1 L_pout49
    s_cbranch_vccnz L_poll49
L_pout49:
    buffer_load_dwordx4 v[96:99], v1, s[16:19], s63 offen sc1
    buffer_load_dwordx2 v[100:101], v14, s[16:19], s63 offen offset:1024 sc1
    s_mov_b32 s56, 400000
    s_waitcnt vmcnt(0)
    v_cndmask_b32 v102, 0, v100, s[72:73]
    v_cndmask_b32 v103, 0, v101, s[72:73]
    v_cndmask_b32 v100, v100, 0, s[72:73]
    v_cndmask_b32 v101, v101, 0, s[72:73]
    s_barrier
    s_add_u32 m0, s33, 16384
    s_add_u32 s34, s57, 16384
    buffer_load_dwordx4 v1, s[16:19], s34 offen sc1 lds
    ds_read_b64 v[112:113], v163 offset:0
    ds_read_b128 v[104:107], v160 offset:0
    ds_read_b128 v[108:111], v160 offset:2560
    s_mov_b64 exec, s[70:71]
    ds_read_b128 v[128:131], v166 offset:0
    ds_read_b128 v[132:135], v166 offset:640
    ds_read_b128 v[136:139], v166 offset:2560
    ds_read_b128 v[140:143], v166 offset:3200
    s_mov_b64 exec, -1
    ds_read_b64 v[124:125], v163 offset:5120
    ds_read_b128 v[116:119], v160 offset:5120
    ds_read_b128 v[120:123], v160 offset:7680
    s_waitcnt lgkmcnt(7)
    v_mfma_f32_32x32x8_bf16 v[16:31], v[112:113], v[100:101], 0
    v_mfma_f32_32x32x16_bf16 v[16:31], v[104:107], v[96:99], v[16:31]
    v_mfma_f32_32x32x8_bf16 v[32:47], v[112:113], v[102:103], 0
    v_mfma_f32_32x32x16_bf16 v[32:47], v[108:111], v[96:99], v[32:47]
    s_nop 9
    s_setprio 3
    v_exp_f32 v16, v16
    v_exp_f32 v17, v17
    s_mov_b64 exec, s[70:71]
    ds_read_b128 v[144:147], v166 offset:5120
    ds_read_b128 v[148:151], v166 offset:5760
    ds_read_b128 v[152:155], v166 offset:7680
    ds_read_b128 v[156:159], v166 offset:8320
    s_mov_b64 exec, -1
    v_exp_f32 v18, v18
    v_exp_f32 v19, v19
    v_exp_f32 v20, v20
    v_exp_f32 v21, v21
    s_waitcnt lgkmcnt(4)
    v_mfma_f32_32x32x8_bf16 v[48:63], v[124:125], v[100:101], 0
    v_exp_f32 v22, v22
    v_exp_f32 v23, v23
    v_exp_f32 v24, v24
    v_exp_f32 v25, v25
    v_smfmac_f32_32x32x32_bf16 v[80:95], v[128:131], v[16:23], v114
    s_add_u32 m0, s33, 24576
    s_add_u32 s34, s57, 24576
    buffer_load_dwordx4 v1, s[16:19], s34 offen sc1 lds
    v_exp_f32 v26, v26
    v_exp_f32 v27, v27
    v_exp_f32 v28, v28
    v_exp_f32 v29, v29
    v_mfma_f32_32x32x16_bf16 v[48:63], v[116:119], v[96:99], v[48:63]
    buffer_load_dwordx4 v[246:249], v171, s[4:7], s93 offen
    v_exp_f32 v30, v30
    v_exp_f32 v31, v31
    v_exp_f32 v32, v32
    v_exp_f32 v33, v33
    v_smfmac_f32_32x32x32_bf16 v[80:95], v[132:135], v[24:31], v114
    ds_read_b64 v[112:113], v163 offset:10240
    ds_read_b128 v[104:107], v160 offset:10240
    ds_read_b128 v[108:111], v160 offset:12800
    v_exp_f32 v34, v34
    v_exp_f32 v35, v35
    v_exp_f32 v36, v36
    v_exp_f32 v37, v37
    v_mfma_f32_32x32x8_bf16 v[64:79], v[124:125], v[102:103], 0
    v_exp_f32 v38, v38
    v_exp_f32 v39, v39
    v_exp_f32 v40, v40
    s_setprio 2
    v_exp_f32 v41, v41
    v_smfmac_f32_32x32x32_bf16 v[80:95], v[136:139], v[32:39], v114
    s_add_u32 m0, s33, 32768
    s_add_u32 s34, s57, 32768
    buffer_load_dwordx4 v1, s[16:19], s34 offen sc1 lds
    v_exp_f32 v42, v42
    v_exp_f32 v43, v43
    v_exp_f32 v44, v44
    v_exp_f32 v45, v45
    v_mfma_f32_32x32x16_bf16 v[64:79], v[120:123], v[96:99], v[64:79]
    s_waitcnt lgkmcnt(0)
    v_exp_f32 v46, v46
    v_exp_f32 v47, v47
    v_exp_f32 v48, v48
    v_exp_f32 v49, v49
    v_smfmac_f32_32x32x32_bf16 v[80:95], v[140:143], v[40:47], v114
    s_mov_b64 exec, s[70:71]
    ds_read_b128 v[128:131], v166 offset:10240
    ds_read_b128 v[132:135], v166 offset:10880
    ds_read_b128 v[136:139], v166 offset:12800
    ds_read_b128 v[140:143], v166 offset:13440
    s_mov_b64 exec, -1
    v_exp_f32 v50, v50
    v_exp_f32 v51, v51
    v_exp_f32 v52, v52
    v_exp_f32 v53, v53
    v_mfma_f32_32x32x8_bf16 v[16:31], v[112:113], v[100:101], 0
    s_setprio 1
    v_exp_f32 v54, v54
    v_exp_f32 v55, v55
    v_exp_f32 v56, v56
    v_exp_f32 v57, v57
    v_smfmac_f32_32x32x32_bf16 v[80:95], v[144:147], v[48:55], v114
    s_add_u32 m0, s33, 40960
    s_add_u32 s34, s57, 40960
    buffer_load_dwordx4 v1, s[16:19], s34 offen sc1 lds
    v_exp_f32 v58, v58
    v_exp_f32 v59, v59
    s_setprio 0
    v_exp_f32 v60, v60
    v_exp_f32 v61, v61
    v_mfma_f32_32x32x16_bf16 v[16:31], v[104:107], v[96:99], v[16:31]
    buffer_load_dwordx4 v[250:253], v171, s[4:7], s93 offen offset:64
    v_exp_f32 v62, v62
    v_exp_f32 v63, v63
    v_exp_f32 v64, v64
    v_exp_f32 v65, v65
    v_smfmac_f32_32x32x32_bf16 v[80:95], v[148:151], v[56:63], v114
    s_waitcnt vmcnt(5) lgkmcnt(0)
    s_barrier
    s_setprio 3
    ds_read_b64 v[124:125], v163 offset:15360
    ds_read_b128 v[116:119], v160 offset:15360
    ds_read_b128 v[120:123], v160 offset:17920
    v_exp_f32 v66, v66
    v_exp_f32 v67, v67
    v_exp_f32 v68, v68
    v_exp_f32 v69, v69
    v_mfma_f32_32x32x8_bf16 v[32:47], v[112:113], v[102:103], 0
    v_exp_f32 v70, v70
    v_exp_f32 v71, v71
    v_exp_f32 v72, v72
    v_exp_f32 v73, v73
    v_smfmac_f32_32x32x32_bf16 v[80:95], v[152:155], v[64:71], v114
    v_exp_f32 v74, v74
    v_exp_f32 v75, v75
    v_exp_f32 v76, v76
    v_exp_f32 v77, v77
    v_mfma_f32_32x32x16_bf16 v[32:47], v[108:111], v[96:99], v[32:47]
    s_waitcnt lgkmcnt(0)
    v_exp_f32 v78, v78
    v_exp_f32 v79, v79
    v_exp_f32 v16, v16
    v_exp_f32 v17, v17
    v_smfmac_f32_32x32x32_bf16 v[80:95], v[156:159], v[72:79], v114
    s_mov_b64 exec, s[70:71]
    ds_read_b128 v[144:147], v166 offset:15360
    ds_read_b128 v[148:151], v166 offset:16000
    ds_read_b128 v[152:155], v166 offset:17920
    ds_read_b128 v[156:159], v166 offset:18560
    s_mov_b64 exec, -1
    s_setprio 2
    v_exp_f32 v18, v18
    v_exp_f32 v19, v19
    v_exp_f32 v20, v20
    v_exp_f32 v21, v21
    v_mfma_f32_32x32x8_bf16 v[48:63], v[124:125], v[100:101], 0
    v_exp_f32 v22, v22
    v_exp_f32 v23, v23
    v_exp_f32 v24, v24
    v_exp_f32 v25, v25
    v_smfmac_f32_32x32x32_bf16 v[80:95], v[128:131], v[16:23], v114
    s_add_u32 m0, s33, 49152
    s_add_u32 s34, s57, 49152
    buffer_load_dwordx4 v1, s[16:19], s34 offen sc1 lds
    s_setprio 1
    v_exp_f32 v26, v26
    v_exp_f32 v27, v27
    v_exp_f32 v28, v28
    v_exp_f32 v29, v29
    v_mfma_f32_32x32x16_bf16 v[48:63], v[116:119], v[96:99], v[48:63]
    buffer_load_dwordx2 v[254:255], v172, s[4:7], s93 offen offset:128
    s_setprio 0
    v_exp_f32 v30, v30
    v_exp_f32 v31, v31
    v_exp_f32 v32, v32
    v_exp_f32 v33, v33
    v_smfmac_f32_32x32x32_bf16 v[80:95], v[132:135], v[24:31], v114
    s_waitcnt vmcnt(6) lgkmcnt(0)
    s_barrier
    s_setprio 3
    ds_read_b64 v[112:113], v163 offset:20480
    ds_read_b128 v[104:107], v160 offset:20480
    ds_read_b128 v[108:111], v160 offset:23040
    v_exp_f32 v34, v34
    v_exp_f32 v35, v35
    v_exp_f32 v36, v36
    v_exp_f32 v37, v37
    v_mfma_f32_32x32x8_bf16 v[64:79], v[124:125], v[102:103], 0
    v_exp_f32 v38, v38
    v_exp_f32 v39, v39
    v_exp_f32 v40, v40
    v_exp_f32 v41, v41
    v_smfmac_f32_32x32x32_bf16 v[80:95], v[136:139], v[32:39], v114
    v_exp_f32 v42, v42
    v_exp_f32 v43, v43
    v_exp_f32 v44, v44
    v_exp_f32 v45, v45
    v_mfma_f32_32x32x16_bf16 v[64:79], v[120:123], v[96:99], v[64:79]
    s_waitcnt lgkmcnt(0)
    v_exp_f32 v46, v46
    v_exp_f32 v47, v47
    v_exp_f32 v48, v48
    v_exp_f32 v49, v49
    v_smfmac_f32_32x32x32_bf16 v[80:95], v[140:143], v[40:47], v114
    s_mov_b64 exec, s[70:71]
    ds_read_b128 v[128:131], v166 offset:20480
    ds_read_b128 v[132:135], v166 offset:21120
    ds_read_b128 v[136:139], v166 offset:23040
    ds_read_b128 v[140:143], v166 offset:23680
    s_mov_b64 exec, -1
    v_exp_f32 v50, v50
    v_exp_f32 v51, v51
    v_exp_f32 v52, v52
    v_exp_f32 v53, v53
    v_mfma_f32_32x32x8_bf16 v[16:31], v[112:113], v[100:101], 0
    v_exp_f32 v54, v54
    v_exp_f32 v55, v55
    v_exp_f32 v56, v56
    v_exp_f32 v57, v57
    v_smfmac_f32_32x32x32_bf16 v[80:95], v[144:147], v[48:55], v114
    s_add_u32 m0, s33, 57344
    s_add_u32 s34, s57, 57344
    buffer_load_dwordx4 v1, s[16:19], s34 offen sc1 lds
    v_exp_f32 v58, v58
    v_exp_f32 v59, v59
    v_exp_f32 v60, v60
    v_exp_f32 v61, v61
    v_mfma_f32_32x32x16_bf16 v[16:31], v[104:107], v[96:99], v[16:31]
    v_exp_f32 v62, v62
    v_exp_f32 v63, v63
    v_exp_f32 v64, v64
    v_exp_f32 v65, v65
    v_smfmac_f32_32x32x32_bf16 v[80:95], v[148:151], v[56:63], v114
    ds_read_b64 v[124:125], v163 offset:25600
    ds_read_b128 v[116:119], v160 offset:25600
    ds_read_b128 v[120:123], v160 offset:28160
    s_setprio 2
    v_exp_f32 v66, v66
    v_exp_f32 v67, v67
    v_exp_f32 v68, v68
    v_exp_f32 v69, v69
    v_mfma_f32_32x32x8_bf16 v[32:47], v[112:113], v[102:103], 0
    v_exp_f32 v70, v70
    v_exp_f32 v71, v71
    v_exp_f32 v72, v72
    v_exp_f32 v73, v73
    v_smfmac_f32_32x32x32_bf16 v[80:95], v[152:155], v[64:71], v114
    v_exp_f32 v74, v74
    v_exp_f32 v75, v75
    v_exp_f32 v76, v76
    v_exp_f32 v77, v77
    v_mfma_f32_32x32x16_bf16 v[32:47], v[108:111], v[96:99], v[32:47]
    s_waitcnt lgkmcnt(0)
    v_exp_f32 v78, v78
    v_exp_f32 v79, v79
    v_exp_f32 v16, v16
    v_exp_f32 v17, v17
    v_smfmac_f32_32x32x32_bf16 v[80:95], v[156:159], v[72:79], v114
    s_mov_b64 exec, s[70:71]
    ds_read_b128 v[144:147], v166 offset:25600
    ds_read_b128 v[148:151], v166 offset:26240
    ds_read_b128 v[152:155], v166 offset:28160
    ds_read_b128 v[156:159], v166 offset:28800
    s_mov_b64 exec, -1
    s_setprio 1
    v_exp_f32 v18, v18
    v_exp_f32 v19, v19
    v_exp_f32 v20, v20
    v_exp_f32 v21, v21
    v_mfma_f32_32x32x8_bf16 v[48:63], v[124:125], v[100:101], 0
    v_exp_f32 v22, v22
    v_exp_f32 v23, v23
    v_exp_f32 v24, v24
    v_exp_f32 v25, v25
    v_smfmac_f32_32x32x32_bf16 v[80:95], v[128:131], v[16:23], v114
    s_add_u32 m0, s33, 65536
    s_add_u32 s34, s57, 65536
    buffer_load_dwordx4 v1, s[16:19], s34 offen sc1 lds
    s_setprio 0
    v_exp_f32 v26, v26
    v_exp_f32 v27, v27
    v_exp_f32 v28, v28
    v_exp_f32 v29, v29
    v_mfma_f32_32x32x16_bf16 v[48:63], v[116:119], v[96:99], v[48:63]
    v_exp_f32 v30, v30
    v_exp_f32 v31, v31
    v_exp_f32 v32, v32
    v_exp_f32 v33, v33
    v_smfmac_f32_32x32x32_bf16 v[80:95], v[132:135], v[24:31], v114
    s_waitcnt vmcnt(6) lgkmcnt(0)
    s_barrier
    s_setprio 3
    ds_read_b64 v[112:113], v163 offset:30720
    ds_read_b128 v[104:107], v160 offset:30720
    ds_read_b128 v[108:111], v160 offset:33280
    v_exp_f32 v34, v34
    v_exp_f32 v35, v35
    v_exp_f32 v36, v36
    v_exp_f32 v37, v37
    v_mfma_f32_32x32x8_bf16 v[64:79], v[124:125], v[102:103], 0
    v_exp_f32 v38, v38
    v_exp_f32 v39, v39
    v_exp_f32 v40, v40
    v_exp_f32 v41, v41
    v_smfmac_f32_32x32x32_bf16 v[80:95], v[136:139], v[32:39], v114
    v_exp_f32 v42, v42
    v_exp_f32 v43, v43
    v_exp_f32 v44, v44
    v_exp_f32 v45, v45
    v_mfma_f32_32x32x16_bf16 v[64:79], v[120:123], v[96:99], v[64:79]
    s_waitcnt lgkmcnt(0)
    v_exp_f32 v46, v46
    v_exp_f32 v47, v47
    v_exp_f32 v48, v48
    v_exp_f32 v49, v49
    v_smfmac_f32_32x32x32_bf16 v[80:95], v[140:143], v[40:47], v114
    s_mov_b64 exec, s[70:71]
    ds_read_b128 v[128:131], v166 offset:30720
    ds_read_b128 v[132:135], v166 offset:31360
    ds_read_b128 v[136:139], v166 offset:33280
    ds_read_b128 v[140:143], v166 offset:33920
    s_mov_b64 exec, -1
    v_exp_f32 v50, v50
    v_exp_f32 v51, v51
    v_exp_f32 v52, v52
    v_exp_f32 v53, v53
    v_mfma_f32_32x32x8_bf16 v[16:31], v[112:113], v[100:101], 0
    v_exp_f32 v54, v54
    v_exp_f32 v55, v55
    v_exp_f32 v56, v56
    v_exp_f32 v57, v57
    v_smfmac_f32_32x32x32_bf16 v[80:95], v[144:147], v[48:55], v114
    s_add_u32 m0, s33, 73728
    s_add_u32 s34, s57, 73728
    buffer_load_dwordx4 v1, s[16:19], s34 offen sc1 lds
    v_exp_f32 v58, v58
    v_exp_f32 v59, v59
    v_exp_f32 v60, v60
    v_exp_f32 v61, v61
    v_mfma_f32_32x32x16_bf16 v[16:31], v[104:107], v[96:99], v[16:31]
    buffer_load_dwordx4 v[224:227], v126, s[16:19], s83 offen sc1
    v_exp_f32 v62, v62
    v_exp_f32 v63, v63
    v_exp_f32 v64, v64
    v_exp_f32 v65, v65
    v_smfmac_f32_32x32x32_bf16 v[80:95], v[148:151], v[56:63], v114
    ds_read_b64 v[124:125], v163 offset:35840
    ds_read_b128 v[116:119], v160 offset:35840
    ds_read_b128 v[120:123], v160 offset:38400
    s_setprio 2
    v_exp_f32 v66, v66
    v_exp_f32 v67, v67
    v_exp_f32 v68, v68
    v_exp_f32 v69, v69
    v_mfma_f32_32x32x8_bf16 v[32:47], v[112:113], v[102:103], 0
    v_exp_f32 v70, v70
    v_exp_f32 v71, v71
    v_exp_f32 v72, v72
    v_exp_f32 v73, v73
    v_smfmac_f32_32x32x32_bf16 v[80:95], v[152:155], v[64:71], v114
    v_exp_f32 v74, v74
    v_exp_f32 v75, v75
    v_exp_f32 v76, v76
    v_exp_f32 v77, v77
    v_mfma_f32_32x32x16_bf16 v[32:47], v[108:111], v[96:99], v[32:47]
    s_waitcnt lgkmcnt(0)
    v_exp_f32 v78, v78
    v_exp_f32 v79, v79
    v_exp_f32 v16, v16
    v_exp_f32 v17, v17
    v_smfmac_f32_32x32x32_bf16 v[80:95], v[156:159], v[72:79], v114
    s_mov_b64 exec, s[70:71]
    ds_read_b128 v[144:147], v166 offset:35840
    ds_read_b128 v[148:151], v166 offset:36480
    ds_read_b128 v[152:155], v166 offset:38400
    ds_read_b128 v[156:159], v166 offset:39040
    s_mov_b64 exec, -1
    s_setprio 1
    v_exp_f32 v18, v18
    v_exp_f32 v19, v19
    v_exp_f32 v20, v20
    v_exp_f32 v21, v21
    v_mfma_f32_32x32x8_bf16 v[48:63], v[124:125], v[100:101], 0
    v_exp_f32 v22, v22
    v_exp_f32 v23, v23
    v_exp_f32 v24, v24
    v_exp_f32 v25, v25
    v_smfmac_f32_32x32x32_bf16 v[80:95], v[128:131], v[16:23], v114
    s_setprio 0
    v_exp_f32 v26, v26
    v_exp_f32 v27, v27
    v_exp_f32 v28, v28
    v_exp_f32 v29, v29
    v_mfma_f32_32x32x16_bf16 v[48:63], v[116:119], v[96:99], v[48:63]
    s_add_u32 m0, s90, 122880
    s_nop 0
    buffer_load_dwordx4 v216, s[12:15], s69 offen lds
    v_exp_f32 v30, v30
    v_exp_f32 v31, v31
    v_exp_f32 v32, v32
    v_exp_f32 v33, v33
    v_smfmac_f32_32x32x32_bf16 v[80:95], v[132:135], v[24:31], v114
    s_waitcnt vmcnt(6) lgkmcnt(0)
    s_barrier
    s_setprio 3
    ds_read_b64 v[112:113], v163 offset:40960
    ds_read_b128 v[104:107], v160 offset:40960
    ds_read_b128 v[108:111], v160 offset:43520
    v_exp_f32 v34, v34
    v_exp_f32 v35, v35
    v_exp_f32 v36, v36
    v_exp_f32 v37, v37
    v_mfma_f32_32x32x8_bf16 v[64:79], v[124:125], v[102:103], 0
    v_exp_f32 v38, v38
    v_exp_f32 v39, v39
    v_exp_f32 v40, v40
    v_exp_f32 v41, v41
    v_smfmac_f32_32x32x32_bf16 v[80:95], v[136:139], v[32:39], v114
    s_add_u32 m0, s90, 123904
    s_nop 0
    buffer_load_dwordx4 v217, s[12:15], s69 offen lds
    v_exp_f32 v42, v42
    v_exp_f32 v43, v43
    v_exp_f32 v44, v44
    v_exp_f32 v45, v45
    v_mfma_f32_32x32x16_bf16 v[64:79], v[120:123], v[96:99], v[64:79]
    s_waitcnt lgkmcnt(0)
    v_exp_f32 v46, v46
    v_exp_f32 v47, v47
    v_exp_f32 v48, v48
    v_exp_f32 v49, v49
    v_smfmac_f32_32x32x32_bf16 v[80:95], v[140:143], v[40:47], v114
    s_mov_b64 exec, s[70:71]
    ds_read_b128 v[128:131], v166 offset:40960
    ds_read_b128 v[132:135], v166 offset:41600
    ds_read_b128 v[136:139], v166 offset:43520
    ds_read_b128 v[140:143], v166 offset:44160
    s_mov_b64 exec, -1
    v_exp_f32 v50, v50
    v_exp_f32 v51, v51
    v_exp_f32 v52, v52
    v_exp_f32 v53, v53
    v_mfma_f32_32x32x8_bf16 v[16:31], v[112:113], v[100:101], 0
    v_exp_f32 v54, v54
    v_exp_f32 v55, v55
    v_exp_f32 v56, v56
    v_exp_f32 v57, v57
    v_smfmac_f32_32x32x32_bf16 v[80:95], v[144:147], v[48:55], v114
    s_cmp_eq_u32 s95, 2
    s_cbranch_scc1 L_ch4
L_cr4:
    v_exp_f32 v58, v58
    v_exp_f32 v59, v59
    v_exp_f32 v60, v60
    v_exp_f32 v61, v61
    v_mfma_f32_32x32x16_bf16 v[16:31], v[104:107], v[96:99], v[16:31]
    s_add_u32 m0, s90, 124928
    s_nop 0
    buffer_load_dwordx4 v218, s[12:15], s69 offen lds
    v_exp_f32 v62, v62
    v_exp_f32 v63, v63
    v_exp_f32 v64, v64
    v_exp_f32 v65, v65
    v_smfmac_f32_32x32x32_bf16 v[80:95], v[148:151], v[56:63], v114
    ds_read_b64 v[124:125], v163 offset:46080
    ds_read_b128 v[116:119], v160 offset:46080
    ds_read_b128 v[120:123], v160 offset:48640
    s_setprio 2
    v_exp_f32 v66, v66
    v_exp_f32 v67, v67
    v_exp_f32 v68, v68
    v_exp_f32 v69, v69
    v_mfma_f32_32x32x8_bf16 v[32:47], v[112:113], v[102:103], 0
    v_exp_f32 v70, v70
    v_exp_f32 v71, v71
    v_exp_f32 v72, v72
    v_exp_f32 v73, v73
    v_smfmac_f32_32x32x32_bf16 v[80:95], v[152:155], v[64:71], v114
    s_add_u32 m0, s90, 125952
    s_nop 0
    buffer_load_dwordx4 v219, s[12:15], s69 offen lds
    v_exp_f32 v74, v74
    v_exp_f32 v75, v75
    v_exp_f32 v76, v76
    v_exp_f32 v77, v77
    v_mfma_f32_32x32x16_bf16 v[32:47], v[108:111], v[96:99], v[32:47]
    s_waitcnt lgkmcnt(0)
    v_exp_f32 v78, v78
    v_exp_f32 v79, v79
    v_exp_f32 v16, v16
    v_exp_f32 v17, v17
    v_smfmac_f32_32x32x32_bf16 v[80:95], v[156:159], v[72:79], v114
    s_mov_b64 exec, s[70:71]
    ds_read_b128 v[144:147], v166 offset:46080
    ds_read_b128 v[148:151], v166 offset:46720
    ds_read_b128 v[152:155], v166 offset:48640
    ds_read_b128 v[156:159], v166 offset:49280
    s_mov_b64 exec, -1
    s_setprio 1
    v_exp_f32 v18, v18
    v_exp_f32 v19, v19
    v_exp_f32 v20, v20
    v_exp_f32 v21, v21
    v_mfma_f32_32x32x8_bf16 v[48:63], v[124:125], v[100:101], 0
    v_exp_f32 v22, v22
    v_exp_f32 v23, v23
    v_exp_f32 v24, v24
    v_exp_f32 v25, v25
    v_smfmac_f32_32x32x32_bf16 v[80:95], v[128:131], v[16:23], v114
    s_setprio 0
    v_exp_f32 v26, v26
    v_exp_f32 v27, v27
    v_exp_f32 v28, v28
    v_exp_f32 v29, v29
    v_mfma_f32_32x32x16_bf16 v[48:63], v[116:119], v[96:99], v[48:63]
    s_add_u32 m0, s90, 126976
    s_nop 0
    buffer_load_dwordx4 v220, s[12:15], s69 offen lds
    s_waitcnt vmcnt(5)
L_wc:
    v_min3_u32 v4, v224, v225, v226
    v_min_u32 v4, v4, v227
    v_cmp_eq_u32 vcc, 0, v4
    s_nop 0
    s_cbranch_vccnz L_wr
L_wo:
    v_exp_f32 v30, v30
    v_exp_f32 v31, v31
    v_exp_f32 v32, v32
    v_exp_f32 v33, v33
    v_smfmac_f32_32x32x32_bf16 v[80:95], v[132:135], v[24:31], v114
    s_waitcnt vmcnt(7) lgkmcnt(0)
    s_barrier
    s_setprio 3
    ds_read_b64 v[112:113], v163 offset:51200
    ds_read_b128 v[104:107], v160 offset:51200
    ds_read_b128 v[108:111], v160 offset:53760
    v_exp_f32 v34, v34
    v_exp_f32 v35, v35
    v_exp_f32 v36, v36
    v_exp_f32 v37, v37
    v_mfma_f32_32x32x8_bf16 v[64:79], v[124:125], v[102:103], 0
    v_exp_f32 v38, v38
    v_exp_f32 v39, v39
    v_exp_f32 v40, v40
    v_exp_f32 v41, v41
    v_smfmac_f32_32x32x32_bf16 v[80:95], v[136:139], v[32:39], v114
    s_add_u32 m0, s33, 81920
    s_add_u32 s34, s57, 81920
    buffer_load_dwordx4 v1, s[16:19], s34 offen sc1 lds
    v_exp_f32 v42, v42
    v_exp_f32 v43, v43
    v_exp_f32 v44, v44
    v_exp_f32 v45, v45
    v_mfma_f32_32x32x16_bf16 v[64:79], v[120:123], v[96:99], v[64:79]
    s_waitcnt lgkmcnt(0)
    v_exp_f32 v46, v46
    v_exp_f32 v47, v47
    v_exp_f32 v48, v48
    v_exp_f32 v49, v49
    v_smfmac_f32_32x32x32_bf16 v[80:95], v[140:143], v[40:47], v114
    s_mov_b64 exec, s[70:71]
    ds_read_b128 v[128:131], v166 offset:51200
    ds_read_b128 v[132:135], v166 offset:51840
    ds_read_b128 v[136:139], v166 offset:53760
    ds_read_b128 v[140:143], v166 offset:54400
    s_mov_b64 exec, -1
    v_exp_f32 v50, v50
    v_exp_f32 v51, v51
    v_exp_f32 v52, v52
    v_exp_f32 v53, v53
    v_mfma_f32_32x32x8_bf16 v[16:31], v[112:113], v[100:101], 0
    v_exp_f32 v54, v54
    v_exp_f32 v55, v55
    v_exp_f32 v56, v56
    v_exp_f32 v57, v57
    v_smfmac_f32_32x32x32_bf16 v[80:95], v[144:147], v[48:55], v114
    s_add_u32 m0, s33, 90112
    s_add_u32 s34, s57, 90112
    buffer_load_dwordx4 v1, s[16:19], s34 offen sc1 lds
    v_exp_f32 v58, v58
    v_exp_f32 v59, v59
    v_exp_f32 v60, v60
    v_exp_f32 v61, v61
    v_mfma_f32_32x32x16_bf16 v[16:31], v[104:107], v[96:99], v[16:31]
    s_cmp_eq_u32 s95, 2
    s_cbranch_scc1 L_ch5
L_cr5:
    v_exp_f32 v62, v62
    v_exp_f32 v63, v63
    v_exp_f32 v64, v64
    v_exp_f32 v65, v65
    v_smfmac_f32_32x32x32_bf16 v[80:95], v[148:151], v[56:63], v114
    ds_read_b64 v[124:125], v163 offset:56320
    ds_read_b128 v[116:119], v160 offset:56320
    ds_read_b128 v[120:123], v160 offset:58880
    v_exp_f32 v66, v66
    v_exp_f32 v67, v67
    v_exp_f32 v68, v68
    v_exp_f32 v69, v69
    v_mfma_f32_32x32x8_bf16 v[32:47], v[112:113], v[102:103], 0
    v_exp_f32 v70, v70
    v_exp_f32 v71, v71
    v_exp_f32 v72, v72
    v_exp_f32 v73, v73
    v_smfmac_f32_32x32x32_bf16 v[80:95], v[152:155], v[64:71], v114
    s_add_u32 m0, s33, 98304
    s_add_u32 s34, s57, 98304
    buffer_load_dwordx4 v1, s[16:19], s34 offen sc1 lds
    v_exp_f32 v74, v74
    v_exp_f32 v75, v75
    v_exp_f32 v76, v76
    v_exp_f32 v77, v77
    v_mfma_f32_32x32x16_bf16 v[32:47], v[108:111], v[96:99], v[32:47]
    s_waitcnt lgkmcnt(0)
    v_exp_f32 v78, v78
    v_exp_f32 v79, v79
    v_exp_f32 v16, v16
    v_exp_f32 v17, v17
    v_smfmac_f32_32x32x32_bf16 v[80:95], v[156:159], v[72:79], v114
    s_mov_b64 exec, s[70:71]
    ds_read_b128 v[144:147], v166 offset:56320
    ds_read_b128 v[148:151], v166 offset:56960
    ds_read_b128 v[152:155], v166 offset:58880
    ds_read_b128 v[156:159], v166 offset:59520
    s_mov_b64 exec, -1
    s_setprio 2
    v_exp_f32 v18, v18
    v_exp_f32 v19, v19
    v_exp_f32 v20, v20
    v_exp_f32 v21, v21
    v_mfma_f32_32x32x8_bf16 v[48:63], v[124:125], v[100:101], 0
    v_exp_f32 v22, v22
    v_exp_f32 v23, v23
    v_exp_f32 v24, v24
    v_exp_f32 v25, v25
    v_smfmac_f32_32x32x32_bf16 v[80:95], v[128:131], v[16:23], v114
    s_add_u32 m0, s33, 106496
    s_add_u32 s34, s57, 106496
    buffer_load_dwordx4 v1, s[16:19], s34 offen sc1 lds
    v_exp_f32 v26, v26
    v_exp_f32 v27, v27
    v_exp_f32 v28, v28
    v_exp_f32 v29, v29
    v_mfma_f32_32x32x16_bf16 v[48:63], v[116:119], v[96:99], v[48:63]
    s_cmp_eq_u32 s95, 2
    s_cbranch_scc1 L_ch6
L_cr6:
    s_mov_b32 s95, 0
    s_mov_b32 s97, 0
    v_exp_f32 v30, v30
    v_exp_f32 v31, v31
    v_exp_f32 v32, v32
    v_exp_f32 v33, v33
    v_smfmac_f32_32x32x32_bf16 v[80:95], v[132:135], v[24:31], v114
    ds_read_b64 v[112:113], v164 offset:0
    ds_read_b128 v[104:107], v161 offset:0
    ds_read_b128 v[108:111], v161 offset:2560
    v_exp_f32 v34, v34
    v_exp_f32 v35, v35
    v_exp_f32 v36, v36
    v_exp_f32 v37, v37
    v_mfma_f32_32x32x8_bf16 v[64:79], v[124:125], v[102:103], 0
    v_exp_f32 v38, v38
    v_exp_f32 v39, v39
    v_exp_f32 v40, v40
    v_exp_f32 v41, v41
    v_smfmac_f32_32x32x32_bf16 v[80:95], v[136:139], v[32:39], v114
    s_add_u32 m0, s33, 114688
    s_add_u32 s34, s57, 114688
    buffer_load_dwordx4 v1, s[16:19], s34 offen sc1 lds
    s_setprio 1
    v_exp_f32 v42, v42
    v_exp_f32 v43, v43
    v_exp_f32 v44, v44
    v_exp_f32 v45, v45
    v_mfma_f32_32x32x16_bf16 v[64:79], v[120:123], v[96:99], v[64:79]
    s_waitcnt lgkmcnt(0)
    v_exp_f32 v46, v46
    v_exp_f32 v47, v47
    v_exp_f32 v48, v48
    v_exp_f32 v49, v49
    v_smfmac_f32_32x32x32_bf16 v[80:95], v[140:143], v[40:47], v114
    s_mov_b64 exec, s[70:71]
    ds_read_b128 v[128:131], v167 offset:0
    ds_read_b128 v[132:135], v167 offset:640
    ds_read_b128 v[136:139], v167 offset:2560
    ds_read_b128 v[140:143], v167 offset:3200
    s_mov_b64 exec, -1
    v_exp_f32 v50, v50
    v_exp_f32 v51, v51
    v_exp_f32 v52, v52
    v_exp_f32 v53, v53
    v_mfma_f32_32x32x8_bf16 v[16:31], v[112:113], v[100:101], 0
    s_setprio 0
    v_exp_f32 v54, v54
    v_exp_f32 v55, v55
    v_exp_f32 v56, v56
    v_exp_f32 v57, v57
    v_smfmac_f32_32x32x32_bf16 v[80:95], v[144:147], v[48:55], v114
    v_exp_f32 v58, v58
    v_exp_f32 v59, v59
    v_exp_f32 v60, v60
    v_exp_f32 v61, v61
    v_mfma_f32_32x32x16_bf16 v[16:31], v[104:107], v[96:99], v[16:31]
    v_exp_f32 v62, v62
    v_exp_f32 v63, v63
    v_exp_f32 v64, v64
    v_exp_f32 v65, v65
    v_smfmac_f32_32x32x32_bf16 v[80:95], v[148:151], v[56:63], v114
    s_waitcnt vmcnt(4) lgkmcnt(0)
    s_barrier
    s_setprio 3
    ds_read_b64 v[124:125], v164 offset:5120
    ds_read_b128 v[116:119], v161 offset:5120
    ds_read_b128 v[120:123], v161 offset:7680
    v_exp_f32 v66, v66
    v_exp_f32 v67, v67
    v_exp_f32 v68, v68
    v_exp_f32 v69, v69
    v_mfma_f32_32x32x8_bf16 v[32:47], v[112:113], v[102:103], 0
    v_exp_f32 v70, v70
    v_exp_f32 v71, v71
    v_exp_f32 v72, v72
    v_exp_f32 v73, v73
    v_smfmac_f32_32x32x32_bf16 v[80:95], v[152:155], v[64:71], v114
    v_exp_f32 v74, v74
    v_exp_f32 v75, v75
    v_exp_f32 v76, v76
    v_exp_f32 v77, v77
    v_mfma_f32_32x32x16_bf16 v[32:47], v[108:111], v[96:99], v[32:47]
    s_waitcnt lgkmcnt(0)
    v_exp_f32 v78, v78
    v_exp_f32 v79, v79
    v_exp_f32 v16, v16
    v_exp_f32 v17, v17
    v_smfmac_f32_32x32x32_bf16 v[80:95], v[156:159], v[72:79], v114
    s_mov_b64 exec, s[70:71]
    ds_read_b128 v[144:147], v167 offset:5120
    ds_read_b128 v[148:151], v167 offset:5760
    ds_read_b128 v[152:155], v167 offset:7680
    ds_read_b128 v[156:159], v167 offset:8320
    s_mov_b64 exec, -1
    v_exp_f32 v18, v18
    v_exp_f32 v19, v19
    v_exp_f32 v20, v20
    v_exp_f32 v21, v21
    v_mfma_f32_32x32x8_bf16 v[48:63], v[124:125], v[100:101], 0
    v_exp_f32 v22, v22
    v_exp_f32 v23, v23
    v_exp_f32 v24, v24
    v_exp_f32 v25, v25
    v_smfmac_f32_32x32x32_bf16 v[80:95], v[128:131], v[16:23], v114
    s_cmp_lg_u32 s58, 0
    s_cbranch_scc1 L_trb0
    ds_read_b64_tr_b16 v[180:181], v176 offset:0
    ds_read_b64_tr_b16 v[182:183], v176 offset:512
L_trj0:
    v_exp_f32 v26, v26
    v_exp_f32 v27, v27
    v_exp_f32 v28, v28
    v_exp_f32 v29, v29
    v_mfma_f32_32x32x16_bf16 v[48:63], v[116:119], v[96:99], v[48:63]
    s_cmp_lg_u32 s58, 0
    s_cbranch_scc1 L_trb1
    ds_read_b64_tr_b16 v[184:185], v176 offset:4096
    ds_read_b64_tr_b16 v[186:187], v176 offset:4608
L_trj1:
    v_exp_f32 v30, v30
    v_exp_f32 v31, v31
    v_exp_f32 v32, v32
    v_exp_f32 v33, v33
    v_smfmac_f32_32x32x32_bf16 v[80:95], v[132:135], v[24:31], v114
    ds_read_b64 v[112:113], v164 offset:10240
    ds_read_b128 v[104:107], v161 offset:10240
    ds_read_b128 v[108:111], v161 offset:12800
    v_exp_f32 v34, v34
    v_exp_f32 v35, v35
    v_exp_f32 v36, v36
    v_exp_f32 v37, v37
    v_mfma_f32_32x32x8_bf16 v[64:79], v[124:125], v[102:103], 0
    v_exp_f32 v38, v38
    v_exp_f32 v39, v39
    v_exp_f32 v40, v40
    v_exp_f32 v41, v41
    v_smfmac_f32_32x32x32_bf16 v[80:95], v[136:139], v[32:39], v114
    v_exp_f32 v42, v42
    v_exp_f32 v43, v43
    v_exp_f32 v44, v44
    v_exp_f32 v45, v45
    v_mfma_f32_32x32x16_bf16 v[64:79], v[120:123], v[96:99], v[64:79]
    s_waitcnt lgkmcnt(0)
    v_exp_f32 v46, v46
    v_exp_f32 v47, v47
    v_exp_f32 v48, v48
    v_exp_f32 v49, v49
    v_smfmac_f32_32x32x32_bf16 v[80:95], v[140:143], v[40:47], v114
    s_mov_b64 exec, s[70:71]
    ds_read_b128 v[128:131], v167 offset:10240
    ds_read_b128 v[132:135], v167 offset:10880
    ds_read_b128 v[136:139], v167 offset:12800
    ds_read_b128 v[140:143], v167 offset:13440
    s_mov_b64 exec, -1
    v_exp_f32 v50, v50
    v_exp_f32 v51, v51
    v_exp_f32 v52, v52
    v_exp_f32 v53, v53
    v_mfma_f32_32x32x8_bf16 v[16:31], v[112:113], v[100:101], 0
    v_exp_f32 v54, v54
    v_exp_f32 v55, v55
    v_exp_f32 v56, v56
    v_exp_f32 v57, v57
    v_smfmac_f32_32x32x32_bf16 v[80:95], v[144:147], v[48:55], v114
    s_cmp_lg_u32 s58, 0
    s_cbranch_scc1 L_trb2
    ds_read_b64_tr_b16 v[188:189], v176 offset:8192
    ds_read_b64_tr_b16 v[190:191], v176 offset:8704
L_trj2:
    v_smfmac_f32_16x16x64_bf16 v[210:213], v[204:207], v[180:187], v208
    v_exp_f32 v58, v58
    v_exp_f32 v59, v59
    v_exp_f32 v60, v60
    v_exp_f32 v61, v61
    v_mfma_f32_32x32x16_bf16 v[16:31], v[104:107], v[96:99], v[16:31]
    s_cmp_lg_u32 s58, 0
    s_cbranch_scc1 L_trb3
    ds_read_b64_tr_b16 v[192:193], v176 offset:12288
    ds_read_b64_tr_b16 v[194:195], v176 offset:12800
L_trj3:
    v_exp_f32 v62, v62
    v_exp_f32 v63, v63
    v_exp_f32 v64, v64
    v_exp_f32 v65, v65
    v_smfmac_f32_32x32x32_bf16 v[80:95], v[148:151], v[56:63], v114
    ds_read_b64 v[124:125], v164 offset:15360
    ds_read_b128 v[116:119], v161 offset:15360
    ds_read_b128 v[120:123], v161 offset:17920
    s_setprio 2
    v_exp_f32 v66, v66
    v_exp_f32 v67, v67
    v_exp_f32 v68, v68
    v_exp_f32 v69, v69
    v_mfma_f32_32x32x8_bf16 v[32:47], v[112:113], v[102:103], 0
    v_exp_f32 v70, v70
    v_exp_f32 v71, v71
    v_exp_f32 v72, v72
    v_exp_f32 v73, v73
    v_smfmac_f32_32x32x32_bf16 v[80:95], v[152:155], v[64:71], v114
    buffer_store_dwordx4 v[180:183], v1, s[16:19], s59 offen sc1
    s_add_u32 s59, s59, s60
    v_exp_f32 v74, v74
    v_exp_f32 v75, v75
    v_exp_f32 v76, v76
    v_exp_f32 v77, v77
    v_mfma_f32_32x32x16_bf16 v[32:47], v[108:111], v[96:99], v[32:47]
    s_waitcnt lgkmcnt(0)
    v_exp_f32 v78, v78
    v_exp_f32 v79, v79
    v_exp_f32 v16, v16
    v_exp_f32 v17, v17
    v_smfmac_f32_32x32x32_bf16 v[80:95], v[156:159], v[72:79], v114
    s_mov_b64 exec, s[70:71]
    ds_read_b128 v[144:147], v167 offset:15360
    ds_read_b128 v[148:151], v167 offset:16000
    ds_read_b128 v[152:155], v167 offset:17920
    ds_read_b128 v[156:159], v167 offset:18560
    s_mov_b64 exec, -1
    v_exp_f32 v18, v18
    v_exp_f32 v19, v19
    v_exp_f32 v20, v20
    v_exp_f32 v21, v21
    v_mfma_f32_32x32x8_bf16 v[48:63], v[124:125], v[100:101], 0
    v_exp_f32 v22, v22
    v_exp_f32 v23, v23
    v_exp_f32 v24, v24
    v_exp_f32 v25, v25
    v_smfmac_f32_32x32x32_bf16 v[80:95], v[128:131], v[16:23], v114
    s_cmp_lg_u32 s58, 0
    s_cbranch_scc1 L_trb4
    ds_read_b64_tr_b16 v[196:197], v176 offset:16384
    ds_read_b64_tr_b16 v[198:199], v176 offset:16896
L_trj4:
    v_smfmac_f32_16x16x64_bf16 v[210:213], v[204:207], v[188:195], v208
    v_exp_f32 v26, v26
    v_exp_f32 v27, v27
    v_exp_f32 v28, v28
    v_exp_f32 v29, v29
    v_mfma_f32_32x32x16_bf16 v[48:63], v[116:119], v[96:99], v[48:63]
    buffer_store_dwordx4 v[184:187], v1, s[16:19], s59 offen sc1
    s_add_u32 s59, s59, s60
    v_exp_f32 v30, v30
    v_exp_f32 v31, v31
    v_exp_f32 v32, v32
    v_exp_f32 v33, v33
    v_smfmac_f32_32x32x32_bf16 v[80:95], v[132:135], v[24:31], v114
    ds_read_b64 v[112:113], v164 offset:20480
    ds_read_b128 v[104:107], v161 offset:20480
    ds_read_b128 v[108:111], v161 offset:23040
    s_setprio 1
    v_exp_f32 v34, v34
    v_exp_f32 v35, v35
    v_exp_f32 v36, v36
    v_exp_f32 v37, v37
    v_mfma_f32_32x32x8_bf16 v[64:79], v[124:125], v[102:103], 0
    v_exp_f32 v38, v38
    v_exp_f32 v39, v39
    v_exp_f32 v40, v40
    v_exp_f32 v41, v41
    v_smfmac_f32_32x32x32_bf16 v[80:95], v[136:139], v[32:39], v114
    buffer_store_dwordx4 v[188:191], v1, s[16:19], s59 offen sc1
    s_add_u32 s59, s59, s60
    v_exp_f32 v42, v42
    v_exp_f32 v43, v43
    v_exp_f32 v44, v44
    v_exp_f32 v45, v45
    v_mfma_f32_32x32x16_bf16 v[64:79], v[120:123], v[96:99], v[64:79]
    s_waitcnt lgkmcnt(0)
    v_exp_f32 v46, v46
    v_exp_f32 v47, v47
    v_exp_f32 v48, v48
    v_exp_f32 v49, v49
    v_smfmac_f32_32x32x32_bf16 v[80:95], v[140:143], v[40:47], v114
    s_mov_b64 exec, s[70:71]
    ds_read_b128 v[128:131], v167 offset:20480
    ds_read_b128 v[132:135], v167 offset:21120
    ds_read_b128 v[136:139], v167 offset:23040
    ds_read_b128 v[140:143], v167 offset:23680
    s_mov_b64 exec, -1
    s_setprio 0
    v_exp_f32 v50, v50
    v_exp_f32 v51, v51
    v_exp_f32 v52, v52
    v_exp_f32 v53, v53
    v_mfma_f32_32x32x8_bf16 v[16:31], v[112:113], v[100:101], 0
    v_exp_f32 v54, v54
    v_exp_f32 v55, v55
    v_exp_f32 v56, v56
    v_exp_f32 v57, v57
    v_smfmac_f32_32x32x32_bf16 v[80:95], v[144:147], v[48:55], v114
    buffer_store_dwordx4 v[192:195], v1, s[16:19], s59 offen sc1
    s_add_u32 s59, s59, s60
    v_smfmac_f32_16x16x64_bf16 v[210:213], v[204:207], v[196:203], v208
    v_exp_f32 v58, v58
    v_exp_f32 v59, v59
    v_exp_f32 v60, v60
    v_exp_f32 v61, v61
    v_mfma_f32_32x32x16_bf16 v[16:31], v[104:107], v[96:99], v[16:31]
    buffer_store_dwordx4 v[196:199], v1, s[16:19], s59 offen sc1
    s_add_u32 s59, s59, s60
    v_exp_f32 v62, v62
    v_exp_f32 v63, v63
    v_exp_f32 v64, v64
    v_exp_f32 v65, v65
    v_smfmac_f32_32x32x32_bf16 v[80:95], v[148:151], v[56:63], v114
    s_waitcnt vmcnt(5) lgkmcnt(0)
    s_barrier
    s_setprio 3
    ds_read_b64 v[124:125], v164 offset:25600
    ds_read_b128 v[116:119], v161 offset:25600
    ds_read_b128 v[120:123], v161 offset:28160
    v_exp_f32 v66, v66
    v_exp_f32 v67, v67
    v_exp_f32 v68, v68
    v_exp_f32 v69, v69
    v_mfma_f32_32x32x8_bf16 v[32:47], v[112:113], v[102:103], 0
    v_exp_f32 v70, v70
    v_exp_f32 v71, v71
    v_exp_f32 v72, v72
    v_exp_f32 v73, v73
    v_smfmac_f32_32x32x32_bf16 v[80:95], v[152:155], v[64:71], v114
    s_add_u32 m0, s33, 122880
    s_add_u32 s34, s57, 122880
    buffer_load_dwordx4 v1, s[16:19], s34 offen sc1 lds
    v_add_f32 v5, v210, v211
    v_cvt_pk_bf16_f32 v7, v5, 0
    v_lshlrev_b32 v6, 16, v7
    v_sub_f32 v6, v5, v6
    v_cvt_pk_bf16_f32 v6, v5, v6
    s_mov_b32 s58, 0
    buffer_store_dwordx2 v[6:7], v209, s[16:19], s61 offen sc1
    v_exp_f32 v74, v74
    v_exp_f32 v75, v75
    v_exp_f32 v76, v76
    v_exp_f32 v77, v77
    v_mfma_f32_32x32x16_bf16 v[32:47], v[108:111], v[96:99], v[32:47]
    s_waitcnt lgkmcnt(0)
    v_exp_f32 v78, v78
    v_exp_f32 v79, v79
    v_exp_f32 v16, v16
    v_exp_f32 v17, v17
    v_smfmac_f32_32x32x32_bf16 v[80:95], v[156:159], v[72:79], v114
    s_mov_b64 exec, s[70:71]
    ds_read_b128 v[144:147], v167 offset:25600
    ds_read_b128 v[148:151], v167 offset:26240
    ds_read_b128 v[152:155], v167 offset:28160
    ds_read_b128 v[156:159], v167 offset:28800
    s_mov_b64 exec, -1
    v_exp_f32 v18, v18
    v_exp_f32 v19, v19
    v_exp_f32 v20, v20
    v_exp_f32 v21, v21
    v_mfma_f32_32x32x8_bf16 v[48:63], v[124:125], v[100:101], 0
    v_exp_f32 v22, v22
    v_exp_f32 v23, v23
    v_exp_f32 v24, v24
    v_exp_f32 v25, v25
    v_smfmac_f32_32x32x32_bf16 v[80:95], v[128:131], v[16:23], v114
    s_add_u32 m0, s33, 131072
    s_add_u32 s34, s57, 131072
    buffer_load_dwordx4 v1, s[16:19], s34 offen sc1 lds
    v_exp_f32 v26, v26
    v_exp_f32 v27, v27
    v_exp_f32 v28, v28
    v_exp_f32 v29, v29
    v_mfma_f32_32x32x16_bf16 v[48:63], v[116:119], v[96:99], v[48:63]
    v_exp_f32 v30, v30
    v_exp_f32 v31, v31
    v_exp_f32 v32, v32
    v_exp_f32 v33, v33
    v_smfmac_f32_32x32x32_bf16 v[80:95], v[132:135], v[24:31], v114
    ds_read_b64 v[112:113], v164 offset:30720
    ds_read_b128 v[104:107], v161 offset:30720
    ds_read_b128 v[108:111], v161 offset:33280
    v_exp_f32 v34, v34
    v_exp_f32 v35, v35
    v_exp_f32 v36, v36
    v_exp_f32 v37, v37
    v_mfma_f32_32x32x8_bf16 v[64:79], v[124:125], v[102:103], 0
    v_exp_f32 v38, v38
    v_exp_f32 v39, v39
    v_exp_f32 v40, v40
    v_exp_f32 v41, v41
    v_smfmac_f32_32x32x32_bf16 v[80:95], v[136:139], v[32:39], v114
    s_add_u32 m0, s33, 139264
    s_add_u32 s34, s57, 139264
    buffer_load_dwordx4 v1, s[16:19], s34 offen sc1 lds
    v_exp_f32 v42, v42
    v_exp_f32 v43, v43
    v_exp_f32 v44, v44
    v_exp_f32 v45, v45
    v_mfma_f32_32x32x16_bf16 v[64:79], v[120:123], v[96:99], v[64:79]
    s_waitcnt lgkmcnt(0)
    v_exp_f32 v46, v46
    v_exp_f32 v47, v47
    v_exp_f32 v48, v48
    v_exp_f32 v49, v49
    v_smfmac_f32_32x32x32_bf16 v[80:95], v[140:143], v[40:47], v114
    s_mov_b64 exec, s[70:71]
    ds_read_b128 v[128:131], v167 offset:30720
    ds_read_b128 v[132:135], v167 offset:31360
    ds_read_b128 v[136:139], v167 offset:33280
    ds_read_b128 v[140:143], v167 offset:33920
    s_mov_b64 exec, -1
    s_setprio 2
    v_exp_f32 v50, v50
    v_exp_f32 v51, v51
    v_exp_f32 v52, v52
    v_exp_f32 v53, v53
    v_mfma_f32_32x32x8_bf16 v[16:31], v[112:113], v[100:101], 0
    v_exp_f32 v54, v54
    v_exp_f32 v55, v55
    v_exp_f32 v56, v56
    v_exp_f32 v57, v57
    v_smfmac_f32_32x32x32_bf16 v[80:95], v[144:147], v[48:55], v114
    s_add_u32 m0, s33, 147456
    s_add_u32 s34, s57, 147456
    buffer_load_dwordx4 v1, s[16:19], s34 offen sc1 lds
    v_exp_f32 v58, v58
    v_exp_f32 v59, v59
    v_exp_f32 v60, v60
    v_exp_f32 v61, v61
    v_mfma_f32_32x32x16_bf16 v[16:31], v[104:107], v[96:99], v[16:31]
    v_exp_f32 v62, v62
    v_exp_f32 v63, v63
    v_exp_f32 v64, v64
    v_exp_f32 v65, v65
    v_smfmac_f32_32x32x32_bf16 v[80:95], v[148:151], v[56:63], v114
    ds_read_b64 v[124:125], v164 offset:35840
    ds_read_b128 v[116:119], v161 offset:35840
    ds_read_b128 v[120:123], v161 offset:38400
    v_exp_f32 v66, v66
    v_exp_f32 v67, v67
    v_exp_f32 v68, v68
    v_exp_f32 v69, v69
    v_mfma_f32_32x32x8_bf16 v[32:47], v[112:113], v[102:103], 0
    v_exp_f32 v70, v70
    v_exp_f32 v71, v71
    v_exp_f32 v72, v72
    v_exp_f32 v73, v73
    v_smfmac_f32_32x32x32_bf16 v[80:95], v[152:155], v[64:71], v114
    s_add_u32 m0, s33, 155648
    s_add_u32 s34, s57, 155648
    buffer_load_dwordx4 v1, s[16:19], s34 offen sc1 lds
    s_setprio 1
    v_exp_f32 v74, v74
    v_exp_f32 v75, v75
    v_exp_f32 v76, v76
    v_exp_f32 v77, v77
    v_mfma_f32_32x32x16_bf16 v[32:47], v[108:111], v[96:99], v[32:47]
    s_waitcnt lgkmcnt(0)
    v_exp_f32 v78, v78
    v_exp_f32 v79, v79
    v_exp_f32 v16, v16
    v_exp_f32 v17, v17
    v_smfmac_f32_32x32x32_bf16 v[80:95], v[156:159], v[72:79], v114
    s_mov_b64 exec, s[70:71]
    ds_read_b128 v[144:147], v167 offset:35840
    ds_read_b128 v[148:151], v167 offset:36480
    ds_read_b128 v[152:155], v167 offset:38400
    ds_read_b128 v[156:159], v167 offset:39040
    s_mov_b64 exec, -1
    v_exp_f32 v18, v18
    v_exp_f32 v19, v19
    v_exp_f32 v20, v20
    v_exp_f32 v21, v21
    v_mfma_f32_32x32x8_bf16 v[48:63], v[124:125], v[100:101], 0
    s_setprio 0
    v_exp_f32 v22, v22
    v_exp_f32 v23, v23
    v_exp_f32 v24, v24
    v_exp_f32 v25, v25
    v_smfmac_f32_32x32x32_bf16 v[80:95], v[128:131], v[16:23], v114
    s_add_u32 m0, s33, 0
    s_add_u32 s34, s62, m0
    buffer_load_dwordx4 v1, s[16:19], s34 offen sc1 lds
    v_exp_f32 v26, v26
    v_exp_f32 v27, v27
    v_exp_f32 v28, v28
    v_exp_f32 v29, v29
    v_mfma_f32_32x32x16_bf16 v[48:63], v[116:119], v[96:99], v[48:63]
    v_exp_f32 v30, v30
    v_exp_f32 v31, v31
    v_exp_f32 v32, v32
    v_exp_f32 v33, v33
    v_smfmac_f32_32x32x32_bf16 v[80:95], v[132:135], v[24:31], v114
    s_waitcnt vmcnt(5) lgkmcnt(0)
    s_barrier
    s_setprio 3
    ds_read_b64 v[112:113], v164 offset:40960
    ds_read_b128 v[104:107], v161 offset:40960
    ds_read_b128 v[108:111], v161 offset:43520
    v_exp_f32 v34, v34
    v_exp_f32 v35, v35
    v_exp_f32 v36, v36
    v_exp_f32 v37, v37
    v_mfma_f32_32x32x8_bf16 v[64:79], v[124:125], v[102:103], 0
    v_exp_f32 v38, v38
    v_exp_f32 v39, v39
    v_exp_f32 v40, v40
    v_exp_f32 v41, v41
    v_smfmac_f32_32x32x32_bf16 v[80:95], v[136:139], v[32:39], v114
    buffer_store_dword v127, off, s[16:19], s92 sc1
    s_add_u32 m0, s33, 8192
    s_add_u32 s34, s62, m0
    buffer_load_dwordx4 v1, s[16:19], s34 offen sc1 lds
    v_exp_f32 v42, v42
    v_exp_f32 v43, v43
    v_exp_f32 v44, v44
    v_exp_f32 v45, v45
    v_mfma_f32_32x32x16_bf16 v[64:79], v[120:123], v[96:99], v[64:79]
    s_waitcnt lgkmcnt(0)
    v_exp_f32 v46, v46
    v_exp_f32 v47, v47
    v_exp_f32 v48, v48
    v_exp_f32 v49, v49
    v_smfmac_f32_32x32x32_bf16 v[80:95], v[140:143], v[40:47], v114
    s_mov_b64 exec, s[70:71]
    ds_read_b128 v[128:131], v167 offset:40960
    ds_read_b128 v[132:135], v167 offset:41600
    ds_read_b128 v[136:139], v167 offset:43520
    ds_read_b128 v[140:143], v167 offset:44160
    s_mov_b64 exec, -1
    v_exp_f32 v50, v50
    v_exp_f32 v51, v51
    v_exp_f32 v52, v52
    v_exp_f32 v53, v53
    v_mfma_f32_32x32x8_bf16 v[16:31], v[112:113], v[100:101], 0
    v_exp_f32 v54, v54
    v_exp_f32 v55, v55
    v_exp_f32 v56, v56
    v_exp_f32 v57, v57
    v_smfmac_f32_32x32x32_bf16 v[80:95], v[144:147], v[48:55], v114
    s_add_u32 m0, s33, 16384
    s_add_u32 s34, s62, m0
    buffer_load_dwordx4 v1, s[16:19], s34 offen sc1 lds
    v_exp_f32 v58, v58
    v_exp_f32 v59, v59
    v_exp_f32 v60, v60
    v_exp_f32 v61, v61
    v_mfma_f32_32x32x16_bf16 v[16:31], v[104:107], v[96:99], v[16:31]
    v_exp_f32 v62, v62
    v_exp_f32 v63, v63
    v_exp_f32 v64, v64
    v_exp_f32 v65, v65
    v_smfmac_f32_32x32x32_bf16 v[80:95], v[148:151], v[56:63], v114
    ds_read_b64 v[124:125], v164 offset:46080
    ds_read_b128 v[116:119], v161 offset:46080
    ds_read_b128 v[120:123], v161 offset:48640
    v_exp_f32 v66, v66
    v_exp_f32 v67, v67
    v_exp_f32 v68, v68
    v_exp_f32 v69, v69
    v_mfma_f32_32x32x8_bf16 v[32:47], v[112:113], v[102:103], 0
    v_exp_f32 v70, v70
    v_exp_f32 v71, v71
    v_exp_f32 v72, v72
    v_exp_f32 v73, v73
    v_smfmac_f32_32x32x32_bf16 v[80:95], v[152:155], v[64:71], v114
    s_add_u32 m0, s33, 24576
    s_add_u32 s34, s62, m0
    buffer_load_dwordx4 v1, s[16:19], s34 offen sc1 lds
    v_exp_f32 v74, v74
    v_exp_f32 v75, v75
    v_exp_f32 v76, v76
    v_exp_f32 v77, v77
    v_mfma_f32_32x32x16_bf16 v[32:47], v[108:111], v[96:99], v[32:47]
    s_waitcnt lgkmcnt(0)
    v_exp_f32 v78, v78
    v_exp_f32 v79, v79
    v_exp_f32 v16, v16
    v_exp_f32 v17, v17
    v_smfmac_f32_32x32x32_bf16 v[80:95], v[156:159], v[72:79], v114
    s_mov_b64 exec, s[70:71]
    ds_read_b128 v[144:147], v167 offset:46080
    ds_read_b128 v[148:151], v167 offset:46720
    ds_read_b128 v[152:155], v167 offset:48640
    ds_read_b128 v[156:159], v167 offset:49280
    s_mov_b64 exec, -1
    v_exp_f32 v18, v18
    v_exp_f32 v19, v19
    v_exp_f32 v20, v20
    v_exp_f32 v21, v21
    v_mfma_f32_32x32x8_bf16 v[48:63], v[124:125], v[100:101], 0
    v_exp_f32 v22, v22
    v_exp_f32 v23, v23
    v_exp_f32 v24, v24
    v_exp_f32 v25, v25
    v_smfmac_f32_32x32x32_bf16 v[80:95], v[128:131], v[16:23], v114
    s_add_u32 m0, s33, 32768
    s_add_u32 s34, s62, m0
    buffer_load_dwordx4 v1, s[16:19], s34 offen sc1 lds
    v_exp_f32 v26, v26
    v_exp_f32 v27, v27
    v_exp_f32 v28, v28
    v_exp_f32 v29, v29
    v_mfma_f32_32x32x16_bf16 v[48:63], v[116:119], v[96:99], v[48:63]
    v_exp_f32 v30, v30
    v_exp_f32 v31, v31
    v_exp_f32 v32, v32
    v_exp_f32 v33, v33
    v_smfmac_f32_32x32x32_bf16 v[80:95], v[132:135], v[24:31], v114
    ds_read_b64 v[112:113], v164 offset:51200
    ds_read_b128 v[104:107], v161 offset:51200
    ds_read_b128 v[108:111], v161 offset:53760
    s_setprio 2
    v_exp_f32 v34, v34
    v_exp_f32 v35, v35
    v_exp_f32 v36, v36
    v_exp_f32 v37, v37
    v_mfma_f32_32x32x8_bf16 v[64:79], v[124:125], v[102:103], 0
    v_exp_f32 v38, v38
    v_exp_f32 v39, v39
    v_exp_f32 v40, v40
    v_exp_f32 v41, v41
    v_smfmac_f32_32x32x32_bf16 v[80:95], v[136:139], v[32:39], v114
    s_add_u32 m0, s33, 40960
    s_add_u32 s34, s62, m0
    buffer_load_dwordx4 v1, s[16:19], s34 offen sc1 lds
    v_exp_f32 v42, v42
    v_exp_f32 v43, v43
    v_exp_f32 v44, v44
    v_exp_f32 v45, v45
    v_mfma_f32_32x32x16_bf16 v[64:79], v[120:123], v[96:99], v[64:79]
    s_waitcnt lgkmcnt(0)
    v_exp_f32 v46, v46
    v_exp_f32 v47, v47
    v_exp_f32 v48, v48
    v_exp_f32 v49, v49
    v_smfmac_f32_32x32x32_bf16 v[80:95], v[140:143], v[40:47], v114
    s_mov_b64 exec, s[70:71]
    ds_read_b128 v[128:131], v167 offset:51200
    ds_read_b128 v[132:135], v167 offset:51840
    ds_read_b128 v[136:139], v167 offset:53760
    ds_read_b128 v[140:143], v167 offset:54400
    s_mov_b64 exec, -1
    v_exp_f32 v50, v50
    v_exp_f32 v51, v51
    v_exp_f32 v52, v52
    v_exp_f32 v53, v53
    v_mfma_f32_32x32x8_bf16 v[16:31], v[112:113], v[100:101], 0
    v_exp_f32 v54, v54
    v_exp_f32 v55, v55
    v_exp_f32 v56, v56
    v_exp_f32 v57, v57
    v_smfmac_f32_32x32x32_bf16 v[80:95], v[144:147], v[48:55], v114
    s_add_u32 m0, s33, 49152
    s_add_u32 s34, s62, m0
    buffer_load_dwordx4 v1, s[16:19], s34 offen sc1 lds
    v_exp_f32 v58, v58
    v_exp_f32 v59, v59
    v_exp_f32 v60, v60
    v_exp_f32 v61, v61
    v_mfma_f32_32x32x16_bf16 v[16:31], v[104:107], v[96:99], v[16:31]
    v_exp_f32 v62, v62
    v_exp_f32 v63, v63
    v_exp_f32 v64, v64
    v_exp_f32 v65, v65
    v_smfmac_f32_32x32x32_bf16 v[80:95], v[148:151], v[56:63], v114
    ds_read_b64 v[124:125], v164 offset:56320
    ds_read_b128 v[116:119], v161 offset:56320
    ds_read_b128 v[120:123], v161 offset:58880
    s_setprio 1
    v_exp_f32 v66, v66
    v_exp_f32 v67, v67
    v_exp_f32 v68, v68
    v_exp_f32 v69, v69
    v_mfma_f32_32x32x8_bf16 v[32:47], v[112:113], v[102:103], 0
    v_exp_f32 v70, v70
    v_exp_f32 v71, v71
    v_exp_f32 v72, v72
    v_exp_f32 v73, v73
    v_smfmac_f32_32x32x32_bf16 v[80:95], v[152:155], v[64:71], v114
    s_add_u32 m0, s33, 57344
    s_add_u32 s34, s62, m0
    buffer_load_dwordx4 v1, s[16:19], s34 offen sc1 lds
    v_exp_f32 v74, v74
    v_exp_f32 v75, v75
    v_exp_f32 v76, v76
    v_exp_f32 v77, v77
    v_mfma_f32_32x32x16_bf16 v[32:47], v[108:111], v[96:99], v[32:47]
    s_waitcnt lgkmcnt(0)
    v_exp_f32 v78, v78
    v_exp_f32 v79, v79
    v_exp_f32 v16, v16
    v_exp_f32 v17, v17
    v_smfmac_f32_32x32x32_bf16 v[80:95], v[156:159], v[72:79], v114
    s_mov_b64 exec, s[70:71]
    ds_read_b128 v[144:147], v167 offset:56320
    ds_read_b128 v[148:151], v167 offset:56960
    ds_read_b128 v[152:155], v167 offset:58880
    ds_read_b128 v[156:159], v167 offset:59520
    s_mov_b64 exec, -1
    s_setprio 0
    v_exp_f32 v18, v18
    v_exp_f32 v19, v19
    v_exp_f32 v20, v20
    v_exp_f32 v21, v21
    v_mfma_f32_32x32x8_bf16 v[48:63], v[124:125], v[100:101], 0
    v_exp_f32 v22, v22
    v_exp_f32 v23, v23
    v_exp_f32 v24, v24
    v_exp_f32 v25, v25
    v_smfmac_f32_32x32x32_bf16 v[80:95], v[128:131], v[16:23], v114
    s_add_u32 m0, s33, 65536
    s_add_u32 s34, s62, m0
    buffer_load_dwordx4 v1, s[16:19], s34 offen sc1 lds
    v_exp_f32 v26, v26
    v_exp_f32 v27, v27
    v_exp_f32 v28, v28
    v_exp_f32 v29, v29
    v_mfma_f32_32x32x16_bf16 v[48:63], v[116:119], v[96:99], v[48:63]
    v_exp_f32 v30, v30
    v_exp_f32 v31, v31
    v_exp_f32 v32, v32
    v_exp_f32 v33, v33
    v_smfmac_f32_32x32x32_bf16 v[80:95], v[132:135], v[24:31], v114
    s_waitcnt vmcnt(10) lgkmcnt(0)
    s_barrier
    s_setprio 3
    ds_read_b64 v[112:113], v165 offset:0
    ds_read_b128 v[104:107], v162 offset:0
    ds_read_b128 v[108:111], v162 offset:2560
    v_exp_f32 v34, v34
    v_exp_f32 v35, v35
    v_exp_f32 v36, v36
    v_exp_f32 v37, v37
    v_mfma_f32_32x32x8_bf16 v[64:79], v[124:125], v[102:103], 0
    v_exp_f32 v38, v38
    v_exp_f32 v39, v39
    v_exp_f32 v40, v40
    v_exp_f32 v41, v41
    v_smfmac_f32_32x32x32_bf16 v[80:95], v[136:139], v[32:39], v114
    s_add_u32 m0, s33, 73728
    s_add_u32 s34, s62, m0
    buffer_load_dwordx4 v1, s[16:19], s34 offen sc1 lds
    v_exp_f32 v42, v42
    v_exp_f32 v43, v43
    v_exp_f32 v44, v44
    v_exp_f32 v45, v45
    v_mfma_f32_32x32x16_bf16 v[64:79], v[120:123], v[96:99], v[64:79]
    s_waitcnt lgkmcnt(0)
    v_exp_f32 v46, v46
    v_exp_f32 v47, v47
    v_exp_f32 v48, v48
    v_exp_f32 v49, v49
    v_smfmac_f32_32x32x32_bf16 v[80:95], v[140:143], v[40:47], v114
    s_mov_b64 exec, s[70:71]
    ds_read_b128 v[128:131], v168 offset:0
    ds_read_b128 v[132:135], v168 offset:640
    ds_read_b128 v[136:139], v168 offset:2560
    ds_read_b128 v[140:143], v168 offset:3200
    s_mov_b64 exec, -1
    v_exp_f32 v50, v50
    v_exp_f32 v51, v51
    v_exp_f32 v52, v52
    v_exp_f32 v53, v53
    v_mfma_f32_32x32x8_bf16 v[16:31], v[112:113], v[100:101], 0
    v_exp_f32 v54, v54
    v_exp_f32 v55, v55
    v_exp_f32 v56, v56
    v_exp_f32 v57, v57
    v_smfmac_f32_32x32x32_bf16 v[80:95], v[144:147], v[48:55], v114
    s_add_u32 m0, s33, 81920
    s_add_u32 s34, s62, m0
    buffer_load_dwordx4 v1, s[16:19], s34 offen sc1 lds
    v_exp_f32 v58, v58
    v_exp_f32 v59, v59
    v_exp_f32 v60, v60
    v_exp_f32 v61, v61
    v_mfma_f32_32x32x16_bf16 v[16:31], v[104:107], v[96:99], v[16:31]
    v_exp_f32 v62, v62
    v_exp_f32 v63, v63
    v_exp_f32 v64, v64
    v_exp_f32 v65, v65
    v_smfmac_f32_32x32x32_bf16 v[80:95], v[148:151], v[56:63], v114
    ds_read_b64 v[124:125], v165 offset:5120
    ds_read_b128 v[116:119], v162 offset:5120
    ds_read_b128 v[120:123], v162 offset:7680
    v_exp_f32 v66, v66
    v_exp_f32 v67, v67
    v_exp_f32 v68, v68
    v_exp_f32 v69, v69
    v_mfma_f32_32x32x8_bf16 v[32:47], v[112:113], v[102:103], 0
    v_exp_f32 v70, v70
    v_exp_f32 v71, v71
    v_exp_f32 v72, v72
    v_exp_f32 v73, v73
    v_smfmac_f32_32x32x32_bf16 v[80:95], v[152:155], v[64:71], v114
    s_add_u32 m0, s33, 90112
    s_add_u32 s34, s62, m0
    buffer_load_dwordx4 v1, s[16:19], s34 offen sc1 lds
    v_exp_f32 v74, v74
    v_exp_f32 v75, v75
    v_exp_f32 v76, v76
    v_exp_f32 v77, v77
    v_mfma_f32_32x32x16_bf16 v[32:47], v[108:111], v[96:99], v[32:47]
    s_waitcnt lgkmcnt(0)
    v_exp_f32 v78, v78
    v_exp_f32 v79, v79
    v_exp_f32 v16, v16
    v_exp_f32 v17, v17
    v_smfmac_f32_32x32x32_bf16 v[80:95], v[156:159], v[72:79], v114
    s_mov_b64 exec, s[70:71]
    ds_read_b128 v[144:147], v168 offset:5120
    ds_read_b128 v[148:151], v168 offset:5760
    ds_read_b128 v[152:155], v168 offset:7680
    ds_read_b128 v[156:159], v168 offset:8320
    s_mov_b64 exec, -1
    v_exp_f32 v18, v18
    v_exp_f32 v19, v19
    v_exp_f32 v20, v20
    v_exp_f32 v21, v21
    v_mfma_f32_32x32x8_bf16 v[48:63], v[124:125], v[100:101], 0
    v_exp_f32 v22, v22
    v_exp_f32 v23, v23
    v_exp_f32 v24, v24
    v_exp_f32 v25, v25
    v_smfmac_f32_32x32x32_bf16 v[80:95], v[128:131], v[16:23], v114
    s_and_b32 s35, s33, 0xfff
    s_add_u32 m0, s35, 98304
    s_add_u32 s34, s62, m0
    buffer_load_dwordx4 v1, s[16:19], s34 offen sc1 lds
    v_exp_f32 v26, v26
    v_exp_f32 v27, v27
    v_exp_f32 v28, v28
    v_exp_f32 v29, v29
    v_mfma_f32_32x32x16_bf16 v[48:63], v[116:119], v[96:99], v[48:63]
    v_exp_f32 v30, v30
    v_exp_f32 v31, v31
    v_exp_f32 v32, v32
    v_exp_f32 v33, v33
    v_smfmac_f32_32x32x32_bf16 v[80:95], v[132:135], v[24:31], v114
    ds_read_b64 v[112:113], v165 offset:10240
    ds_read_b128 v[104:107], v162 offset:10240
    ds_read_b128 v[108:111], v162 offset:12800
    s_setprio 2
    v_exp_f32 v34, v34
    v_exp_f32 v35, v35
    v_exp_f32 v36, v36
    v_exp_f32 v37, v37
    v_mfma_f32_32x32x8_bf16 v[64:79], v[124:125], v[102:103], 0
    v_exp_f32 v38, v38
    v_exp_f32 v39, v39
    v_exp_f32 v40, v40
    v_exp_f32 v41, v41
    v_smfmac_f32_32x32x32_bf16 v[80:95], v[136:139], v[32:39], v114
    v_exp_f32 v42, v42
    v_exp_f32 v43, v43
    v_exp_f32 v44, v44
    v_exp_f32 v45, v45
    v_mfma_f32_32x32x16_bf16 v[64:79], v[120:123], v[96:99], v[64:79]
    s_waitcnt lgkmcnt(0)
    v_exp_f32 v46, v46
    v_exp_f32 v47, v47
    v_exp_f32 v48, v48
    v_exp_f32 v49, v49
    v_smfmac_f32_32x32x32_bf16 v[80:95], v[140:143], v[40:47], v114
    s_mov_b64 exec, s[70:71]
    ds_read_b128 v[128:131], v168 offset:10240
    ds_read_b128 v[132:135], v168 offset:10880
    ds_read_b128 v[136:139], v168 offset:12800
    ds_read_b128 v[140:143], v168 offset:13440
    s_mov_b64 exec, -1
    v_exp_f32 v50, v50
    v_exp_f32 v51, v51
    v_exp_f32 v52, v52
    v_exp_f32 v53, v53
    v_mfma_f32_32x32x8_bf16 v[16:31], v[112:113], v[100:101], 0
    v_exp_f32 v54, v54
    v_exp_f32 v55, v55
    v_exp_f32 v56, v56
    v_exp_f32 v57, v57
    v_smfmac_f32_32x32x32_bf16 v[80:95], v[144:147], v[48:55], v114
    buffer_load_dword v8, v170, s[16:19], s81 offen sc1
    v_exp_f32 v58, v58
    v_exp_f32 v59, v59
    v_exp_f32 v60, v60
    v_exp_f32 v61, v61
    v_mfma_f32_32x32x16_bf16 v[16:31], v[104:107], v[96:99], v[16:31]
    v_exp_f32 v62, v62
    v_exp_f32 v63, v63
    v_exp_f32 v64, v64
    v_exp_f32 v65, v65
    v_smfmac_f32_32x32x32_bf16 v[80:95], v[148:151], v[56:63], v114
    ds_read_b64 v[124:125], v165 offset:15360
    ds_read_b128 v[116:119], v162 offset:15360
    ds_read_b128 v[120:123], v162 offset:17920
    s_setprio 1
    v_exp_f32 v66, v66
    v_exp_f32 v67, v67
    v_exp_f32 v68, v68
    v_exp_f32 v69, v69
    v_mfma_f32_32x32x8_bf16 v[32:47], v[112:113], v[102:103], 0
    v_exp_f32 v70, v70
    v_exp_f32 v71, v71
    v_exp_f32 v72, v72
    v_exp_f32 v73, v73
    v_smfmac_f32_32x32x32_bf16 v[80:95], v[152:155], v[64:71], v114
    v_exp_f32 v74, v74
    v_exp_f32 v75, v75
    v_exp_f32 v76, v76
    v_exp_f32 v77, v77
    v_mfma_f32_32x32x16_bf16 v[32:47], v[108:111], v[96:99], v[32:47]
    s_waitcnt lgkmcnt(0)
    v_exp_f32 v78, v78
    v_exp_f32 v79, v79
    v_exp_f32 v16, v16
    v_exp_f32 v17, v17
    v_smfmac_f32_32x32x32_bf16 v[80:95], v[156:159], v[72:79], v114
    s_mov_b64 exec, s[70:71]
    ds_read_b128 v[144:147], v168 offset:15360
    ds_read_b128 v[148:151], v168 offset:16000
    ds_read_b128 v[152:155], v168 offset:17920
    ds_read_b128 v[156:159], v168 offset:18560
    s_mov_b64 exec, -1
    s_setprio 0
    v_exp_f32 v18, v18
    v_exp_f32 v19, v19
    v_exp_f32 v20, v20
    v_exp_f32 v21, v21
    v_mfma_f32_32x32x8_bf16 v[48:63], v[124:125], v[100:101], 0
    v_exp_f32 v22, v22
    v_exp_f32 v23, v23
    v_exp_f32 v24, v24
    v_exp_f32 v25, v25
    v_smfmac_f32_32x32x32_bf16 v[80:95], v[128:131], v[16:23], v114
    v_exp_f32 v26, v26
    v_exp_f32 v27, v27
    v_exp_f32 v28, v28
    v_exp_f32 v29, v29
    v_mfma_f32_32x32x16_bf16 v[48:63], v[116:119], v[96:99], v[48:63]
    s_waitcnt vmcnt(0)
L_fc:
    v_cmp_eq_u32 vcc, 0, v8
    s_nop 0
    s_cbranch_vccnz L_fr
L_fo:
    v_exp_f32 v30, v30
    v_exp_f32 v31, v31
    v_exp_f32 v32, v32
    v_exp_f32 v33, v33
    v_smfmac_f32_32x32x32_bf16 v[80:95], v[132:135], v[24:31], v114
    s_waitcnt vmcnt(15) lgkmcnt(0)
    s_barrier
    s_setprio 3
    ds_read_b64 v[112:113], v165 offset:20480
    ds_read_b128 v[104:107], v162 offset:20480
    ds_read_b128 v[108:111], v162 offset:23040
    v_exp_f32 v34, v34
    v_exp_f32 v35, v35
    v_exp_f32 v36, v36
    v_exp_f32 v37, v37
    v_mfma_f32_32x32x8_bf16 v[64:79], v[124:125], v[102:103], 0
    v_exp_f32 v38, v38
    v_exp_f32 v39, v39
    v_exp_f32 v40, v40
    v_exp_f32 v41, v41
    v_smfmac_f32_32x32x32_bf16 v[80:95], v[136:139], v[32:39], v114
    s_add_u32 m0, s33, 102400
    s_add_u32 s34, s94, m0
    buffer_load_dwordx4 v1, s[16:19], s34 offen sc1 lds
    s_mov_b64 exec, 31
    global_load_dword v9, v175, s[74:75]
    s_mov_b64 exec, -1
    v_exp_f32 v42, v42
    v_exp_f32 v43, v43
    v_exp_f32 v44, v44
    v_exp_f32 v45, v45
    v_mfma_f32_32x32x16_bf16 v[64:79], v[120:123], v[96:99], v[64:79]
    s_waitcnt lgkmcnt(0)
    v_exp_f32 v46, v46
    v_exp_f32 v47, v47
    v_exp_f32 v48, v48
    v_exp_f32 v49, v49
    v_smfmac_f32_32x32x32_bf16 v[80:95], v[140:143], v[40:47], v114
    s_mov_b64 exec, s[70:71]
    ds_read_b128 v[128:131], v168 offset:20480
    ds_read_b128 v[132:135], v168 offset:21120
    ds_read_b128 v[136:139], v168 offset:23040
    ds_read_b128 v[140:143], v168 offset:23680
    s_mov_b64 exec, -1
    v_exp_f32 v50, v50
    v_exp_f32 v51, v51
    v_exp_f32 v52, v52
    v_exp_f32 v53, v53
    v_mfma_f32_32x32x8_bf16 v[16:31], v[112:113], v[100:101], 0
    v_exp_f32 v54, v54
    v_exp_f32 v55, v55
    v_exp_f32 v56, v56
    v_exp_f32 v57, v57
    v_smfmac_f32_32x32x32_bf16 v[80:95], v[144:147], v[48:55], v114
    s_add_u32 m0, s33, 110592
    s_add_u32 s34, s94, m0
    buffer_load_dwordx4 v1, s[16:19], s34 offen sc1 lds
    v_exp_f32 v58, v58
    v_exp_f32 v59, v59
    v_exp_f32 v60, v60
    v_exp_f32 v61, v61
    v_mfma_f32_32x32x16_bf16 v[16:31], v[104:107], v[96:99], v[16:31]
    buffer_load_dword v9, v169, s[16:19], 0 offen sc1
    v_exp_f32 v62, v62
    v_exp_f32 v63, v63
    v_exp_f32 v64, v64
    v_exp_f32 v65, v65
    v_smfmac_f32_32x32x32_bf16 v[80:95], v[148:151], v[56:63], v114
    ds_read_b64 v[124:125], v165 offset:25600
    ds_read_b128 v[116:119], v162 offset:25600
    ds_read_b128 v[120:123], v162 offset:28160
    v_exp_f32 v66, v66
    v_exp_f32 v67, v67
    v_exp_f32 v68, v68
    v_exp_f32 v69, v69
    v_mfma_f32_32x32x8_bf16 v[32:47], v[112:113], v[102:103], 0
    v_exp_f32 v70, v70
    v_exp_f32 v71, v71
    v_exp_f32 v72, v72
    v_exp_f32 v73, v73
    v_smfmac_f32_32x32x32_bf16 v[80:95], v[152:155], v[64:71], v114
    s_add_u32 m0, s33, 118784
    s_add_u32 s34, s94, m0
    buffer_load_dwordx4 v1, s[16:19], s34 offen sc1 lds
    v_exp_f32 v74, v74
    v_exp_f32 v75, v75
    v_exp_f32 v76, v76
    v_exp_f32 v77, v77
    v_mfma_f32_32x32x16_bf16 v[32:47], v[108:111], v[96:99], v[32:47]
    s_waitcnt lgkmcnt(0)
    v_exp_f32 v78, v78
    v_exp_f32 v79, v79
    v_exp_f32 v16, v16
    v_exp_f32 v17, v17
    v_smfmac_f32_32x32x32_bf16 v[80:95], v[156:159], v[72:79], v114
    s_mov_b64 exec, s[70:71]
    ds_read_b128 v[144:147], v168 offset:25600
    ds_read_b128 v[148:151], v168 offset:26240
    ds_read_b128 v[152:155], v168 offset:28160
    ds_read_b128 v[156:159], v168 offset:28800
    s_mov_b64 exec, -1
    v_exp_f32 v18, v18
    v_exp_f32 v19, v19
    v_exp_f32 v20, v20
    v_exp_f32 v21, v21
    v_mfma_f32_32x32x8_bf16 v[48:63], v[124:125], v[100:101], 0
    v_exp_f32 v22, v22
    v_exp_f32 v23, v23
    v_exp_f32 v24, v24
    v_exp_f32 v25, v25
    v_smfmac_f32_32x32x32_bf16 v[80:95], v[128:131], v[16:23], v114
    s_add_u32 m0, s33, 126976
    s_add_u32 s34, s94, m0
    buffer_load_dwordx4 v1, s[16:19], s34 offen sc1 lds
    v_exp_f32 v26, v26
    v_exp_f32 v27, v27
    v_exp_f32 v28, v28
    v_exp_f32 v29, v29
    v_mfma_f32_32x32x16_bf16 v[48:63], v[116:119], v[96:99], v[48:63]
    v_exp_f32 v30, v30
    v_exp_f32 v31, v31
    v_exp_f32 v32, v32
    v_exp_f32 v33, v33
    v_smfmac_f32_32x32x32_bf16 v[80:95], v[132:135], v[24:31], v114
    ds_read_b64 v[112:113], v165 offset:30720
    ds_read_b128 v[104:107], v162 offset:30720
    ds_read_b128 v[108:111], v162 offset:33280
    v_exp_f32 v34, v34
    v_exp_f32 v35, v35
    v_exp_f32 v36, v36
    v_exp_f32 v37, v37
    v_mfma_f32_32x32x8_bf16 v[64:79], v[124:125], v[102:103], 0
    v_exp_f32 v38, v38
    v_exp_f32 v39, v39
    v_exp_f32 v40, v40
    v_exp_f32 v41, v41
    v_smfmac_f32_32x32x32_bf16 v[80:95], v[136:139], v[32:39], v114
    s_add_u32 m0, s33, 135168
    s_add_u32 s34, s94, m0
    buffer_load_dwordx4 v1, s[16:19], s34 offen sc1 lds
    v_exp_f32 v42, v42
    v_exp_f32 v43, v43
    v_exp_f32 v44, v44
    v_exp_f32 v45, v45
    v_mfma_f32_32x32x16_bf16 v[64:79], v[120:123], v[96:99], v[64:79]
    s_waitcnt lgkmcnt(0)
    v_exp_f32 v46, v46
    v_exp_f32 v47, v47
    v_exp_f32 v48, v48
    v_exp_f32 v49, v49
    v_smfmac_f32_32x32x32_bf16 v[80:95], v[140:143], v[40:47], v114
    s_mov_b64 exec, s[70:71]
    ds_read_b128 v[128:131], v168 offset:30720
    ds_read_b128 v[132:135], v168 offset:31360
    ds_read_b128 v[136:139], v168 offset:33280
    ds_read_b128 v[140:143], v168 offset:33920
    s_mov_b64 exec, -1
    v_exp_f32 v50, v50
    v_exp_f32 v51, v51
    v_exp_f32 v52, v52
    v_exp_f32 v53, v53
    v_mfma_f32_32x32x8_bf16 v[16:31], v[112:113], v[100:101], 0
    v_exp_f32 v54, v54
    v_exp_f32 v55, v55
    v_exp_f32 v56, v56
    s_setprio 2
    v_exp_f32 v57, v57
    v_smfmac_f32_32x32x32_bf16 v[80:95], v[144:147], v[48:55], v114
    v_exp_f32 v58, v58
    v_exp_f32 v59, v59
    v_exp_f32 v60, v60
    v_exp_f32 v61, v61
    v_mfma_f32_32x32x16_bf16 v[16:31], v[104:107], v[96:99], v[16:31]
    v_exp_f32 v62, v62
    v_exp_f32 v63, v63
    v_exp_f32 v64, v64
    v_exp_f32 v65, v65
    v_smfmac_f32_32x32x32_bf16 v[80:95], v[148:151], v[56:63], v114
    ds_read_b64 v[124:125], v165 offset:35840
    ds_read_b128 v[116:119], v162 offset:35840
    ds_read_b128 v[120:123], v162 offset:38400
    v_exp_f32 v66, v66
    v_exp_f32 v67, v67
    v_exp_f32 v68, v68
    v_exp_f32 v69, v69
    v_mfma_f32_32x32x8_bf16 v[32:47], v[112:113], v[102:103], 0
    v_exp_f32 v70, v70
    v_exp_f32 v71, v71
    v_exp_f32 v72, v72
    v_exp_f32 v73, v73
    v_smfmac_f32_32x32x32_bf16 v[80:95], v[152:155], v[64:71], v114
    v_exp_f32 v74, v74
    v_exp_f32 v75, v75
    v_exp_f32 v76, v76
    v_exp_f32 v77, v77
    v_mfma_f32_32x32x16_bf16 v[32:47], v[108:111], v[96:99], v[32:47]
    s_waitcnt lgkmcnt(0)
    v_exp_f32 v78, v78
    v_exp_f32 v79, v79
    v_exp_f32 v16, v16
    v_exp_f32 v17, v17
    v_smfmac_f32_32x32x32_bf16 v[80:95], v[156:159], v[72:79], v114
    s_mov_b64 exec, s[70:71]
    ds_read_b128 v[144:147], v168 offset:35840
    ds_read_b128 v[148:151], v168 offset:36480
    ds_read_b128 v[152:155], v168 offset:38400
    ds_read_b128 v[156:159], v168 offset:39040
    s_mov_b64 exec, -1
    v_exp_f32 v18, v18
    v_exp_f32 v19, v19
    v_exp_f32 v20, v20
    v_exp_f32 v21, v21
    v_mfma_f32_32x32x8_bf16 v[48:63], v[124:125], v[100:101], 0
    v_exp_f32 v22, v22
    v_exp_f32 v23, v23
    v_exp_f32 v24, v24
    v_exp_f32 v25, v25
    v_smfmac_f32_32x32x32_bf16 v[80:95], v[128:131], v[16:23], v114
    v_exp_f32 v26, v26
    v_exp_f32 v27, v27
    v_exp_f32 v28, v28
    v_exp_f32 v29, v29
    v_mfma_f32_32x32x16_bf16 v[48:63], v[116:119], v[96:99], v[48:63]
    v_exp_f32 v30, v30
    v_exp_f32 v31, v31
    v_exp_f32 v32, v32
    v_exp_f32 v33, v33
    v_smfmac_f32_32x32x32_bf16 v[80:95], v[132:135], v[24:31], v114
    v_exp_f32 v34, v34
    v_exp_f32 v35, v35
    v_exp_f32 v36, v36
    s_setprio 1
    v_exp_f32 v37, v37
    v_mfma_f32_32x32x8_bf16 v[64:79], v[124:125], v[102:103], 0
    v_exp_f32 v38, v38
    v_exp_f32 v39, v39
    v_exp_f32 v40, v40
    v_exp_f32 v41, v41
    v_smfmac_f32_32x32x32_bf16 v[80:95], v[136:139], v[32:39], v114
    v_exp_f32 v42, v42
    v_exp_f32 v43, v43
    v_exp_f32 v44, v44
    v_exp_f32 v45, v45
    v_mfma_f32_32x32x16_bf16 v[64:79], v[120:123], v[96:99], v[64:79]
    s_waitcnt lgkmcnt(0)
    v_exp_f32 v46, v46
    v_exp_f32 v47, v47
    v_exp_f32 v48, v48
    v_exp_f32 v49, v49
    v_smfmac_f32_32x32x32_bf16 v[80:95], v[140:143], v[40:47], v114
    v_exp_f32 v50, v50
    v_exp_f32 v51, v51
    v_exp_f32 v52, v52
    v_exp_f32 v53, v53
    v_exp_f32 v54, v54
    v_exp_f32 v55, v55
    v_exp_f32 v56, v56
    v_exp_f32 v57, v57
    v_smfmac_f32_32x32x32_bf16 v[80:95], v[144:147], v[48:55], v114
    v_exp_f32 v58, v58
    s_setprio 0
    v_exp_f32 v59, v59
    v_exp_f32 v60, v60
    v_exp_f32 v61, v61
    v_exp_f32 v62, v62
    v_exp_f32 v63, v63
    v_exp_f32 v64, v64
    v_exp_f32 v65, v65
    v_smfmac_f32_32x32x32_bf16 v[80:95], v[148:151], v[56:63], v114
    v_exp_f32 v66, v66
    v_exp_f32 v67, v67
    v_exp_f32 v68, v68
    v_exp_f32 v69, v69
    v_exp_f32 v70, v70
    v_exp_f32 v71, v71
    v_exp_f32 v72, v72
    v_exp_f32 v73, v73
    v_smfmac_f32_32x32x32_bf16 v[80:95], v[152:155], v[64:71], v114
    v_exp_f32 v74, v74
    v_exp_f32 v75, v75
    v_exp_f32 v76, v76
    v_exp_f32 v77, v77
    v_exp_f32 v78, v78
    v_exp_f32 v79, v79
    s_waitcnt vmcnt(0)
    s_setprio 3
    v_smfmac_f32_32x32x32_bf16 v[80:95], v[156:159], v[72:79], v114
    s_mov_b32 s58, 0
    s_nop 10
L_fin:
    v_cndmask_b32 v4, v92, v88, s[72:73]
    v_rcp_f32 v6, v4
    s_cmp_lg_u32 s31, 0
    v_mul_f32 v24, v80, v6
    v_mul_f32 v25, v81, v6
    v_mul_f32 v26, v82, v6
    v_mul_f32 v27, v83, v6
    v_mul_f32 v28, v84, v6
    v_mul_f32 v29, v85, v6
    v_mul_f32 v30, v86, v6
    v_mul_f32 v31, v87, v6
    v_cvt_pk_bf16_f32 v16, v24, v25
    v_cvt_pk_bf16_f32 v17, v26, v27
    v_cvt_pk_bf16_f32 v18, v28, v29
    v_cvt_pk_bf16_f32 v19, v30, v31
    s_cbranch_scc1 L_ms50
    buffer_store_dwordx4 v[16:19], v173, s[16:19], s79 offen
L_mb50:
    v_mul_f32 v32, v88, v6
    v_mul_f32 v33, v89, v6
    v_mul_f32 v34, v90, v6
    v_mul_f32 v35, v91, v6
    v_cvt_pk_bf16_f32 v20, v32, v33
    v_cvt_pk_bf16_f32 v21, v34, v35
    s_cbranch_scc1 L_ms51
    buffer_store_dwordx2 v[20:21], v174, s[16:19], s80 offen
L_mb51:
    v_add_f32 v5, abs(v80), abs(v81)
    v_add_f32 v5, v5, abs(v82)
    v_add_f32 v5, v5, abs(v83)
    v_add_f32 v5, v5, abs(v84)
    v_add_f32 v5, v5, abs(v85)
    v_add_f32 v5, v5, abs(v86)
    v_add_f32 v5, v5, abs(v87)
    v_add_f32 v5, v5, abs(v88)
    v_add_f32 v5, v5, abs(v89)
    v_add_f32 v5, v5, abs(v90)
    v_add_f32 v5, v5, abs(v91)
    v_cmp_nle_f32 vcc, 0x2b800000, v4
    s_nop 0
    s_mov_b64 s[76:77], vcc
    v_cmp_nge_f32 vcc, 0x5d800000, v4
    s_nop 0
    s_or_b64 s[76:77], s[76:77], vcc
    v_cmp_nge_f32 vcc, 0x7e800000, v5
    s_nop 0
    s_or_b64 s[76:77], s[76:77], vcc
    s_cbranch_scc1 L_exact
L_pub:
    s_cmp_lg_u32 s31, 0
    v_mov_b32 v4, 1
    s_waitcnt vmcnt(0)
    s_mov_b64 exec, 1
    s_cbranch_scc1 L_ms52
    buffer_store_dword v4, off, s[16:19], s78
L_mb52:
    s_mov_b64 exec, -1
    s_cmp_ge_u32 s28, 4
    s_cbranch_scc1 L_help
    s_setprio 1
    s_lshr_b32 s34, s65, 1
    s_lshl_b32 s82, s34, 7
    s_add_u32 s83, s82, 28078080
    s_mul_i32 s81, s34, 110592
    s_add_u32 s81, s81, 13238272
    s_mul_i32 s79, s34, 40960
    s_and_b32 s34, s65, 1
    s_mul_i32 s35, s34, 20480
    s_add_u32 s81, s81, s35
    s_lshl_b32 s35, s34, 10
    s_add_u32 s79, s79, s35
    s_add_u32 s79, s79, 10485760
    s_lshl_b32 s34, s34, 3
    s_add_u32 s34, s34, s67
    s_lshl_b32 s34, s34, 2
    s_add_u32 s78, s82, s34
    s_add_u32 s78, s78, 28086272
    s_lshl_b32 s80, s67, 14
    s_lshl_b32 s34, s65, 7
    s_add_u32 s80, s80, s34
    s_add_u32 s80, s80, 13107200
    v_and_b32 v6, 15, v10
    v_lshrrev_b32 v7, 4, v10
    v_lshlrev_b32 v8, 4, v6
    s_mul_i32 s35, s67, 10
    v_add_u32 v4, s35, v7
    v_and_b32 v5, 0xfc, v4
    v_add_u32 v4, v4, v5
    v_lshl_add_u32 v14, v4, 8, v8
    v_add3_u32 v4, s35, v12, 8
    v_and_b32 v5, 0xfc, v4
    v_add_u32 v4, v4, v5
    v_lshl_add_u32 v15, v4, 8, v8
    v_and_b32 v7, 1, v7
    v_lshl_add_u32 v15, v7, 3, v15
    v_lshlrev_b32 v13, 3, v6
    v_lshl_add_u32 v13, v12, 2, v13
    v_mov_b32 v8, 0x3f803f80
    v_mov_b32 v6, 0
    v_mov_b32 v7, 0
    s_barrier
    ds_read_b128 v[36:39], v1 offset:0
    ds_read_b128 v[40:43], v1 offset:1024
    ds_read_b128 v[44:47], v1 offset:2048
    ds_read_b128 v[48:51], v1 offset:3072
    ds_read_b128 v[52:55], v1 offset:4096
    ds_read_b128 v[56:59], v1 offset:5120
    ds_read_b128 v[60:63], v1 offset:6144
    ds_read_b128 v[64:67], v1 offset:7168
    ds_read_b128 v[68:71], v1 offset:8192
    ds_read_b128 v[72:75], v1 offset:9216
    v_lshlrev_b32 v16, 16, v246
    v_and_b32 v17, 0xffff0000, v246
    v_lshlrev_b32 v18, 16, v247
    v_and_b32 v19, 0xffff0000, v247
    v_lshlrev_b32 v20, 16, v248
    v_and_b32 v21, 0xffff0000, v248
    v_lshlrev_b32 v22, 16, v249
    v_and_b32 v23, 0xffff0000, v249
    v_lshlrev_b32 v24, 16, v250
    v_and_b32 v25, 0xffff0000, v250
    v_lshlrev_b32 v26, 16, v251
    v_and_b32 v27, 0xffff0000, v251
    v_lshlrev_b32 v28, 16, v252
    v_and_b32 v29, 0xffff0000, v252
    v_lshlrev_b32 v30, 16, v253
    v_and_b32 v31, 0xffff0000, v253
    v_lshlrev_b32 v32, 16, v254
    v_and_b32 v33, 0xffff0000, v254
    v_lshlrev_b32 v34, 16, v255
    v_and_b32 v35, 0xffff0000, v255
    v_and_b32 v4, 31, v10
    v_lshlrev_b32 v4, 2, v4
    s_mov_b32 s56, 400000
L_poll53:
    buffer_load_dword v5, v4, s[16:19], s83 offen sc1
    s_sub_u32 s56, s56, 1
    s_waitcnt vmcnt(0)
    v_cmp_eq_u32 vcc, 0, v5
    s_cbranch_scc1 L_pout53
    s_cbranch_vccnz L_poll53
L_pout53:
    buffer_load_dwordx4 v[96:99], v1, s[16:19], s81 offen offset:0 sc1
    buffer_load_dwordx4 v[100:103], v1, s[16:19], s81 offen offset:1024 sc1
    buffer_load_dwordx4 v[104:107], v1, s[16:19], s81 offen offset:2048 sc1
    buffer_load_dwordx4 v[108:111], v1, s[16:19], s81 offen offset:3072 sc1
    s_add_u32 s81, s81, 4096
    buffer_load_dwordx4 v[112:115], v1, s[16:19], s81 offen offset:0 sc1
    buffer_load_dwordx4 v[116:119], v1, s[16:19], s81 offen offset:1024 sc1
    buffer_load_dwordx4 v[120:123], v1, s[16:19], s81 offen offset:2048 sc1
    buffer_load_dwordx4 v[124:127], v1, s[16:19], s81 offen offset:3072 sc1
    s_barrier
    s_waitcnt vmcnt(7) lgkmcnt(5)
    v_mfma_f32_16x16x32_bf16 v[16:19], v[36:39], v[96:99], v[16:19]
    ds_read_b128 v[76:79], v1 offset:10240
    v_mfma_f32_16x16x32_bf16 v[20:23], v[40:43], v[96:99], v[20:23]
    ds_read_b128 v[80:83], v1 offset:11264
    s_add_u32 s81, s81, 4096
    buffer_load_dwordx4 v[128:131], v1, s[16:19], s81 offen offset:0 sc1
    v_mfma_f32_16x16x32_bf16 v[24:27], v[44:47], v[96:99], v[24:27]
    ds_read_b128 v[84:87], v1 offset:12288
    v_mfma_f32_16x16x32_bf16 v[28:31], v[48:51], v[96:99], v[28:31]
    ds_read_b128 v[88:91], v1 offset:13312
    v_mfma_f32_16x16x32_bf16 v[32:35], v[52:55], v[96:99], v[32:35]
    ds_read_b128 v[92:95], v1 offset:14336
    s_waitcnt vmcnt(7) lgkmcnt(5)
    v_mfma_f32_16x16x32_bf16 v[16:19], v[56:59], v[100:103], v[16:19]
    ds_read_b128 v[36:39], v1 offset:15360
    v_mfma_f32_16x16x32_bf16 v[20:23], v[60:63], v[100:103], v[20:23]
    ds_read_b128 v[40:43], v1 offset:16384
    buffer_load_dwordx4 v[132:135], v1, s[16:19], s81 offen offset:1024 sc1
    v_mfma_f32_16x16x32_bf16 v[24:27], v[64:67], v[100:103], v[24:27]
    ds_read_b128 v[44:47], v1 offset:17408
    v_mfma_f32_16x16x32_bf16 v[28:31], v[68:71], v[100:103], v[28:31]
    ds_read_b128 v[48:51], v1 offset:18432
    v_mfma_f32_16x16x32_bf16 v[32:35], v[72:75], v[100:103], v[32:35]
    ds_read_b128 v[52:55], v1 offset:19456
    s_waitcnt vmcnt(7) lgkmcnt(5)
    s_barrier
    v_mfma_f32_16x16x32_bf16 v[16:19], v[76:79], v[104:107], v[16:19]
    ds_read_b128 v[56:59], v1 offset:20480
    v_mfma_f32_16x16x32_bf16 v[20:23], v[80:83], v[104:107], v[20:23]
    ds_read_b128 v[60:63], v1 offset:21504
    buffer_load_dwordx4 v[136:139], v1, s[16:19], s81 offen offset:2048 sc1
    v_mfma_f32_16x16x32_bf16 v[24:27], v[84:87], v[104:107], v[24:27]
    ds_read_b128 v[64:67], v1 offset:22528
    v_mfma_f32_16x16x32_bf16 v[28:31], v[88:91], v[104:107], v[28:31]
    ds_read_b128 v[68:71], v1 offset:23552
    v_mfma_f32_16x16x32_bf16 v[32:35], v[92:95], v[104:107], v[32:35]
    ds_read_b128 v[72:75], v1 offset:24576
    s_waitcnt vmcnt(7) lgkmcnt(5)
    v_mfma_f32_16x16x32_bf16 v[16:19], v[36:39], v[108:111], v[16:19]
    ds_read_b128 v[76:79], v1 offset:25600
    v_mfma_f32_16x16x32_bf16 v[20:23], v[40:43], v[108:111], v[20:23]
    ds_read_b128 v[80:83], v1 offset:26624
    buffer_load_dwordx4 v[140:143], v1, s[16:19], s81 offen offset:3072 sc1
    v_mfma_f32_16x16x32_bf16 v[24:27], v[44:47], v[108:111], v[24:27]
    ds_read_b128 v[84:87], v1 offset:27648
    v_mfma_f32_16x16x32_bf16 v[28:31], v[48:51], v[108:111], v[28:31]
    ds_read_b128 v[88:91], v1 offset:28672
    v_mfma_f32_16x16x32_bf16 v[32:35], v[52:55], v[108:111], v[32:35]
    ds_read_b128 v[92:95], v1 offset:29696
    s_waitcnt vmcnt(7) lgkmcnt(5)
    v_mfma_f32_16x16x32_bf16 v[16:19], v[56:59], v[112:115], v[16:19]
    ds_read_b128 v[36:39], v1 offset:30720
    v_mfma_f32_16x16x32_bf16 v[20:23], v[60:63], v[112:115], v[20:23]
    ds_read_b128 v[40:43], v1 offset:31744
    s_add_u32 s81, s81, 4096
    buffer_load_dwordx4 v[144:147], v1, s[16:19], s81 offen offset:0 sc1
    v_mfma_f32_16x16x32_bf16 v[24:27], v[64:67], v[112:115], v[24:27]
    ds_read_b128 v[44:47], v1 offset:32768
    v_mfma_f32_16x16x32_bf16 v[28:31], v[68:71], v[112:115], v[28:31]
    ds_read_b128 v[48:51], v1 offset:33792
    v_mfma_f32_16x16x32_bf16 v[32:35], v[72:75], v[112:115], v[32:35]
    ds_read_b128 v[52:55], v1 offset:34816
    s_waitcnt vmcnt(7) lgkmcnt(5)
    v_mfma_f32_16x16x32_bf16 v[16:19], v[76:79], v[116:119], v[16:19]
    ds_read_b128 v[56:59], v1 offset:35840
    v_mfma_f32_16x16x32_bf16 v[20:23], v[80:83], v[116:119], v[20:23]
    ds_read_b128 v[60:63], v1 offset:36864
    buffer_load_dwordx4 v[148:151], v1, s[16:19], s81 offen offset:1024 sc1
    v_mfma_f32_16x16x32_bf16 v[24:27], v[84:87], v[116:119], v[24:27]
    ds_read_b128 v[64:67], v1 offset:37888
    v_mfma_f32_16x16x32_bf16 v[28:31], v[88:91], v[116:119], v[28:31]
    ds_read_b128 v[68:71], v1 offset:38912
    v_mfma_f32_16x16x32_bf16 v[32:35], v[92:95], v[116:119], v[32:35]
    ds_read_b128 v[72:75], v1 offset:39936
    s_waitcnt vmcnt(7) lgkmcnt(5)
    s_barrier
    v_mfma_f32_16x16x32_bf16 v[16:19], v[36:39], v[120:123], v[16:19]
    ds_read_b128 v[76:79], v1 offset:40960
    v_mfma_f32_16x16x32_bf16 v[20:23], v[40:43], v[120:123], v[20:23]
    ds_read_b128 v[80:83], v1 offset:41984
    buffer_load_dwordx4 v[152:155], v1, s[16:19], s81 offen offset:2048 sc1
    v_mfma_f32_16x16x32_bf16 v[24:27], v[44:47], v[120:123], v[24:27]
    ds_read_b128 v[84:87], v1 offset:43008
    v_mfma_f32_16x16x32_bf16 v[28:31], v[48:51], v[120:123], v[28:31]
    ds_read_b128 v[88:91], v1 offset:44032
    v_mfma_f32_16x16x32_bf16 v[32:35], v[52:55], v[120:123], v[32:35]
    ds_read_b128 v[92:95], v1 offset:45056
    s_waitcnt vmcnt(7) lgkmcnt(5)
    v_mfma_f32_16x16x32_bf16 v[16:19], v[56:59], v[124:127], v[16:19]
    ds_read_b128 v[36:39], v1 offset:46080
    v_mfma_f32_16x16x32_bf16 v[20:23], v[60:63], v[124:127], v[20:23]
    ds_read_b128 v[40:43], v1 offset:47104
    buffer_load_dwordx4 v[156:159], v1, s[16:19], s81 offen offset:3072 sc1
    v_mfma_f32_16x16x32_bf16 v[24:27], v[64:67], v[124:127], v[24:27]
    ds_read_b128 v[44:47], v1 offset:48128
    v_mfma_f32_16x16x32_bf16 v[28:31], v[68:71], v[124:127], v[28:31]
    ds_read_b128 v[48:51], v1 offset:49152
    v_mfma_f32_16x16x32_bf16 v[32:35], v[72:75], v[124:127], v[32:35]
    ds_read_b128 v[52:55], v1 offset:50176
    s_waitcnt vmcnt(7) lgkmcnt(5)
    v_mfma_f32_16x16x32_bf16 v[16:19], v[76:79], v[128:131], v[16:19]
    ds_read_b128 v[56:59], v1 offset:51200
    v_mfma_f32_16x16x32_bf16 v[20:23], v[80:83], v[128:131], v[20:23]
    ds_read_b128 v[60:63], v1 offset:52224
    s_add_u32 s81, s81, 4096
    buffer_load_dwordx4 v[160:163], v1, s[16:19], s81 offen offset:0 sc1
    v_mfma_f32_16x16x32_bf16 v[24:27], v[84:87], v[128:131], v[24:27]
    ds_read_b128 v[64:67], v1 offset:53248
    v_mfma_f32_16x16x32_bf16 v[28:31], v[88:91], v[128:131], v[28:31]
    ds_read_b128 v[68:71], v1 offset:54272
    v_mfma_f32_16x16x32_bf16 v[32:35], v[92:95], v[128:131], v[32:35]
    ds_read_b128 v[72:75], v1 offset:55296
    s_waitcnt vmcnt(7) lgkmcnt(5)
    v_mfma_f32_16x16x32_bf16 v[16:19], v[36:39], v[132:135], v[16:19]
    ds_read_b128 v[76:79], v1 offset:56320
    v_mfma_f32_16x16x32_bf16 v[20:23], v[40:43], v[132:135], v[20:23]
    ds_read_b128 v[80:83], v1 offset:57344
    buffer_load_dwordx4 v[164:167], v1, s[16:19], s81 offen offset:1024 sc1
    v_mfma_f32_16x16x32_bf16 v[24:27], v[44:47], v[132:135], v[24:27]
    ds_read_b128 v[84:87], v1 offset:58368
    v_mfma_f32_16x16x32_bf16 v[28:31], v[48:51], v[132:135], v[28:31]
    ds_read_b128 v[88:91], v1 offset:59392
    v_mfma_f32_16x16x32_bf16 v[32:35], v[52:55], v[132:135], v[32:35]
    ds_read_b128 v[92:95], v1 offset:60416
    s_waitcnt vmcnt(7) lgkmcnt(5)
    s_barrier
    v_mfma_f32_16x16x32_bf16 v[16:19], v[56:59], v[136:139], v[16:19]
    ds_read_b128 v[36:39], v1 offset:61440
    v_mfma_f32_16x16x32_bf16 v[20:23], v[60:63], v[136:139], v[20:23]
    ds_read_b128 v[40:43], v1 offset:62464
    buffer_load_dwordx4 v[168:171], v1, s[16:19], s81 offen offset:2048 sc1
    v_mfma_f32_16x16x32_bf16 v[24:27], v[64:67], v[136:139], v[24:27]
    ds_read_b128 v[44:47], v1 offset:63488
    v_mfma_f32_16x16x32_bf16 v[28:31], v[68:71], v[136:139], v[28:31]
    ds_read_b128 v[48:51], v1 offset:64512
    v_mfma_f32_16x16x32_bf16 v[32:35], v[72:75], v[136:139], v[32:35]
    ds_read_b128 v[52:55], v2 offset:0
    s_waitcnt vmcnt(7) lgkmcnt(5)
    v_mfma_f32_16x16x32_bf16 v[16:19], v[76:79], v[140:143], v[16:19]
    ds_read_b128 v[56:59], v2 offset:1024
    v_mfma_f32_16x16x32_bf16 v[20:23], v[80:83], v[140:143], v[20:23]
    ds_read_b128 v[60:63], v2 offset:2048
    buffer_load_dwordx4 v[172:175], v1, s[16:19], s81 offen offset:3072 sc1
    v_mfma_f32_16x16x32_bf16 v[24:27], v[84:87], v[140:143], v[24:27]
    ds_read_b128 v[64:67], v2 offset:3072
    v_mfma_f32_16x16x32_bf16 v[28:31], v[88:91], v[140:143], v[28:31]
    ds_read_b128 v[68:71], v2 offset:4096
    v_mfma_f32_16x16x32_bf16 v[32:35], v[92:95], v[140:143], v[32:35]
    ds_read_b128 v[72:75], v2 offset:5120
    s_waitcnt vmcnt(7) lgkmcnt(5)
    v_mfma_f32_16x16x32_bf16 v[16:19], v[36:39], v[144:147], v[16:19]
    ds_read_b128 v[76:79], v2 offset:6144
    v_mfma_f32_16x16x32_bf16 v[20:23], v[40:43], v[144:147], v[20:23]
    ds_read_b128 v[80:83], v2 offset:7168
    v_mfma_f32_16x16x32_bf16 v[24:27], v[44:47], v[144:147], v[24:27]
    ds_read_b128 v[84:87], v2 offset:8192
    v_mfma_f32_16x16x32_bf16 v[28:31], v[48:51], v[144:147], v[28:31]
    ds_read_b128 v[88:91], v2 offset:9216
    v_mfma_f32_16x16x32_bf16 v[32:35], v[52:55], v[144:147], v[32:35]
    ds_read_b128 v[92:95], v2 offset:10240
    s_waitcnt vmcnt(6) lgkmcnt(5)
    v_mfma_f32_16x16x32_bf16 v[16:19], v[56:59], v[148:151], v[16:19]
    ds_read_b128 v[36:39], v2 offset:11264
    v_mfma_f32_16x16x32_bf16 v[20:23], v[60:63], v[148:151], v[20:23]
    ds_read_b128 v[40:43], v2 offset:12288
    v_mfma_f32_16x16x32_bf16 v[24:27], v[64:67], v[148:151], v[24:27]
    ds_read_b128 v[44:47], v2 offset:13312
    v_mfma_f32_16x16x32_bf16 v[28:31], v[68:71], v[148:151], v[28:31]
    ds_read_b128 v[48:51], v2 offset:14336
    v_mfma_f32_16x16x32_bf16 v[32:35], v[72:75], v[148:151], v[32:35]
    ds_read_b128 v[52:55], v2 offset:15360
    s_waitcnt vmcnt(5) lgkmcnt(5)
    s_barrier
    v_mfma_f32_16x16x32_bf16 v[16:19], v[76:79], v[152:155], v[16:19]
    ds_read_b128 v[56:59], v2 offset:16384
    v_mfma_f32_16x16x32_bf16 v[20:23], v[80:83], v[152:155], v[20:23]
    ds_read_b128 v[60:63], v2 offset:17408
    v_mfma_f32_16x16x32_bf16 v[24:27], v[84:87], v[152:155], v[24:27]
    ds_read_b128 v[64:67], v2 offset:18432
    v_mfma_f32_16x16x32_bf16 v[28:31], v[88:91], v[152:155], v[28:31]
    ds_read_b128 v[68:71], v2 offset:19456
    v_mfma_f32_16x16x32_bf16 v[32:35], v[92:95], v[152:155], v[32:35]
    ds_read_b128 v[72:75], v2 offset:20480
    s_waitcnt vmcnt(4) lgkmcnt(5)
    v_mfma_f32_16x16x32_bf16 v[16:19], v[36:39], v[156:159], v[16:19]
    ds_read_b128 v[76:79], v2 offset:21504
    v_mfma_f32_16x16x32_bf16 v[20:23], v[40:43], v[156:159], v[20:23]
    ds_read_b128 v[80:83], v2 offset:22528
    v_mfma_f32_16x16x32_bf16 v[24:27], v[44:47], v[156:159], v[24:27]
    ds_read_b128 v[84:87], v2 offset:23552
    v_mfma_f32_16x16x32_bf16 v[28:31], v[48:51], v[156:159], v[28:31]
    ds_read_b128 v[88:91], v2 offset:24576
    v_mfma_f32_16x16x32_bf16 v[32:35], v[52:55], v[156:159], v[32:35]
    ds_read_b128 v[92:95], v2 offset:25600
    s_waitcnt vmcnt(3) lgkmcnt(5)
    v_mfma_f32_16x16x32_bf16 v[16:19], v[56:59], v[160:163], v[16:19]
    ds_read_b128 v[36:39], v2 offset:26624
    v_mfma_f32_16x16x32_bf16 v[20:23], v[60:63], v[160:163], v[20:23]
    ds_read_b128 v[40:43], v2 offset:27648
    v_mfma_f32_16x16x32_bf16 v[24:27], v[64:67], v[160:163], v[24:27]
    ds_read_b128 v[44:47], v2 offset:28672
    v_mfma_f32_16x16x32_bf16 v[28:31], v[68:71], v[160:163], v[28:31]
    ds_read_b128 v[48:51], v2 offset:29696
    v_mfma_f32_16x16x32_bf16 v[32:35], v[72:75], v[160:163], v[32:35]
    ds_read_b128 v[52:55], v2 offset:30720
    s_waitcnt vmcnt(2) lgkmcnt(5)
    v_mfma_f32_16x16x32_bf16 v[16:19], v[76:79], v[164:167], v[16:19]
    ds_read_b128 v[56:59], v2 offset:31744
    v_mfma_f32_16x16x32_bf16 v[20:23], v[80:83], v[164:167], v[20:23]
    ds_read_b128 v[60:63], v2 offset:32768
    v_mfma_f32_16x16x32_bf16 v[24:27], v[84:87], v[164:167], v[24:27]
    ds_read_b128 v[64:67], v2 offset:33792
    v_mfma_f32_16x16x32_bf16 v[28:31], v[88:91], v[164:167], v[28:31]
    ds_read_b128 v[68:71], v2 offset:34816
    v_mfma_f32_16x16x32_bf16 v[32:35], v[92:95], v[164:167], v[32:35]
    ds_read_b128 v[72:75], v2 offset:35840
    s_waitcnt vmcnt(1) lgkmcnt(5)
    v_mfma_f32_16x16x32_bf16 v[16:19], v[36:39], v[168:171], v[16:19]
    v_mfma_f32_16x16x32_bf16 v[20:23], v[40:43], v[168:171], v[20:23]
    v_mfma_f32_16x16x32_bf16 v[24:27], v[44:47], v[168:171], v[24:27]
    v_mfma_f32_16x16x32_bf16 v[28:31], v[48:51], v[168:171], v[28:31]
    v_mfma_f32_16x16x32_bf16 v[32:35], v[52:55], v[168:171], v[32:35]
    s_waitcnt vmcnt(0) lgkmcnt(0)
    v_mfma_f32_16x16x32_bf16 v[16:19], v[56:59], v[172:175], v[16:19]
    v_mfma_f32_16x16x32_bf16 v[20:23], v[60:63], v[172:175], v[20:23]
    v_mfma_f32_16x16x32_bf16 v[24:27], v[64:67], v[172:175], v[24:27]
    v_mfma_f32_16x16x32_bf16 v[28:31], v[68:71], v[172:175], v[28:31]
    v_mfma_f32_16x16x32_bf16 v[32:35], v[72:75], v[172:175], v[32:35]
    s_barrier
    s_cmp_lg_u32 s31, 0
    s_nop 2
    v_cvt_pk_bf16_f32 v246, v16, v17
    v_cvt_pk_bf16_f32 v247, v18, v19
    v_cvt_pk_bf16_f32 v248, v20, v21
    v_cvt_pk_bf16_f32 v249, v22, v23
    s_cbranch_scc1 L_ms54
    buffer_store_dwordx4 v[246:249], v14, s[16:19], s79 offen
L_mb54:
    v_cvt_pk_bf16_f32 v250, v24, v25
    v_cvt_pk_bf16_f32 v251, v26, v27
    v_cvt_pk_bf16_f32 v252, v28, v29
    v_cvt_pk_bf16_f32 v253, v30, v31
    s_cbranch_scc1 L_ms55
    buffer_store_dwordx4 v[250:253], v14, s[16:19], s79 offen offset:2048
L_mb55:
    v_cvt_pk_bf16_f32 v254, v32, v33
    v_cvt_pk_bf16_f32 v255, v34, v35
    s_cbranch_scc1 L_ms56
    buffer_store_dwordx2 v[254:255], v15, s[16:19], s79 offen
L_mb56:
    v_dot2c_f32_bf16 v6, v246, v8
    v_dot2c_f32_bf16 v7, v246, v246
    v_dot2c_f32_bf16 v6, v247, v8
    v_dot2c_f32_bf16 v7, v247, v247
    v_dot2c_f32_bf16 v6, v248, v8
    v_dot2c_f32_bf16 v7, v248, v248
    v_dot2c_f32_bf16 v6, v249, v8
    v_dot2c_f32_bf16 v7, v249, v249
    v_dot2c_f32_bf16 v6, v250, v8
    v_dot2c_f32_bf16 v7, v250, v250
    v_dot2c_f32_bf16 v6, v251, v8
    v_dot2c_f32_bf16 v7, v251, v251
    v_dot2c_f32_bf16 v6, v252, v8
    v_dot2c_f32_bf16 v7, v252, v252
    v_dot2c_f32_bf16 v6, v253, v8
    v_dot2c_f32_bf16 v7, v253, v253
    v_dot2c_f32_bf16 v6, v254, v8
    v_dot2c_f32_bf16 v7, v254, v254
    v_dot2c_f32_bf16 v6, v255, v8
    v_dot2c_f32_bf16 v7, v255, v255
    s_nop 2
    v_permlane32_swap_b32 v6, v7
    v_add_f32 v6, v6, v7
    v_mov_b32 v7, v6
    v_mov_b32 v4, 1
    s_nop 0
    v_permlane16_swap_b32 v6, v7
    v_add_f32 v6, v6, v7
    s_cbranch_scc1 L_ms57
    buffer_store_dword v6, v13, s[16:19], s80 offen
L_mb57:
    ds_read_b128 v[128:131], v2 offset:36864
    ds_read_b128 v[132:135], v2 offset:37888
    ds_read_b128 v[136:139], v2 offset:38912
    ds_read_b128 v[140:143], v2 offset:39936
    ds_read_b128 v[144:147], v2 offset:40960
    ds_read_b128 v[148:151], v2 offset:41984
    v_lshlrev_b32 v13, 3, v11
    v_lshl_add_u32 v13, v12, 16, v13
    v_and_b32 v5, 15, v10
    v_lshlrev_b32 v5, 2, v5
    s_waitcnt vmcnt(0)
    s_mov_b64 exec, 1
    s_cbranch_scc1 L_ms58
    buffer_store_dword v4, off, s[16:19], s78
L_mb58:
    s_mov_b64 exec, -1
    s_lshl_b32 s82, s66, 7
    s_add_u32 s83, s82, 28086272
    s_mul_i32 s81, s66, 40960
    s_add_u32 s81, s81, 10485760
    s_lshl_b32 s80, s66, 8
    s_add_u32 s80, s80, 13107200
    s_mov_b32 s56, 400000
L_poll59:
    buffer_load_dword v6, v5, s[16:19], s83 offen sc1
    s_sub_u32 s56, s56, 1
    s_waitcnt vmcnt(0)
    v_cmp_eq_u32 vcc, 0, v6
    s_cbranch_scc1 L_pout59
    s_cbranch_vccnz L_poll59
L_pout59:
    buffer_load_dwordx4 v[156:159], v1, s[16:19], s81 offen offset:0 sc1
    buffer_load_dwordx4 v[160:163], v1, s[16:19], s81 offen offset:1024 sc1
    buffer_load_dwordx4 v[164:167], v1, s[16:19], s81 offen offset:2048 sc1
    buffer_load_dwordx4 v[168:171], v1, s[16:19], s81 offen offset:3072 sc1
    s_add_u32 s81, s81, 4096
    buffer_load_dwordx4 v[172:175], v1, s[16:19], s81 offen offset:0 sc1
    buffer_load_dwordx4 v[176:179], v1, s[16:19], s81 offen offset:1024 sc1
    s_barrier
    s_waitcnt vmcnt(4) lgkmcnt(4)
    v_mfma_f32_16x16x32_bf16 v[16:19], v[128:131], v[156:159], 0
    ds_read_b128 v[152:155], v2 offset:43008
    v_mfma_f32_16x16x32_bf16 v[20:23], v[128:131], v[160:163], 0
    v_mfma_f32_16x16x32_bf16 v[28:31], v[132:135], v[160:163], 0
    ds_read_b128 v[128:131], v2 offset:44032
    v_mfma_f32_16x16x32_bf16 v[24:27], v[132:135], v[156:159], 0
    s_waitcnt lgkmcnt(4)
    v_mfma_f32_16x16x32_bf16 v[32:35], v[136:139], v[156:159], 0
    ds_read_b128 v[132:135], v2 offset:45056
    v_mfma_f32_16x16x32_bf16 v[36:39], v[136:139], v[160:163], 0
    buffer_load_dwordx4 v[180:183], v1, s[16:19], s81 offen offset:2048 sc1
    v_mfma_f32_16x16x32_bf16 v[44:47], v[140:143], v[160:163], 0
    ds_read_b128 v[136:139], v2 offset:46080
    v_mfma_f32_16x16x32_bf16 v[40:43], v[140:143], v[156:159], 0
    s_waitcnt lgkmcnt(4)
    v_mfma_f32_16x16x32_bf16 v[48:51], v[144:147], v[156:159], 0
    ds_read_b128 v[140:143], v2 offset:47104
    v_mfma_f32_16x16x32_bf16 v[52:55], v[144:147], v[160:163], 0
    v_mfma_f32_16x16x32_bf16 v[60:63], v[148:151], v[160:163], 0
    ds_read_b128 v[144:147], v2 offset:48128
    v_mfma_f32_16x16x32_bf16 v[56:59], v[148:151], v[156:159], 0
    buffer_load_dwordx4 v[184:187], v1, s[16:19], s81 offen offset:3072 sc1
    s_waitcnt lgkmcnt(4)
    v_mfma_f32_16x16x32_bf16 v[64:67], v[152:155], v[156:159], 0
    ds_read_b128 v[148:151], v2 offset:49152
    v_mfma_f32_16x16x32_bf16 v[68:71], v[152:155], v[160:163], 0
    v_mfma_f32_16x16x32_bf16 v[76:79], v[128:131], v[160:163], 0
    ds_read_b128 v[152:155], v2 offset:50176
    v_mfma_f32_16x16x32_bf16 v[72:75], v[128:131], v[156:159], 0
    s_waitcnt lgkmcnt(4)
    v_mfma_f32_16x16x32_bf16 v[80:83], v[132:135], v[156:159], 0
    ds_read_b128 v[128:131], v2 offset:51200
    v_mfma_f32_16x16x32_bf16 v[84:87], v[132:135], v[160:163], 0
    v_mfma_f32_16x16x32_bf16 v[92:95], v[136:139], v[160:163], 0
    ds_read_b128 v[132:135], v2 offset:52224
    v_mfma_f32_16x16x32_bf16 v[88:91], v[136:139], v[156:159], 0
    s_add_u32 s81, s81, 4096
    buffer_load_dwordx4 v[188:191], v1, s[16:19], s81 offen offset:0 sc1
    s_waitcnt lgkmcnt(4)
    v_mfma_f32_16x16x32_bf16 v[96:99], v[140:143], v[156:159], 0
    ds_read_b128 v[136:139], v2 offset:53248
    v_mfma_f32_16x16x32_bf16 v[100:103], v[140:143], v[160:163], 0
    v_mfma_f32_16x16x32_bf16 v[108:111], v[144:147], v[160:163], 0
    ds_read_b128 v[140:143], v2 offset:54272
    v_mfma_f32_16x16x32_bf16 v[104:107], v[144:147], v[156:159], 0
    s_waitcnt lgkmcnt(4)
    v_mfma_f32_16x16x32_bf16 v[112:115], v[148:151], v[156:159], 0
    ds_read_b128 v[144:147], v2 offset:55296
    v_mfma_f32_16x16x32_bf16 v[116:119], v[148:151], v[160:163], 0
    buffer_load_dwordx4 v[192:195], v1, s[16:19], s81 offen offset:1024 sc1
    v_mfma_f32_16x16x32_bf16 v[124:127], v[152:155], v[160:163], 0
    ds_read_b128 v[148:151], v2 offset:56320
    v_mfma_f32_16x16x32_bf16 v[120:123], v[152:155], v[156:159], 0
    s_waitcnt vmcnt(6) lgkmcnt(4)
    v_mfma_f32_16x16x32_bf16 v[16:19], v[128:131], v[164:167], v[16:19]
    ds_read_b128 v[152:155], v2 offset:57344
    v_mfma_f32_16x16x32_bf16 v[20:23], v[128:131], v[168:171], v[20:23]
    v_mfma_f32_16x16x32_bf16 v[28:31], v[132:135], v[168:171], v[28:31]
    ds_read_b128 v[128:131], v2 offset:58368
    v_mfma_f32_16x16x32_bf16 v[24:27], v[132:135], v[164:167], v[24:27]
    s_waitcnt lgkmcnt(4)
    v_mfma_f32_16x16x32_bf16 v[32:35], v[136:139], v[164:167], v[32:35]
    ds_read_b128 v[132:135], v2 offset:59392
    v_mfma_f32_16x16x32_bf16 v[36:39], v[136:139], v[168:171], v[36:39]
    buffer_load_dwordx4 v[196:199], v1, s[16:19], s81 offen offset:2048 sc1
    v_mfma_f32_16x16x32_bf16 v[44:47], v[140:143], v[168:171], v[44:47]
    ds_read_b128 v[136:139], v2 offset:60416
    v_mfma_f32_16x16x32_bf16 v[40:43], v[140:143], v[164:167], v[40:43]
    s_waitcnt lgkmcnt(4)
    v_mfma_f32_16x16x32_bf16 v[48:51], v[144:147], v[164:167], v[48:51]
    ds_read_b128 v[140:143], v2 offset:61440
    v_mfma_f32_16x16x32_bf16 v[52:55], v[144:147], v[168:171], v[52:55]
    v_mfma_f32_16x16x32_bf16 v[60:63], v[148:151], v[168:171], v[60:63]
    ds_read_b128 v[144:147], v2 offset:62464
    v_mfma_f32_16x16x32_bf16 v[56:59], v[148:151], v[164:167], v[56:59]
    buffer_load_dwordx4 v[200:203], v1, s[16:19], s81 offen offset:3072 sc1
    s_waitcnt lgkmcnt(4)
    v_mfma_f32_16x16x32_bf16 v[64:67], v[152:155], v[164:167], v[64:67]
    ds_read_b128 v[148:151], v2 offset:63488
    v_mfma_f32_16x16x32_bf16 v[68:71], v[152:155], v[168:171], v[68:71]
    v_mfma_f32_16x16x32_bf16 v[76:79], v[128:131], v[168:171], v[76:79]
    ds_read_b128 v[152:155], v2 offset:64512
    v_mfma_f32_16x16x32_bf16 v[72:75], v[128:131], v[164:167], v[72:75]
    s_waitcnt lgkmcnt(4)
    v_mfma_f32_16x16x32_bf16 v[80:83], v[132:135], v[164:167], v[80:83]
    s_barrier
    ds_read_b128 v[128:131], v3 offset:0
    v_mfma_f32_16x16x32_bf16 v[84:87], v[132:135], v[168:171], v[84:87]
    v_mfma_f32_16x16x32_bf16 v[92:95], v[136:139], v[168:171], v[92:95]
    ds_read_b128 v[132:135], v3 offset:1024
    v_mfma_f32_16x16x32_bf16 v[88:91], v[136:139], v[164:167], v[88:91]
    s_add_u32 s81, s81, 4096
    buffer_load_dwordx4 v[204:207], v1, s[16:19], s81 offen offset:0 sc1
    s_waitcnt lgkmcnt(4)
    v_mfma_f32_16x16x32_bf16 v[96:99], v[140:143], v[164:167], v[96:99]
    ds_read_b128 v[136:139], v3 offset:2048
    v_mfma_f32_16x16x32_bf16 v[100:103], v[140:143], v[168:171], v[100:103]
    v_mfma_f32_16x16x32_bf16 v[108:111], v[144:147], v[168:171], v[108:111]
    ds_read_b128 v[140:143], v3 offset:3072
    v_mfma_f32_16x16x32_bf16 v[104:107], v[144:147], v[164:167], v[104:107]
    s_waitcnt lgkmcnt(4)
    v_mfma_f32_16x16x32_bf16 v[112:115], v[148:151], v[164:167], v[112:115]
    ds_read_b128 v[144:147], v3 offset:4096
    v_mfma_f32_16x16x32_bf16 v[116:119], v[148:151], v[168:171], v[116:119]
    buffer_load_dwordx4 v[208:211], v1, s[16:19], s81 offen offset:1024 sc1
    v_mfma_f32_16x16x32_bf16 v[124:127], v[152:155], v[168:171], v[124:127]
    ds_read_b128 v[148:151], v3 offset:5120
    v_mfma_f32_16x16x32_bf16 v[120:123], v[152:155], v[164:167], v[120:123]
    s_waitcnt vmcnt(8) lgkmcnt(4)
    v_mfma_f32_16x16x32_bf16 v[16:19], v[128:131], v[172:175], v[16:19]
    ds_read_b128 v[152:155], v3 offset:6144
    v_mfma_f32_16x16x32_bf16 v[20:23], v[128:131], v[176:179], v[20:23]
    v_mfma_f32_16x16x32_bf16 v[28:31], v[132:135], v[176:179], v[28:31]
    ds_read_b128 v[128:131], v3 offset:7168
    v_mfma_f32_16x16x32_bf16 v[24:27], v[132:135], v[172:175], v[24:27]
    s_waitcnt lgkmcnt(4)
    v_mfma_f32_16x16x32_bf16 v[32:35], v[136:139], v[172:175], v[32:35]
    ds_read_b128 v[132:135], v3 offset:8192
    v_mfma_f32_16x16x32_bf16 v[36:39], v[136:139], v[176:179], v[36:39]
    buffer_load_dwordx4 v[212:215], v1, s[16:19], s81 offen offset:2048 sc1
    v_mfma_f32_16x16x32_bf16 v[44:47], v[140:143], v[176:179], v[44:47]
    ds_read_b128 v[136:139], v3 offset:9216
    v_mfma_f32_16x16x32_bf16 v[40:43], v[140:143], v[172:175], v[40:43]
    s_waitcnt lgkmcnt(4)
    v_mfma_f32_16x16x32_bf16 v[48:51], v[144:147], v[172:175], v[48:51]
    ds_read_b128 v[140:143], v3 offset:10240
    v_mfma_f32_16x16x32_bf16 v[52:55], v[144:147], v[176:179], v[52:55]
    v_mfma_f32_16x16x32_bf16 v[60:63], v[148:151], v[176:179], v[60:63]
    ds_read_b128 v[144:147], v3 offset:11264
    v_mfma_f32_16x16x32_bf16 v[56:59], v[148:151], v[172:175], v[56:59]
    buffer_load_dwordx4 v[216:219], v1, s[16:19], s81 offen offset:3072 sc1
    s_waitcnt lgkmcnt(4)
    v_mfma_f32_16x16x32_bf16 v[64:67], v[152:155], v[172:175], v[64:67]
    ds_read_b128 v[148:151], v3 offset:12288
    v_mfma_f32_16x16x32_bf16 v[68:71], v[152:155], v[176:179], v[68:71]
    v_mfma_f32_16x16x32_bf16 v[76:79], v[128:131], v[176:179], v[76:79]
    ds_read_b128 v[152:155], v3 offset:13312
    v_mfma_f32_16x16x32_bf16 v[72:75], v[128:131], v[172:175], v[72:75]
    s_waitcnt lgkmcnt(4)
    v_mfma_f32_16x16x32_bf16 v[80:83], v[132:135], v[172:175], v[80:83]
    ds_read_b128 v[128:131], v3 offset:14336
    v_mfma_f32_16x16x32_bf16 v[84:87], v[132:135], v[176:179], v[84:87]
    v_mfma_f32_16x16x32_bf16 v[92:95], v[136:139], v[176:179], v[92:95]
    ds_read_b128 v[132:135], v3 offset:15360
    v_mfma_f32_16x16x32_bf16 v[88:91], v[136:139], v[172:175], v[88:91]
    s_waitcnt lgkmcnt(4)
    v_mfma_f32_16x16x32_bf16 v[96:99], v[140:143], v[172:175], v[96:99]
    ds_read_b128 v[136:139], v3 offset:16384
    v_mfma_f32_16x16x32_bf16 v[100:103], v[140:143], v[176:179], v[100:103]
    v_mfma_f32_16x16x32_bf16 v[108:111], v[144:147], v[176:179], v[108:111]
    ds_read_b128 v[140:143], v3 offset:17408
    v_mfma_f32_16x16x32_bf16 v[104:107], v[144:147], v[172:175], v[104:107]
    s_waitcnt lgkmcnt(4)
    v_mfma_f32_16x16x32_bf16 v[112:115], v[148:151], v[172:175], v[112:115]
    ds_read_b128 v[144:147], v3 offset:18432
    v_mfma_f32_16x16x32_bf16 v[116:119], v[148:151], v[176:179], v[116:119]
    v_mfma_f32_16x16x32_bf16 v[124:127], v[152:155], v[176:179], v[124:127]
    ds_read_b128 v[148:151], v3 offset:19456
    v_mfma_f32_16x16x32_bf16 v[120:123], v[152:155], v[172:175], v[120:123]
    s_waitcnt vmcnt(8) lgkmcnt(4)
    v_mfma_f32_16x16x32_bf16 v[16:19], v[128:131], v[180:183], v[16:19]
    ds_read_b128 v[152:155], v3 offset:20480
    v_mfma_f32_16x16x32_bf16 v[20:23], v[128:131], v[184:187], v[20:23]
    v_mfma_f32_16x16x32_bf16 v[28:31], v[132:135], v[184:187], v[28:31]
    ds_read_b128 v[128:131], v3 offset:21504
    v_mfma_f32_16x16x32_bf16 v[24:27], v[132:135], v[180:183], v[24:27]
    s_waitcnt lgkmcnt(4)
    v_mfma_f32_16x16x32_bf16 v[32:35], v[136:139], v[180:183], v[32:35]
    ds_read_b128 v[132:135], v3 offset:22528
    v_mfma_f32_16x16x32_bf16 v[36:39], v[136:139], v[184:187], v[36:39]
    s_add_u32 s81, s81, 4096
    buffer_load_dwordx4 v[220:223], v1, s[16:19], s81 offen offset:0 sc1
    v_mfma_f32_16x16x32_bf16 v[44:47], v[140:143], v[184:187], v[44:47]
    ds_read_b128 v[136:139], v3 offset:23552
    v_mfma_f32_16x16x32_bf16 v[40:43], v[140:143], v[180:183], v[40:43]
    s_waitcnt lgkmcnt(4)
    v_mfma_f32_16x16x32_bf16 v[48:51], v[144:147], v[180:183], v[48:51]
    ds_read_b128 v[140:143], v3 offset:24576
    v_mfma_f32_16x16x32_bf16 v[52:55], v[144:147], v[184:187], v[52:55]
    v_mfma_f32_16x16x32_bf16 v[60:63], v[148:151], v[184:187], v[60:63]
    ds_read_b128 v[144:147], v3 offset:25600
    v_mfma_f32_16x16x32_bf16 v[56:59], v[148:151], v[180:183], v[56:59]
    buffer_load_dwordx4 v[224:227], v1, s[16:19], s81 offen offset:1024 sc1
    s_waitcnt lgkmcnt(4)
    v_mfma_f32_16x16x32_bf16 v[64:67], v[152:155], v[180:183], v[64:67]
    ds_read_b128 v[148:151], v3 offset:26624
    v_mfma_f32_16x16x32_bf16 v[68:71], v[152:155], v[184:187], v[68:71]
    v_mfma_f32_16x16x32_bf16 v[76:79], v[128:131], v[184:187], v[76:79]
    ds_read_b128 v[152:155], v3 offset:27648
    v_mfma_f32_16x16x32_bf16 v[72:75], v[128:131], v[180:183], v[72:75]
    s_waitcnt lgkmcnt(4)
    v_mfma_f32_16x16x32_bf16 v[80:83], v[132:135], v[180:183], v[80:83]
    s_barrier
    ds_read_b128 v[128:131], v3 offset:28672
    v_mfma_f32_16x16x32_bf16 v[84:87], v[132:135], v[184:187], v[84:87]
    v_mfma_f32_16x16x32_bf16 v[92:95], v[136:139], v[184:187], v[92:95]
    ds_read_b128 v[132:135], v3 offset:29696
    v_mfma_f32_16x16x32_bf16 v[88:91], v[136:139], v[180:183], v[88:91]
    s_waitcnt lgkmcnt(4)
    v_mfma_f32_16x16x32_bf16 v[96:99], v[140:143], v[180:183], v[96:99]
    ds_read_b128 v[136:139], v3 offset:30720
    v_mfma_f32_16x16x32_bf16 v[100:103], v[140:143], v[184:187], v[100:103]
    v_mfma_f32_16x16x32_bf16 v[108:111], v[144:147], v[184:187], v[108:111]
    ds_read_b128 v[140:143], v3 offset:31744
    v_mfma_f32_16x16x32_bf16 v[104:107], v[144:147], v[180:183], v[104:107]
    s_waitcnt lgkmcnt(4)
    v_mfma_f32_16x16x32_bf16 v[112:115], v[148:151], v[180:183], v[112:115]
    ds_read_b128 v[144:147], v1 offset:0
    v_mfma_f32_16x16x32_bf16 v[116:119], v[148:151], v[184:187], v[116:119]
    v_mfma_f32_16x16x32_bf16 v[124:127], v[152:155], v[184:187], v[124:127]
    ds_read_b128 v[148:151], v1 offset:1024
    v_mfma_f32_16x16x32_bf16 v[120:123], v[152:155], v[180:183], v[120:123]
    s_waitcnt vmcnt(8) lgkmcnt(4)
    v_mfma_f32_16x16x32_bf16 v[16:19], v[128:131], v[188:191], v[16:19]
    ds_read_b128 v[152:155], v1 offset:2048
    v_mfma_f32_16x16x32_bf16 v[20:23], v[128:131], v[192:195], v[20:23]
    v_mfma_f32_16x16x32_bf16 v[28:31], v[132:135], v[192:195], v[28:31]
    ds_read_b128 v[128:131], v1 offset:3072
    v_mfma_f32_16x16x32_bf16 v[24:27], v[132:135], v[188:191], v[24:27]
    s_waitcnt lgkmcnt(4)
    v_mfma_f32_16x16x32_bf16 v[32:35], v[136:139], v[188:191], v[32:35]
    ds_read_b128 v[132:135], v1 offset:4096
    v_mfma_f32_16x16x32_bf16 v[36:39], v[136:139], v[192:195], v[36:39]
    buffer_load_dwordx4 v[228:231], v1, s[16:19], s81 offen offset:2048 sc1
    v_mfma_f32_16x16x32_bf16 v[44:47], v[140:143], v[192:195], v[44:47]
    ds_read_b128 v[136:139], v1 offset:5120
    v_mfma_f32_16x16x32_bf16 v[40:43], v[140:143], v[188:191], v[40:43]
    s_waitcnt lgkmcnt(4)
    v_mfma_f32_16x16x32_bf16 v[48:51], v[144:147], v[188:191], v[48:51]
    ds_read_b128 v[140:143], v1 offset:6144
    v_mfma_f32_16x16x32_bf16 v[52:55], v[144:147], v[192:195], v[52:55]
    buffer_load_dwordx2 v[236:237], v13, s[16:19], s80 offen sc1
    s_add_u32 s80, s80, 16384
    v_mfma_f32_16x16x32_bf16 v[60:63], v[148:151], v[192:195], v[60:63]
    ds_read_b128 v[144:147], v1 offset:7168
    v_mfma_f32_16x16x32_bf16 v[56:59], v[148:151], v[188:191], v[56:59]
    buffer_load_dwordx4 v[232:235], v1, s[16:19], s81 offen offset:3072 sc1
    s_waitcnt lgkmcnt(4)
    v_mfma_f32_16x16x32_bf16 v[64:67], v[152:155], v[188:191], v[64:67]
    ds_read_b128 v[148:151], v1 offset:8192
    v_mfma_f32_16x16x32_bf16 v[68:71], v[152:155], v[192:195], v[68:71]
    v_mfma_f32_16x16x32_bf16 v[76:79], v[128:131], v[192:195], v[76:79]
    ds_read_b128 v[152:155], v1 offset:9216
    v_mfma_f32_16x16x32_bf16 v[72:75], v[128:131], v[188:191], v[72:75]
    s_waitcnt lgkmcnt(4)
    v_mfma_f32_16x16x32_bf16 v[80:83], v[132:135], v[188:191], v[80:83]
    ds_read_b128 v[128:131], v1 offset:10240
    v_mfma_f32_16x16x32_bf16 v[84:87], v[132:135], v[192:195], v[84:87]
    v_mfma_f32_16x16x32_bf16 v[92:95], v[136:139], v[192:195], v[92:95]
    ds_read_b128 v[132:135], v1 offset:11264
    v_mfma_f32_16x16x32_bf16 v[88:91], v[136:139], v[188:191], v[88:91]
    s_waitcnt lgkmcnt(4)
    v_mfma_f32_16x16x32_bf16 v[96:99], v[140:143], v[188:191], v[96:99]
    ds_read_b128 v[136:139], v1 offset:12288
    v_mfma_f32_16x16x32_bf16 v[100:103], v[140:143], v[192:195], v[100:103]
    v_mfma_f32_16x16x32_bf16 v[108:111], v[144:147], v[192:195], v[108:111]
    ds_read_b128 v[140:143], v1 offset:13312
    v_mfma_f32_16x16x32_bf16 v[104:107], v[144:147], v[188:191], v[104:107]
    buffer_load_dwordx2 v[238:239], v13, s[16:19], s80 offen sc1
    s_add_u32 s80, s80, 16384
    s_waitcnt lgkmcnt(4)
    v_mfma_f32_16x16x32_bf16 v[112:115], v[148:151], v[188:191], v[112:115]
    ds_read_b128 v[144:147], v1 offset:14336
    v_mfma_f32_16x16x32_bf16 v[116:119], v[148:151], v[192:195], v[116:119]
    v_mfma_f32_16x16x32_bf16 v[124:127], v[152:155], v[192:195], v[124:127]
    ds_read_b128 v[148:151], v1 offset:15360
    v_mfma_f32_16x16x32_bf16 v[120:123], v[152:155], v[188:191], v[120:123]
    s_waitcnt vmcnt(10) lgkmcnt(4)
    v_mfma_f32_16x16x32_bf16 v[16:19], v[128:131], v[196:199], v[16:19]
    ds_read_b128 v[152:155], v1 offset:16384
    v_mfma_f32_16x16x32_bf16 v[20:23], v[128:131], v[200:203], v[20:23]
    v_mfma_f32_16x16x32_bf16 v[28:31], v[132:135], v[200:203], v[28:31]
    ds_read_b128 v[128:131], v1 offset:17408
    v_mfma_f32_16x16x32_bf16 v[24:27], v[132:135], v[196:199], v[24:27]
    s_waitcnt lgkmcnt(4)
    v_mfma_f32_16x16x32_bf16 v[32:35], v[136:139], v[196:199], v[32:35]
    ds_read_b128 v[132:135], v1 offset:18432
    v_mfma_f32_16x16x32_bf16 v[36:39], v[136:139], v[200:203], v[36:39]
    s_add_u32 s81, s81, 4096
    buffer_load_dwordx4 v[156:159], v1, s[16:19], s81 offen offset:0 sc1
    v_mfma_f32_16x16x32_bf16 v[44:47], v[140:143], v[200:203], v[44:47]
    ds_read_b128 v[136:139], v1 offset:19456
    v_mfma_f32_16x16x32_bf16 v[40:43], v[140:143], v[196:199], v[40:43]
    s_waitcnt lgkmcnt(4)
    v_mfma_f32_16x16x32_bf16 v[48:51], v[144:147], v[196:199], v[48:51]
    ds_read_b128 v[140:143], v1 offset:20480
    v_mfma_f32_16x16x32_bf16 v[52:55], v[144:147], v[200:203], v[52:55]
    buffer_load_dwordx2 v[240:241], v13, s[16:19], s80 offen sc1
    s_add_u32 s80, s80, 16384
    v_mfma_f32_16x16x32_bf16 v[60:63], v[148:151], v[200:203], v[60:63]
    ds_read_b128 v[144:147], v1 offset:21504
    v_mfma_f32_16x16x32_bf16 v[56:59], v[148:151], v[196:199], v[56:59]
    buffer_load_dwordx4 v[160:163], v1, s[16:19], s81 offen offset:1024 sc1
    s_waitcnt lgkmcnt(4)
    v_mfma_f32_16x16x32_bf16 v[64:67], v[152:155], v[196:199], v[64:67]
    ds_read_b128 v[148:151], v1 offset:22528
    v_mfma_f32_16x16x32_bf16 v[68:71], v[152:155], v[200:203], v[68:71]
    v_mfma_f32_16x16x32_bf16 v[76:79], v[128:131], v[200:203], v[76:79]
    ds_read_b128 v[152:155], v1 offset:23552
    v_mfma_f32_16x16x32_bf16 v[72:75], v[128:131], v[196:199], v[72:75]
    s_waitcnt lgkmcnt(4)
    v_mfma_f32_16x16x32_bf16 v[80:83], v[132:135], v[196:199], v[80:83]
    s_barrier
    ds_read_b128 v[128:131], v1 offset:24576
    v_mfma_f32_16x16x32_bf16 v[84:87], v[132:135], v[200:203], v[84:87]
    v_mfma_f32_16x16x32_bf16 v[92:95], v[136:139], v[200:203], v[92:95]
    ds_read_b128 v[132:135], v1 offset:25600
    v_mfma_f32_16x16x32_bf16 v[88:91], v[136:139], v[196:199], v[88:91]
    s_waitcnt lgkmcnt(4)
    v_mfma_f32_16x16x32_bf16 v[96:99], v[140:143], v[196:199], v[96:99]
    ds_read_b128 v[136:139], v1 offset:26624
    v_mfma_f32_16x16x32_bf16 v[100:103], v[140:143], v[200:203], v[100:103]
    v_mfma_f32_16x16x32_bf16 v[108:111], v[144:147], v[200:203], v[108:111]
    ds_read_b128 v[140:143], v1 offset:27648
    v_mfma_f32_16x16x32_bf16 v[104:107], v[144:147], v[196:199], v[104:107]
    buffer_load_dwordx2 v[242:243], v13, s[16:19], s80 offen sc1
    s_add_u32 s80, s80, 16384
    s_waitcnt lgkmcnt(4)
    v_mfma_f32_16x16x32_bf16 v[112:115], v[148:151], v[196:199], v[112:115]
    ds_read_b128 v[144:147], v1 offset:28672
    v_mfma_f32_16x16x32_bf16 v[116:119], v[148:151], v[200:203], v[116:119]
    v_mfma_f32_16x16x32_bf16 v[124:127], v[152:155], v[200:203], v[124:127]
    ds_read_b128 v[148:151], v1 offset:29696
    v_mfma_f32_16x16x32_bf16 v[120:123], v[152:155], v[196:199], v[120:123]
    s_waitcnt vmcnt(12) lgkmcnt(4)
    v_mfma_f32_16x16x32_bf16 v[16:19], v[128:131], v[204:207], v[16:19]
    ds_read_b128 v[152:155], v1 offset:30720
    v_mfma_f32_16x16x32_bf16 v[20:23], v[128:131], v[208:211], v[20:23]
    v_mfma_f32_16x16x32_bf16 v[28:31], v[132:135], v[208:211], v[28:31]
    ds_read_b128 v[128:131], v1 offset:31744
    v_mfma_f32_16x16x32_bf16 v[24:27], v[132:135], v[204:207], v[24:27]
    s_waitcnt lgkmcnt(4)
    v_mfma_f32_16x16x32_bf16 v[32:35], v[136:139], v[204:207], v[32:35]
    ds_read_b128 v[132:135], v1 offset:32768
    v_mfma_f32_16x16x32_bf16 v[36:39], v[136:139], v[208:211], v[36:39]
    buffer_load_dwordx4 v[164:167], v1, s[16:19], s81 offen offset:2048 sc1
    v_mfma_f32_16x16x32_bf16 v[44:47], v[140:143], v[208:211], v[44:47]
    ds_read_b128 v[136:139], v1 offset:33792
    v_mfma_f32_16x16x32_bf16 v[40:43], v[140:143], v[204:207], v[40:43]
    s_waitcnt lgkmcnt(4)
    v_mfma_f32_16x16x32_bf16 v[48:51], v[144:147], v[204:207], v[48:51]
    ds_read_b128 v[140:143], v1 offset:34816
    v_mfma_f32_16x16x32_bf16 v[52:55], v[144:147], v[208:211], v[52:55]
    v_mfma_f32_16x16x32_bf16 v[60:63], v[148:151], v[208:211], v[60:63]
    ds_read_b128 v[144:147], v1 offset:35840
    v_mfma_f32_16x16x32_bf16 v[56:59], v[148:151], v[204:207], v[56:59]
    buffer_load_dwordx4 v[168:171], v1, s[16:19], s81 offen offset:3072 sc1
    s_waitcnt lgkmcnt(4)
    v_mfma_f32_16x16x32_bf16 v[64:67], v[152:155], v[204:207], v[64:67]
    ds_read_b128 v[148:151], v1 offset:36864
    v_mfma_f32_16x16x32_bf16 v[68:71], v[152:155], v[208:211], v[68:71]
    v_mfma_f32_16x16x32_bf16 v[76:79], v[128:131], v[208:211], v[76:79]
    ds_read_b128 v[152:155], v1 offset:37888
    v_mfma_f32_16x16x32_bf16 v[72:75], v[128:131], v[204:207], v[72:75]
    s_waitcnt lgkmcnt(4)
    v_mfma_f32_16x16x32_bf16 v[80:83], v[132:135], v[204:207], v[80:83]
    ds_read_b128 v[128:131], v1 offset:38912
    v_mfma_f32_16x16x32_bf16 v[84:87], v[132:135], v[208:211], v[84:87]
    v_mfma_f32_16x16x32_bf16 v[92:95], v[136:139], v[208:211], v[92:95]
    ds_read_b128 v[132:135], v1 offset:39936
    v_mfma_f32_16x16x32_bf16 v[88:91], v[136:139], v[204:207], v[88:91]
    s_waitcnt lgkmcnt(4)
    v_mfma_f32_16x16x32_bf16 v[96:99], v[140:143], v[204:207], v[96:99]
    ds_read_b128 v[136:139], v1 offset:40960
    v_mfma_f32_16x16x32_bf16 v[100:103], v[140:143], v[208:211], v[100:103]
    v_mfma_f32_16x16x32_bf16 v[108:111], v[144:147], v[208:211], v[108:111]
    ds_read_b128 v[140:143], v1 offset:41984
    v_mfma_f32_16x16x32_bf16 v[104:107], v[144:147], v[204:207], v[104:107]
    s_waitcnt lgkmcnt(4)
    v_mfma_f32_16x16x32_bf16 v[112:115], v[148:151], v[204:207], v[112:115]
    ds_read_b128 v[144:147], v1 offset:43008
    v_mfma_f32_16x16x32_bf16 v[116:119], v[148:151], v[208:211], v[116:119]
    v_mfma_f32_16x16x32_bf16 v[124:127], v[152:155], v[208:211], v[124:127]
    ds_read_b128 v[148:151], v1 offset:44032
    v_mfma_f32_16x16x32_bf16 v[120:123], v[152:155], v[204:207], v[120:123]
    s_waitcnt vmcnt(12) lgkmcnt(4)
    v_mfma_f32_16x16x32_bf16 v[16:19], v[128:131], v[212:215], v[16:19]
    ds_read_b128 v[152:155], v1 offset:45056
    v_mfma_f32_16x16x32_bf16 v[20:23], v[128:131], v[216:219], v[20:23]
    v_mfma_f32_16x16x32_bf16 v[28:31], v[132:135], v[216:219], v[28:31]
    ds_read_b128 v[128:131], v1 offset:46080
    v_mfma_f32_16x16x32_bf16 v[24:27], v[132:135], v[212:215], v[24:27]
    s_waitcnt lgkmcnt(4)
    v_mfma_f32_16x16x32_bf16 v[32:35], v[136:139], v[212:215], v[32:35]
    ds_read_b128 v[132:135], v1 offset:47104
    v_mfma_f32_16x16x32_bf16 v[36:39], v[136:139], v[216:219], v[36:39]
    s_add_u32 s81, s81, 4096
    buffer_load_dwordx4 v[172:175], v1, s[16:19], s81 offen offset:0 sc1
    v_mfma_f32_16x16x32_bf16 v[44:47], v[140:143], v[216:219], v[44:47]
    ds_read_b128 v[136:139], v1 offset:48128
    v_mfma_f32_16x16x32_bf16 v[40:43], v[140:143], v[212:215], v[40:43]
    s_waitcnt lgkmcnt(4)
    v_mfma_f32_16x16x32_bf16 v[48:51], v[144:147], v[212:215], v[48:51]
    ds_read_b128 v[140:143], v1 offset:49152
    v_mfma_f32_16x16x32_bf16 v[52:55], v[144:147], v[216:219], v[52:55]
    v_mfma_f32_16x16x32_bf16 v[60:63], v[148:151], v[216:219], v[60:63]
    ds_read_b128 v[144:147], v1 offset:50176
    v_mfma_f32_16x16x32_bf16 v[56:59], v[148:151], v[212:215], v[56:59]
    buffer_load_dwordx4 v[176:179], v1, s[16:19], s81 offen offset:1024 sc1
    s_waitcnt lgkmcnt(4)
    v_mfma_f32_16x16x32_bf16 v[64:67], v[152:155], v[212:215], v[64:67]
    ds_read_b128 v[148:151], v1 offset:51200
    v_mfma_f32_16x16x32_bf16 v[68:71], v[152:155], v[216:219], v[68:71]
    v_mfma_f32_16x16x32_bf16 v[76:79], v[128:131], v[216:219], v[76:79]
    ds_read_b128 v[152:155], v1 offset:52224
    v_mfma_f32_16x16x32_bf16 v[72:75], v[128:131], v[212:215], v[72:75]
    s_waitcnt lgkmcnt(4)
    v_mfma_f32_16x16x32_bf16 v[80:83], v[132:135], v[212:215], v[80:83]
    s_barrier
    ds_read_b128 v[128:131], v1 offset:53248
    v_mfma_f32_16x16x32_bf16 v[84:87], v[132:135], v[216:219], v[84:87]
    v_mfma_f32_16x16x32_bf16 v[92:95], v[136:139], v[216:219], v[92:95]
    ds_read_b128 v[132:135], v1 offset:54272
    v_mfma_f32_16x16x32_bf16 v[88:91], v[136:139], v[212:215], v[88:91]
    s_waitcnt lgkmcnt(4)
    v_mfma_f32_16x16x32_bf16 v[96:99], v[140:143], v[212:215], v[96:99]
    ds_read_b128 v[136:139], v1 offset:55296
    v_mfma_f32_16x16x32_bf16 v[100:103], v[140:143], v[216:219], v[100:103]
    v_mfma_f32_16x16x32_bf16 v[108:111], v[144:147], v[216:219], v[108:111]
    ds_read_b128 v[140:143], v1 offset:56320
    v_mfma_f32_16x16x32_bf16 v[104:107], v[144:147], v[212:215], v[104:107]
    s_waitcnt lgkmcnt(4)
    v_mfma_f32_16x16x32_bf16 v[112:115], v[148:151], v[212:215], v[112:115]
    ds_read_b128 v[144:147], v1 offset:57344
    v_mfma_f32_16x16x32_bf16 v[116:119], v[148:151], v[216:219], v[116:119]
    v_mfma_f32_16x16x32_bf16 v[124:127], v[152:155], v[216:219], v[124:127]
    ds_read_b128 v[148:151], v1 offset:58368
    v_mfma_f32_16x16x32_bf16 v[120:123], v[152:155], v[212:215], v[120:123]
    s_waitcnt vmcnt(12) lgkmcnt(4)
    v_mfma_f32_16x16x32_bf16 v[16:19], v[128:131], v[220:223], v[16:19]
    ds_read_b128 v[152:155], v1 offset:59392
    v_mfma_f32_16x16x32_bf16 v[20:23], v[128:131], v[224:227], v[20:23]
    v_mfma_f32_16x16x32_bf16 v[28:31], v[132:135], v[224:227], v[28:31]
    ds_read_b128 v[128:131], v1 offset:60416
    v_mfma_f32_16x16x32_bf16 v[24:27], v[132:135], v[220:223], v[24:27]
    s_waitcnt lgkmcnt(4)
    v_mfma_f32_16x16x32_bf16 v[32:35], v[136:139], v[220:223], v[32:35]
    ds_read_b128 v[132:135], v1 offset:61440
    v_mfma_f32_16x16x32_bf16 v[36:39], v[136:139], v[224:227], v[36:39]
    buffer_load_dwordx4 v[180:183], v1, s[16:19], s81 offen offset:2048 sc1
    v_mfma_f32_16x16x32_bf16 v[44:47], v[140:143], v[224:227], v[44:47]
    ds_read_b128 v[136:139], v1 offset:62464
    v_mfma_f32_16x16x32_bf16 v[40:43], v[140:143], v[220:223], v[40:43]
    s_waitcnt lgkmcnt(4)
    v_mfma_f32_16x16x32_bf16 v[48:51], v[144:147], v[220:223], v[48:51]
    ds_read_b128 v[140:143], v1 offset:63488
    v_mfma_f32_16x16x32_bf16 v[52:55], v[144:147], v[224:227], v[52:55]
    v_mfma_f32_16x16x32_bf16 v[60:63], v[148:151], v[224:227], v[60:63]
    ds_read_b128 v[144:147], v1 offset:64512
    v_mfma_f32_16x16x32_bf16 v[56:59], v[148:151], v[220:223], v[56:59]
    buffer_load_dwordx4 v[184:187], v1, s[16:19], s81 offen offset:3072 sc1
    s_waitcnt lgkmcnt(4)
    v_mfma_f32_16x16x32_bf16 v[64:67], v[152:155], v[220:223], v[64:67]
    ds_read_b128 v[148:151], v2 offset:0
    v_mfma_f32_16x16x32_bf16 v[68:71], v[152:155], v[224:227], v[68:71]
    v_mfma_f32_16x16x32_bf16 v[76:79], v[128:131], v[224:227], v[76:79]
    ds_read_b128 v[152:155], v2 offset:1024
    v_mfma_f32_16x16x32_bf16 v[72:75], v[128:131], v[220:223], v[72:75]
    s_waitcnt lgkmcnt(4)
    v_mfma_f32_16x16x32_bf16 v[80:83], v[132:135], v[220:223], v[80:83]
    ds_read_b128 v[128:131], v2 offset:2048
    v_mfma_f32_16x16x32_bf16 v[84:87], v[132:135], v[224:227], v[84:87]
    v_mfma_f32_16x16x32_bf16 v[92:95], v[136:139], v[224:227], v[92:95]
    ds_read_b128 v[132:135], v2 offset:3072
    v_mfma_f32_16x16x32_bf16 v[88:91], v[136:139], v[220:223], v[88:91]
    s_waitcnt lgkmcnt(4)
    v_mfma_f32_16x16x32_bf16 v[96:99], v[140:143], v[220:223], v[96:99]
    ds_read_b128 v[136:139], v2 offset:4096
    v_mfma_f32_16x16x32_bf16 v[100:103], v[140:143], v[224:227], v[100:103]
    v_mfma_f32_16x16x32_bf16 v[108:111], v[144:147], v[224:227], v[108:111]
    ds_read_b128 v[140:143], v2 offset:5120
    v_mfma_f32_16x16x32_bf16 v[104:107], v[144:147], v[220:223], v[104:107]
    s_waitcnt lgkmcnt(4)
    v_mfma_f32_16x16x32_bf16 v[112:115], v[148:151], v[220:223], v[112:115]
    ds_read_b128 v[144:147], v2 offset:6144
    v_mfma_f32_16x16x32_bf16 v[116:119], v[148:151], v[224:227], v[116:119]
    v_mfma_f32_16x16x32_bf16 v[124:127], v[152:155], v[224:227], v[124:127]
    ds_read_b128 v[148:151], v2 offset:7168
    v_mfma_f32_16x16x32_bf16 v[120:123], v[152:155], v[220:223], v[120:123]
    s_waitcnt vmcnt(6) lgkmcnt(4)
    v_mfma_f32_16x16x32_bf16 v[16:19], v[128:131], v[228:231], v[16:19]
    ds_read_b128 v[152:155], v2 offset:8192
    v_mfma_f32_16x16x32_bf16 v[20:23], v[128:131], v[232:235], v[20:23]
    v_add_f32 v236, v236, v238
    v_mfma_f32_16x16x32_bf16 v[28:31], v[132:135], v[232:235], v[28:31]
    ds_read_b128 v[128:131], v2 offset:9216
    v_mfma_f32_16x16x32_bf16 v[24:27], v[132:135], v[228:231], v[24:27]
    v_add_f32 v237, v237, v239
    s_waitcnt lgkmcnt(4)
    v_mfma_f32_16x16x32_bf16 v[32:35], v[136:139], v[228:231], v[32:35]
    ds_read_b128 v[132:135], v2 offset:10240
    v_mfma_f32_16x16x32_bf16 v[36:39], v[136:139], v[232:235], v[36:39]
    s_add_u32 s81, s81, 4096
    buffer_load_dwordx4 v[188:191], v1, s[16:19], s81 offen offset:0 sc1
    v_mfma_f32_16x16x32_bf16 v[44:47], v[140:143], v[232:235], v[44:47]
    ds_read_b128 v[136:139], v2 offset:11264
    v_mfma_f32_16x16x32_bf16 v[40:43], v[140:143], v[228:231], v[40:43]
    v_add_f32 v240, v240, v242
    s_waitcnt lgkmcnt(4)
    v_mfma_f32_16x16x32_bf16 v[48:51], v[144:147], v[228:231], v[48:51]
    ds_read_b128 v[140:143], v2 offset:12288
    v_mfma_f32_16x16x32_bf16 v[52:55], v[144:147], v[232:235], v[52:55]
    v_add_f32 v241, v241, v243
    v_mfma_f32_16x16x32_bf16 v[60:63], v[148:151], v[232:235], v[60:63]
    ds_read_b128 v[144:147], v2 offset:13312
    v_mfma_f32_16x16x32_bf16 v[56:59], v[148:151], v[228:231], v[56:59]
    buffer_load_dwordx4 v[192:195], v1, s[16:19], s81 offen offset:1024 sc1
    s_waitcnt lgkmcnt(4)
    v_mfma_f32_16x16x32_bf16 v[64:67], v[152:155], v[228:231], v[64:67]
    ds_read_b128 v[148:151], v2 offset:14336
    v_mfma_f32_16x16x32_bf16 v[68:71], v[152:155], v[232:235], v[68:71]
    v_add_f32 v236, v236, v240
    v_mfma_f32_16x16x32_bf16 v[76:79], v[128:131], v[232:235], v[76:79]
    ds_read_b128 v[152:155], v2 offset:15360
    v_mfma_f32_16x16x32_bf16 v[72:75], v[128:131], v[228:231], v[72:75]
    v_add_f32 v237, v237, v241
    s_waitcnt lgkmcnt(4)
    v_mfma_f32_16x16x32_bf16 v[80:83], v[132:135], v[228:231], v[80:83]
    s_barrier
    ds_read_b128 v[128:131], v2 offset:16384
    v_mfma_f32_16x16x32_bf16 v[84:87], v[132:135], v[232:235], v[84:87]
    v_mov_b32 v238, v236
    v_mfma_f32_16x16x32_bf16 v[92:95], v[136:139], v[232:235], v[92:95]
    ds_read_b128 v[132:135], v2 offset:17408
    v_mfma_f32_16x16x32_bf16 v[88:91], v[136:139], v[228:231], v[88:91]
    s_waitcnt lgkmcnt(4)
    v_mfma_f32_16x16x32_bf16 v[96:99], v[140:143], v[228:231], v[96:99]
    ds_read_b128 v[136:139], v2 offset:18432
    v_mfma_f32_16x16x32_bf16 v[100:103], v[140:143], v[232:235], v[100:103]
    v_mov_b32 v239, v237
    v_mfma_f32_16x16x32_bf16 v[108:111], v[144:147], v[232:235], v[108:111]
    ds_read_b128 v[140:143], v2 offset:19456
    v_mfma_f32_16x16x32_bf16 v[104:107], v[144:147], v[228:231], v[104:107]
    v_permlane32_swap_b32 v236, v238
    s_waitcnt lgkmcnt(4)
    v_mfma_f32_16x16x32_bf16 v[112:115], v[148:151], v[228:231], v[112:115]
    ds_read_b128 v[144:147], v2 offset:20480
    v_mfma_f32_16x16x32_bf16 v[116:119], v[148:151], v[232:235], v[116:119]
    v_mfma_f32_16x16x32_bf16 v[124:127], v[152:155], v[232:235], v[124:127]
    ds_read_b128 v[148:151], v2 offset:21504
    v_mfma_f32_16x16x32_bf16 v[120:123], v[152:155], v[228:231], v[120:123]
    v_permlane32_swap_b32 v237, v239
    s_waitcnt vmcnt(9) lgkmcnt(4)
    v_mfma_f32_16x16x32_bf16 v[16:19], v[128:131], v[156:159], v[16:19]
    ds_read_b128 v[152:155], v2 offset:22528
    v_mfma_f32_16x16x32_bf16 v[20:23], v[128:131], v[160:163], v[20:23]
    v_add_f32 v236, v236, v238
    v_mfma_f32_16x16x32_bf16 v[28:31], v[132:135], v[160:163], v[28:31]
    ds_read_b128 v[128:131], v2 offset:23552
    v_mfma_f32_16x16x32_bf16 v[24:27], v[132:135], v[156:159], v[24:27]
    v_add_f32 v237, v237, v239
    s_waitcnt lgkmcnt(4)
    v_mfma_f32_16x16x32_bf16 v[32:35], v[136:139], v[156:159], v[32:35]
    ds_read_b128 v[132:135], v2 offset:24576
    v_mfma_f32_16x16x32_bf16 v[36:39], v[136:139], v[160:163], v[36:39]
    buffer_load_dwordx4 v[196:199], v1, s[16:19], s81 offen offset:2048 sc1
    v_mfma_f32_16x16x32_bf16 v[44:47], v[140:143], v[160:163], v[44:47]
    ds_read_b128 v[136:139], v2 offset:25600
    v_mfma_f32_16x16x32_bf16 v[40:43], v[140:143], v[156:159], v[40:43]
    v_mul_f32 v236, 0xbacccccd, v236
    s_waitcnt lgkmcnt(4)
    v_mfma_f32_16x16x32_bf16 v[48:51], v[144:147], v[156:159], v[48:51]
    ds_read_b128 v[140:143], v2 offset:26624
    v_mfma_f32_16x16x32_bf16 v[52:55], v[144:147], v[160:163], v[52:55]
    v_mul_f32 v237, 0x3acccccd, v237
    v_mfma_f32_16x16x32_bf16 v[60:63], v[148:151], v[160:163], v[60:63]
    ds_read_b128 v[144:147], v2 offset:27648
    v_mfma_f32_16x16x32_bf16 v[56:59], v[148:151], v[156:159], v[56:59]
    buffer_load_dwordx4 v[200:203], v1, s[16:19], s81 offen offset:3072 sc1
    s_waitcnt lgkmcnt(4)
    v_mfma_f32_16x16x32_bf16 v[64:67], v[152:155], v[156:159], v[64:67]
    ds_read_b128 v[148:151], v2 offset:28672
    v_mfma_f32_16x16x32_bf16 v[68:71], v[152:155], v[160:163], v[68:71]
    v_fma_f32 v237, -v236, v236, v237
    v_mfma_f32_16x16x32_bf16 v[76:79], v[128:131], v[160:163], v[76:79]
    ds_read_b128 v[152:155], v2 offset:29696
    v_mfma_f32_16x16x32_bf16 v[72:75], v[128:131], v[156:159], v[72:75]
    v_max_f32 v237, 0, v237
    s_waitcnt lgkmcnt(4)
    v_mfma_f32_16x16x32_bf16 v[80:83], v[132:135], v[156:159], v[80:83]
    ds_read_b128 v[128:131], v2 offset:30720
    v_mfma_f32_16x16x32_bf16 v[84:87], v[132:135], v[160:163], v[84:87]
    v_add_f32 v237, 0x3727c5ac, v237
    v_mfma_f32_16x16x32_bf16 v[92:95], v[136:139], v[160:163], v[92:95]
    ds_read_b128 v[132:135], v2 offset:31744
    v_mfma_f32_16x16x32_bf16 v[88:91], v[136:139], v[156:159], v[88:91]
    s_waitcnt lgkmcnt(4)
    v_mfma_f32_16x16x32_bf16 v[96:99], v[140:143], v[156:159], v[96:99]
    ds_read_b128 v[136:139], v2 offset:32768
    v_mfma_f32_16x16x32_bf16 v[100:103], v[140:143], v[160:163], v[100:103]
    v_rcp_f32 v244, v237
    v_mfma_f32_16x16x32_bf16 v[108:111], v[144:147], v[160:163], v[108:111]
    ds_read_b128 v[140:143], v2 offset:33792
    v_mfma_f32_16x16x32_bf16 v[104:107], v[144:147], v[156:159], v[104:107]
    v_cvt_pk_bf16_f32 v240, v236, v236
    s_waitcnt lgkmcnt(4)
    v_mfma_f32_16x16x32_bf16 v[112:115], v[148:151], v[156:159], v[112:115]
    ds_read_b128 v[144:147], v2 offset:34816
    v_mfma_f32_16x16x32_bf16 v[116:119], v[148:151], v[160:163], v[116:119]
    v_mfma_f32_16x16x32_bf16 v[124:127], v[152:155], v[160:163], v[124:127]
    ds_read_b128 v[148:151], v2 offset:35840
    v_mfma_f32_16x16x32_bf16 v[120:123], v[152:155], v[156:159], v[120:123]
    v_mov_b32 v245, v244
    s_waitcnt vmcnt(8) lgkmcnt(4)
    v_mfma_f32_16x16x32_bf16 v[16:19], v[128:131], v[164:167], v[16:19]
    ds_read_b128 v[152:155], v2 offset:36864
    v_mfma_f32_16x16x32_bf16 v[20:23], v[128:131], v[168:171], v[20:23]
    v_and_b32 v4, 0xffff0000, v240
    v_mfma_f32_16x16x32_bf16 v[28:31], v[132:135], v[168:171], v[28:31]
    ds_read_b128 v[128:131], v2 offset:37888
    v_mfma_f32_16x16x32_bf16 v[24:27], v[132:135], v[164:167], v[24:27]
    v_mov_b32 v242, v240
    s_waitcnt lgkmcnt(4)
    v_mfma_f32_16x16x32_bf16 v[32:35], v[136:139], v[164:167], v[32:35]
    ds_read_b128 v[132:135], v2 offset:38912
    v_mfma_f32_16x16x32_bf16 v[36:39], v[136:139], v[168:171], v[36:39]
    s_add_u32 s81, s81, 4096
    buffer_load_dwordx4 v[204:207], v1, s[16:19], s81 offen offset:0 sc1
    v_mfma_f32_16x16x32_bf16 v[44:47], v[140:143], v[168:171], v[44:47]
    ds_read_b128 v[136:139], v2 offset:39936
    v_mfma_f32_16x16x32_bf16 v[40:43], v[140:143], v[164:167], v[40:43]
    v_sub_f32 v4, v236, v4
    s_waitcnt lgkmcnt(4)
    v_mfma_f32_16x16x32_bf16 v[48:51], v[144:147], v[164:167], v[48:51]
    ds_read_b128 v[140:143], v2 offset:40960
    v_mfma_f32_16x16x32_bf16 v[52:55], v[144:147], v[168:171], v[52:55]
    v_permlane16_swap_b32 v244, v245
    v_mfma_f32_16x16x32_bf16 v[60:63], v[148:151], v[168:171], v[60:63]
    ds_read_b128 v[144:147], v2 offset:41984
    v_mfma_f32_16x16x32_bf16 v[56:59], v[148:151], v[164:167], v[56:59]
    buffer_load_dwordx4 v[208:211], v1, s[16:19], s81 offen offset:1024 sc1
    s_waitcnt lgkmcnt(4)
    v_mfma_f32_16x16x32_bf16 v[64:67], v[152:155], v[164:167], v[64:67]
    ds_read_b128 v[148:151], v2 offset:43008
    v_mfma_f32_16x16x32_bf16 v[68:71], v[152:155], v[168:171], v[68:71]
    v_cvt_pk_bf16_f32 v241, v4, 0
    v_mfma_f32_16x16x32_bf16 v[76:79], v[128:131], v[168:171], v[76:79]
    ds_read_b128 v[152:155], v2 offset:44032
    v_mfma_f32_16x16x32_bf16 v[72:75], v[128:131], v[164:167], v[72:75]
    v_permlane16_swap_b32 v240, v242
    s_waitcnt lgkmcnt(4)
    v_mfma_f32_16x16x32_bf16 v[80:83], v[132:135], v[164:167], v[80:83]
    s_barrier
    ds_read_b128 v[128:131], v2 offset:45056
    v_mfma_f32_16x16x32_bf16 v[84:87], v[132:135], v[168:171], v[84:87]
    v_mov_b32 v243, v241
    v_mfma_f32_16x16x32_bf16 v[92:95], v[136:139], v[168:171], v[92:95]
    ds_read_b128 v[132:135], v2 offset:46080
    v_mfma_f32_16x16x32_bf16 v[88:91], v[136:139], v[164:167], v[88:91]
    s_waitcnt lgkmcnt(4)
    v_mfma_f32_16x16x32_bf16 v[96:99], v[140:143], v[164:167], v[96:99]
    ds_read_b128 v[136:139], v2 offset:47104
    v_mfma_f32_16x16x32_bf16 v[100:103], v[140:143], v[168:171], v[100:103]
    v_add_u32 v15, 55296, v1
    v_mfma_f32_16x16x32_bf16 v[108:111], v[144:147], v[168:171], v[108:111]
    ds_read_b128 v[140:143], v2 offset:48128
    v_mfma_f32_16x16x32_bf16 v[104:107], v[144:147], v[164:167], v[104:107]
    s_mul_i32 s79, s66, 110592
    s_waitcnt lgkmcnt(4)
    v_mfma_f32_16x16x32_bf16 v[112:115], v[148:151], v[164:167], v[112:115]
    ds_read_b128 v[144:147], v2 offset:49152
    v_mfma_f32_16x16x32_bf16 v[116:119], v[148:151], v[168:171], v[116:119]
    v_mfma_f32_16x16x32_bf16 v[124:127], v[152:155], v[168:171], v[124:127]
    ds_read_b128 v[148:151], v2 offset:50176
    v_mfma_f32_16x16x32_bf16 v[120:123], v[152:155], v[164:167], v[120:123]
    v_permlane16_swap_b32 v241, v243
    s_waitcnt vmcnt(8) lgkmcnt(4)
    v_mfma_f32_16x16x32_bf16 v[16:19], v[128:131], v[172:175], v[16:19]
    ds_read_b128 v[152:155], v2 offset:51200
    v_mfma_f32_16x16x32_bf16 v[20:23], v[128:131], v[176:179], v[20:23]
    s_add_u32 s79, s79, 13238272
    v_mfma_f32_16x16x32_bf16 v[28:31], v[132:135], v[176:179], v[28:31]
    ds_read_b128 v[128:131], v2 offset:52224
    v_mfma_f32_16x16x32_bf16 v[24:27], v[132:135], v[172:175], v[24:27]
    s_lshr_b32 s34, s68, 1
    s_waitcnt lgkmcnt(4)
    v_mfma_f32_16x16x32_bf16 v[32:35], v[136:139], v[172:175], v[32:35]
    ds_read_b128 v[132:135], v2 offset:53248
    v_mfma_f32_16x16x32_bf16 v[36:39], v[136:139], v[176:179], v[36:39]
    buffer_load_dwordx4 v[212:215], v1, s[16:19], s81 offen offset:2048 sc1
    v_mfma_f32_16x16x32_bf16 v[44:47], v[140:143], v[176:179], v[44:47]
    ds_read_b128 v[136:139], v2 offset:54272
    v_mfma_f32_16x16x32_bf16 v[40:43], v[140:143], v[172:175], v[40:43]
    s_lshl_b32 s34, s34, 10
    s_waitcnt lgkmcnt(4)
    v_mfma_f32_16x16x32_bf16 v[48:51], v[144:147], v[172:175], v[48:51]
    ds_read_b128 v[140:143], v2 offset:55296
    v_mfma_f32_16x16x32_bf16 v[52:55], v[144:147], v[176:179], v[52:55]
    s_add_u32 s83, s79, s34
    v_mfma_f32_16x16x32_bf16 v[60:63], v[148:151], v[176:179], v[60:63]
    ds_read_b128 v[144:147], v2 offset:56320
    v_mfma_f32_16x16x32_bf16 v[56:59], v[148:151], v[172:175], v[56:59]
    buffer_load_dwordx4 v[216:219], v1, s[16:19], s81 offen offset:3072 sc1
    s_waitcnt lgkmcnt(4)
    v_mfma_f32_16x16x32_bf16 v[64:67], v[152:155], v[172:175], v[64:67]
    ds_read_b128 v[148:151], v2 offset:57344
    v_mfma_f32_16x16x32_bf16 v[68:71], v[152:155], v[176:179], v[68:71]
    s_and_b32 s34, s68, 1
    v_mfma_f32_16x16x32_bf16 v[76:79], v[128:131], v[176:179], v[76:79]
    ds_read_b128 v[152:155], v2 offset:58368
    v_mfma_f32_16x16x32_bf16 v[72:75], v[128:131], v[172:175], v[72:75]
    s_lshl_b32 s34, s34, 3
    s_waitcnt lgkmcnt(4)
    v_mfma_f32_16x16x32_bf16 v[80:83], v[132:135], v[172:175], v[80:83]
    ds_read_b128 v[128:131], v2 offset:59392
    v_mfma_f32_16x16x32_bf16 v[84:87], v[132:135], v[176:179], v[84:87]
    s_add_u32 s83, s83, s34
    v_mfma_f32_16x16x32_bf16 v[92:95], v[136:139], v[176:179], v[92:95]
    ds_read_b128 v[132:135], v2 offset:60416
    v_mfma_f32_16x16x32_bf16 v[88:91], v[136:139], v[172:175], v[88:91]
    s_waitcnt lgkmcnt(4)
    v_mfma_f32_16x16x32_bf16 v[96:99], v[140:143], v[172:175], v[96:99]
    ds_read_b128 v[136:139], v2 offset:61440
    v_mfma_f32_16x16x32_bf16 v[100:103], v[140:143], v[176:179], v[100:103]
    s_add_u32 s83, s83, 47104
    v_mfma_f32_16x16x32_bf16 v[108:111], v[144:147], v[176:179], v[108:111]
    ds_read_b128 v[140:143], v2 offset:62464
    v_mfma_f32_16x16x32_bf16 v[104:107], v[144:147], v[172:175], v[104:107]
    s_lshl_b32 s34, s68, 10
    s_waitcnt lgkmcnt(4)
    v_mfma_f32_16x16x32_bf16 v[112:115], v[148:151], v[172:175], v[112:115]
    ds_read_b128 v[144:147], v2 offset:63488
    v_mfma_f32_16x16x32_bf16 v[116:119], v[148:151], v[176:179], v[116:119]
    v_mfma_f32_16x16x32_bf16 v[124:127], v[152:155], v[176:179], v[124:127]
    ds_read_b128 v[148:151], v2 offset:64512
    v_mfma_f32_16x16x32_bf16 v[120:123], v[152:155], v[172:175], v[120:123]
    s_add_u32 s79, s79, s34
    s_waitcnt vmcnt(8) lgkmcnt(4)
    v_mfma_f32_16x16x32_bf16 v[16:19], v[128:131], v[180:183], v[16:19]
    ds_read_b128 v[152:155], v3 offset:0
    v_mfma_f32_16x16x32_bf16 v[20:23], v[128:131], v[184:187], v[20:23]
    s_add_u32 s80, s79, 16384
    v_mfma_f32_16x16x32_bf16 v[28:31], v[132:135], v[184:187], v[28:31]
    ds_read_b128 v[128:131], v3 offset:1024
    v_mfma_f32_16x16x32_bf16 v[24:27], v[132:135], v[180:183], v[24:27]
    v_and_b32 v13, 15, v10
    s_waitcnt lgkmcnt(4)
    v_mfma_f32_16x16x32_bf16 v[32:35], v[136:139], v[180:183], v[32:35]
    ds_read_b128 v[132:135], v3 offset:2048
    v_mfma_f32_16x16x32_bf16 v[36:39], v[136:139], v[184:187], v[36:39]
    s_add_u32 s81, s81, 4096
    buffer_load_dwordx4 v[220:223], v1, s[16:19], s81 offen offset:0 sc1
    v_mfma_f32_16x16x32_bf16 v[44:47], v[140:143], v[184:187], v[44:47]
    ds_read_b128 v[136:139], v3 offset:3072
    v_mfma_f32_16x16x32_bf16 v[40:43], v[140:143], v[180:183], v[40:43]
    v_lshlrev_b32 v13, 2, v13
    s_waitcnt lgkmcnt(4)
    v_mfma_f32_16x16x32_bf16 v[48:51], v[144:147], v[180:183], v[48:51]
    ds_read_b128 v[140:143], v3 offset:4096
    v_mfma_f32_16x16x32_bf16 v[52:55], v[144:147], v[184:187], v[52:55]
    v_mov_b32 v14, 1
    v_mfma_f32_16x16x32_bf16 v[60:63], v[148:151], v[184:187], v[60:63]
    ds_read_b128 v[144:147], v3 offset:5120
    v_mfma_f32_16x16x32_bf16 v[56:59], v[148:151], v[180:183], v[56:59]
    buffer_load_dwordx4 v[224:227], v1, s[16:19], s81 offen offset:1024 sc1
    s_waitcnt lgkmcnt(4)
    v_mfma_f32_16x16x32_bf16 v[64:67], v[152:155], v[180:183], v[64:67]
    ds_read_b128 v[148:151], v3 offset:6144
    v_mfma_f32_16x16x32_bf16 v[68:71], v[152:155], v[184:187], v[68:71]
    s_lshr_b32 s36, s65, 1
    v_mfma_f32_16x16x32_bf16 v[76:79], v[128:131], v[184:187], v[76:79]
    ds_read_b128 v[152:155], v3 offset:7168
    v_mfma_f32_16x16x32_bf16 v[72:75], v[128:131], v[180:183], v[72:75]
    s_lshl_b32 s36, s36, 7
    s_waitcnt lgkmcnt(4)
    v_mfma_f32_16x16x32_bf16 v[80:83], v[132:135], v[180:183], v[80:83]
    s_barrier
    ds_read_b128 v[128:131], v3 offset:8192
    v_mfma_f32_16x16x32_bf16 v[84:87], v[132:135], v[184:187], v[84:87]
    s_andn2_b32 s36, s36, 256
    v_mfma_f32_16x16x32_bf16 v[92:95], v[136:139], v[184:187], v[92:95]
    ds_read_b128 v[132:135], v3 offset:9216
    v_mfma_f32_16x16x32_bf16 v[88:91], v[136:139], v[180:183], v[88:91]
    s_waitcnt lgkmcnt(4)
    v_mfma_f32_16x16x32_bf16 v[96:99], v[140:143], v[180:183], v[96:99]
    ds_read_b128 v[136:139], v3 offset:10240
    v_mfma_f32_16x16x32_bf16 v[100:103], v[140:143], v[184:187], v[100:103]
    s_add_u32 s36, s36, 28094464
    v_mfma_f32_16x16x32_bf16 v[108:111], v[144:147], v[184:187], v[108:111]
    ds_read_b128 v[140:143], v3 offset:11264
    v_mfma_f32_16x16x32_bf16 v[104:107], v[144:147], v[180:183], v[104:107]
    v_and_b32 v5, 256, v1
    s_waitcnt lgkmcnt(4)
    v_mfma_f32_16x16x32_bf16 v[112:115], v[148:151], v[180:183], v[112:115]
    ds_read_b128 v[144:147], v3 offset:12288
    v_mfma_f32_16x16x32_bf16 v[116:119], v[148:151], v[184:187], v[116:119]
    v_mfma_f32_16x16x32_bf16 v[124:127], v[152:155], v[184:187], v[124:127]
    ds_read_b128 v[148:151], v3 offset:13312
    v_mfma_f32_16x16x32_bf16 v[120:123], v[152:155], v[180:183], v[120:123]
    v_add_u32 v13, v13, v5
    s_waitcnt vmcnt(8) lgkmcnt(4)
    v_mfma_f32_16x16x32_bf16 v[16:19], v[128:131], v[188:191], v[16:19]
    ds_read_b128 v[152:155], v3 offset:14336
    v_mfma_f32_16x16x32_bf16 v[20:23], v[128:131], v[192:195], v[20:23]
    s_lshl_b32 s34, s68, 2
    v_mfma_f32_16x16x32_bf16 v[28:31], v[132:135], v[192:195], v[28:31]
    ds_read_b128 v[128:131], v3 offset:15360
    v_mfma_f32_16x16x32_bf16 v[24:27], v[132:135], v[188:191], v[24:27]
    s_add_u32 s78, s82, s34
    s_waitcnt lgkmcnt(4)
    v_mfma_f32_16x16x32_bf16 v[32:35], v[136:139], v[188:191], v[32:35]
    ds_read_b128 v[132:135], v3 offset:16384
    v_mfma_f32_16x16x32_bf16 v[36:39], v[136:139], v[192:195], v[36:39]
    buffer_load_dwordx4 v[228:231], v1, s[16:19], s81 offen offset:2048 sc1
    v_mfma_f32_16x16x32_bf16 v[44:47], v[140:143], v[192:195], v[44:47]
    ds_read_b128 v[136:139], v3 offset:17408
    v_mfma_f32_16x16x32_bf16 v[40:43], v[140:143], v[188:191], v[40:43]
    s_add_u32 s78, s78, 28094464
    s_waitcnt lgkmcnt(4)
    v_mfma_f32_16x16x32_bf16 v[48:51], v[144:147], v[188:191], v[48:51]
    ds_read_b128 v[140:143], v3 offset:18432
    v_mfma_f32_16x16x32_bf16 v[52:55], v[144:147], v[192:195], v[52:55]
    s_cmp_eq_u32 s68, 15
    s_cselect_b32 s80, 2146435072, s80
    v_mfma_f32_16x16x32_bf16 v[60:63], v[148:151], v[192:195], v[60:63]
    ds_read_b128 v[144:147], v3 offset:19456
    v_mfma_f32_16x16x32_bf16 v[56:59], v[148:151], v[188:191], v[56:59]
    buffer_load_dwordx4 v[232:235], v1, s[16:19], s81 offen offset:3072 sc1
    s_waitcnt lgkmcnt(4)
    v_mfma_f32_16x16x32_bf16 v[64:67], v[152:155], v[188:191], v[64:67]
    ds_read_b128 v[148:151], v3 offset:20480
    v_mfma_f32_16x16x32_bf16 v[68:71], v[152:155], v[192:195], v[68:71]
    s_add_u32 s37, s80, 15360
    v_mfma_f32_16x16x32_bf16 v[76:79], v[128:131], v[192:195], v[76:79]
    ds_read_b128 v[152:155], v3 offset:21504
    v_mfma_f32_16x16x32_bf16 v[72:75], v[128:131], v[188:191], v[72:75]
    s_waitcnt lgkmcnt(4)
    v_mfma_f32_16x16x32_bf16 v[80:83], v[132:135], v[188:191], v[80:83]
    ds_read_b128 v[128:131], v3 offset:22528
    v_mfma_f32_16x16x32_bf16 v[84:87], v[132:135], v[192:195], v[84:87]
    v_mfma_f32_16x16x32_bf16 v[92:95], v[136:139], v[192:195], v[92:95]
    ds_read_b128 v[132:135], v3 offset:23552
    v_mfma_f32_16x16x32_bf16 v[88:91], v[136:139], v[188:191], v[88:91]
    s_waitcnt lgkmcnt(4)
    v_mfma_f32_16x16x32_bf16 v[96:99], v[140:143], v[188:191], v[96:99]
    ds_read_b128 v[136:139], v3 offset:24576
    v_mfma_f32_16x16x32_bf16 v[100:103], v[140:143], v[192:195], v[100:103]
    v_mfma_f32_16x16x32_bf16 v[108:111], v[144:147], v[192:195], v[108:111]
    ds_read_b128 v[140:143], v3 offset:25600
    v_mfma_f32_16x16x32_bf16 v[104:107], v[144:147], v[188:191], v[104:107]
    s_waitcnt lgkmcnt(4)
    v_mfma_f32_16x16x32_bf16 v[112:115], v[148:151], v[188:191], v[112:115]
    ds_read_b128 v[144:147], v3 offset:26624
    v_mfma_f32_16x16x32_bf16 v[116:119], v[148:151], v[192:195], v[116:119]
    v_mfma_f32_16x16x32_bf16 v[124:127], v[152:155], v[192:195], v[124:127]
    ds_read_b128 v[148:151], v3 offset:27648
    v_mfma_f32_16x16x32_bf16 v[120:123], v[152:155], v[188:191], v[120:123]
    s_waitcnt vmcnt(8) lgkmcnt(4)
    v_mfma_f32_16x16x32_bf16 v[16:19], v[128:131], v[196:199], v[16:19]
    ds_read_b128 v[152:155], v3 offset:28672
    v_mfma_f32_16x16x32_bf16 v[20:23], v[128:131], v[200:203], v[20:23]
    v_mfma_f32_16x16x32_bf16 v[28:31], v[132:135], v[200:203], v[28:31]
    ds_read_b128 v[128:131], v3 offset:29696
    v_mfma_f32_16x16x32_bf16 v[24:27], v[132:135], v[196:199], v[24:27]
    s_waitcnt lgkmcnt(4)
    v_mfma_f32_16x16x32_bf16 v[32:35], v[136:139], v[196:199], v[32:35]
    ds_read_b128 v[132:135], v3 offset:30720
    v_mfma_f32_16x16x32_bf16 v[36:39], v[136:139], v[200:203], v[36:39]
    v_mfma_f32_16x16x32_bf16 v[44:47], v[140:143], v[200:203], v[44:47]
    ds_read_b128 v[136:139], v3 offset:31744
    v_mfma_f32_16x16x32_bf16 v[40:43], v[140:143], v[196:199], v[40:43]
    s_waitcnt lgkmcnt(4)
    v_mfma_f32_16x16x32_bf16 v[48:51], v[144:147], v[196:199], v[48:51]
    ds_read_b128 v[140:143], v1 offset:0
    v_mfma_f32_16x16x32_bf16 v[52:55], v[144:147], v[200:203], v[52:55]
    v_mfma_f32_16x16x32_bf16 v[60:63], v[148:151], v[200:203], v[60:63]
    ds_read_b128 v[144:147], v1 offset:1024
    v_mfma_f32_16x16x32_bf16 v[56:59], v[148:151], v[196:199], v[56:59]
    s_waitcnt lgkmcnt(4)
    v_mfma_f32_16x16x32_bf16 v[64:67], v[152:155], v[196:199], v[64:67]
    ds_read_b128 v[148:151], v1 offset:2048
    v_mfma_f32_16x16x32_bf16 v[68:71], v[152:155], v[200:203], v[68:71]
    v_mfma_f32_16x16x32_bf16 v[76:79], v[128:131], v[200:203], v[76:79]
    ds_read_b128 v[152:155], v1 offset:3072
    v_mfma_f32_16x16x32_bf16 v[72:75], v[128:131], v[196:199], v[72:75]
    s_waitcnt lgkmcnt(4)
    v_mfma_f32_16x16x32_bf16 v[80:83], v[132:135], v[196:199], v[80:83]
    s_barrier
    ds_read_b128 v[128:131], v1 offset:4096
    v_mfma_f32_16x16x32_bf16 v[84:87], v[132:135], v[200:203], v[84:87]
    v_mfma_f32_16x16x32_bf16 v[92:95], v[136:139], v[200:203], v[92:95]
    ds_read_b128 v[132:135], v1 offset:5120
    v_mfma_f32_16x16x32_bf16 v[88:91], v[136:139], v[196:199], v[88:91]
    s_waitcnt lgkmcnt(4)
    v_mfma_f32_16x16x32_bf16 v[96:99], v[140:143], v[196:199], v[96:99]
    ds_read_b128 v[136:139], v1 offset:6144
    v_mfma_f32_16x16x32_bf16 v[100:103], v[140:143], v[200:203], v[100:103]
    v_mfma_f32_16x16x32_bf16 v[108:111], v[144:147], v[200:203], v[108:111]
    ds_read_b128 v[140:143], v1 offset:7168
    v_mfma_f32_16x16x32_bf16 v[104:107], v[144:147], v[196:199], v[104:107]
    s_waitcnt lgkmcnt(4)
    v_mfma_f32_16x16x32_bf16 v[112:115], v[148:151], v[196:199], v[112:115]
    ds_read_b128 v[144:147], v1 offset:8192
    v_mfma_f32_16x16x32_bf16 v[116:119], v[148:151], v[200:203], v[116:119]
    v_mfma_f32_16x16x32_bf16 v[124:127], v[152:155], v[200:203], v[124:127]
    ds_read_b128 v[148:151], v1 offset:9216
    v_mfma_f32_16x16x32_bf16 v[120:123], v[152:155], v[196:199], v[120:123]
    s_waitcnt vmcnt(6) lgkmcnt(4)
    v_mfma_f32_16x16x32_bf16 v[16:19], v[128:131], v[204:207], v[16:19]
    ds_read_b128 v[152:155], v1 offset:10240
    v_mfma_f32_16x16x32_bf16 v[20:23], v[128:131], v[208:211], v[20:23]
    v_mfma_f32_16x16x32_bf16 v[28:31], v[132:135], v[208:211], v[28:31]
    ds_read_b128 v[128:131], v1 offset:11264
    v_mfma_f32_16x16x32_bf16 v[24:27], v[132:135], v[204:207], v[24:27]
    s_waitcnt lgkmcnt(4)
    v_mfma_f32_16x16x32_bf16 v[32:35], v[136:139], v[204:207], v[32:35]
    ds_read_b128 v[132:135], v1 offset:12288
    v_mfma_f32_16x16x32_bf16 v[36:39], v[136:139], v[208:211], v[36:39]
    v_mfma_f32_16x16x32_bf16 v[44:47], v[140:143], v[208:211], v[44:47]
    ds_read_b128 v[136:139], v1 offset:13312
    v_mfma_f32_16x16x32_bf16 v[40:43], v[140:143], v[204:207], v[40:43]
    s_waitcnt lgkmcnt(4)
    v_mfma_f32_16x16x32_bf16 v[48:51], v[144:147], v[204:207], v[48:51]
    ds_read_b128 v[140:143], v1 offset:14336
    v_mfma_f32_16x16x32_bf16 v[52:55], v[144:147], v[208:211], v[52:55]
    v_mfma_f32_16x16x32_bf16 v[60:63], v[148:151], v[208:211], v[60:63]
    ds_read_b128 v[144:147], v1 offset:15360
    v_mfma_f32_16x16x32_bf16 v[56:59], v[148:151], v[204:207], v[56:59]
    s_waitcnt lgkmcnt(4)
    v_mfma_f32_16x16x32_bf16 v[64:67], v[152:155], v[204:207], v[64:67]
    ds_read_b128 v[148:151], v1 offset:16384
    v_mfma_f32_16x16x32_bf16 v[68:71], v[152:155], v[208:211], v[68:71]
    v_mfma_f32_16x16x32_bf16 v[76:79], v[128:131], v[208:211], v[76:79]
    ds_read_b128 v[152:155], v1 offset:17408
    v_mfma_f32_16x16x32_bf16 v[72:75], v[128:131], v[204:207], v[72:75]
    s_waitcnt lgkmcnt(4)
    v_mfma_f32_16x16x32_bf16 v[80:83], v[132:135], v[204:207], v[80:83]
    ds_read_b128 v[128:131], v1 offset:18432
    v_mfma_f32_16x16x32_bf16 v[84:87], v[132:135], v[208:211], v[84:87]
    v_mfma_f32_16x16x32_bf16 v[92:95], v[136:139], v[208:211], v[92:95]
    ds_read_b128 v[132:135], v1 offset:19456
    v_mfma_f32_16x16x32_bf16 v[88:91], v[136:139], v[204:207], v[88:91]
    s_waitcnt lgkmcnt(4)
    v_mfma_f32_16x16x32_bf16 v[96:99], v[140:143], v[204:207], v[96:99]
    ds_read_b128 v[136:139], v1 offset:20480
    v_mfma_f32_16x16x32_bf16 v[100:103], v[140:143], v[208:211], v[100:103]
    v_mfma_f32_16x16x32_bf16 v[108:111], v[144:147], v[208:211], v[108:111]
    ds_read_b128 v[140:143], v1 offset:21504
    v_mfma_f32_16x16x32_bf16 v[104:107], v[144:147], v[204:207], v[104:107]
    s_waitcnt lgkmcnt(4)
    v_mfma_f32_16x16x32_bf16 v[112:115], v[148:151], v[204:207], v[112:115]
    ds_read_b128 v[144:147], v1 offset:22528
    v_mfma_f32_16x16x32_bf16 v[116:119], v[148:151], v[208:211], v[116:119]
    v_mfma_f32_16x16x32_bf16 v[124:127], v[152:155], v[208:211], v[124:127]
    ds_read_b128 v[148:151], v1 offset:23552
    v_mfma_f32_16x16x32_bf16 v[120:123], v[152:155], v[204:207], v[120:123]
    s_waitcnt vmcnt(4) lgkmcnt(4)
    v_mfma_f32_16x16x32_bf16 v[16:19], v[128:131], v[212:215], v[16:19]
    ds_read_b128 v[152:155], v1 offset:24576
    v_mfma_f32_16x16x32_bf16 v[20:23], v[128:131], v[216:219], v[20:23]
    v_mfma_f32_16x16x32_bf16 v[28:31], v[132:135], v[216:219], v[28:31]
    ds_read_b128 v[128:131], v1 offset:25600
    v_mfma_f32_16x16x32_bf16 v[24:27], v[132:135], v[212:215], v[24:27]
    s_waitcnt lgkmcnt(4)
    v_mfma_f32_16x16x32_bf16 v[32:35], v[136:139], v[212:215], v[32:35]
    ds_read_b128 v[132:135], v1 offset:26624
    v_mfma_f32_16x16x32_bf16 v[36:39], v[136:139], v[216:219], v[36:39]
    v_mfma_f32_16x16x32_bf16 v[44:47], v[140:143], v[216:219], v[44:47]
    ds_read_b128 v[136:139], v1 offset:27648
    v_mfma_f32_16x16x32_bf16 v[40:43], v[140:143], v[212:215], v[40:43]
    s_waitcnt lgkmcnt(4)
    v_mfma_f32_16x16x32_bf16 v[48:51], v[144:147], v[212:215], v[48:51]
    ds_read_b128 v[140:143], v1 offset:28672
    v_mfma_f32_16x16x32_bf16 v[52:55], v[144:147], v[216:219], v[52:55]
    v_mfma_f32_16x16x32_bf16 v[60:63], v[148:151], v[216:219], v[60:63]
    ds_read_b128 v[144:147], v1 offset:29696
    v_mfma_f32_16x16x32_bf16 v[56:59], v[148:151], v[212:215], v[56:59]
    s_waitcnt lgkmcnt(4)
    v_mfma_f32_16x16x32_bf16 v[64:67], v[152:155], v[212:215], v[64:67]
    ds_read_b128 v[148:151], v1 offset:30720
    v_mfma_f32_16x16x32_bf16 v[68:71], v[152:155], v[216:219], v[68:71]
    v_mfma_f32_16x16x32_bf16 v[76:79], v[128:131], v[216:219], v[76:79]
    ds_read_b128 v[152:155], v1 offset:31744
    v_mfma_f32_16x16x32_bf16 v[72:75], v[128:131], v[212:215], v[72:75]
    s_waitcnt lgkmcnt(4)
    v_mfma_f32_16x16x32_bf16 v[80:83], v[132:135], v[212:215], v[80:83]
    s_barrier
    ds_read_b128 v[128:131], v1 offset:32768
    v_mfma_f32_16x16x32_bf16 v[84:87], v[132:135], v[216:219], v[84:87]
    v_mfma_f32_16x16x32_bf16 v[92:95], v[136:139], v[216:219], v[92:95]
    ds_read_b128 v[132:135], v1 offset:33792
    v_mfma_f32_16x16x32_bf16 v[88:91], v[136:139], v[212:215], v[88:91]
    s_waitcnt lgkmcnt(4)
    v_mfma_f32_16x16x32_bf16 v[96:99], v[140:143], v[212:215], v[96:99]
    ds_read_b128 v[136:139], v1 offset:47104
    v_mfma_f32_16x16x32_bf16 v[100:103], v[140:143], v[216:219], v[100:103]
    v_mfma_f32_16x16x32_bf16 v[108:111], v[144:147], v[216:219], v[108:111]
    ds_read_b128 v[140:143], v1 offset:48128
    v_mfma_f32_16x16x32_bf16 v[104:107], v[144:147], v[212:215], v[104:107]
    s_waitcnt lgkmcnt(4)
    v_mfma_f32_16x16x32_bf16 v[112:115], v[148:151], v[212:215], v[112:115]
    ds_read_b128 v[144:147], v1 offset:61440
    v_mfma_f32_16x16x32_bf16 v[116:119], v[148:151], v[216:219], v[116:119]
    v_mfma_f32_16x16x32_bf16 v[124:127], v[152:155], v[216:219], v[124:127]
    ds_read_b128 v[148:151], v1 offset:34816
    v_mfma_f32_16x16x32_bf16 v[120:123], v[152:155], v[212:215], v[120:123]
    s_cmp_lg_u32 s31, 0
    s_waitcnt vmcnt(2) lgkmcnt(4)
    v_mfma_f32_16x16x32_bf16 v[16:19], v[128:131], v[220:223], v[16:19]
    ds_read_b128 v[152:155], v1 offset:35840
    v_mfma_f32_16x16x32_bf16 v[20:23], v[128:131], v[224:227], v[20:23]
    v_mfma_f32_16x16x32_bf16 v[28:31], v[132:135], v[224:227], v[28:31]
    ds_read_b128 v[128:131], v1 offset:49152
    v_mfma_f32_16x16x32_bf16 v[24:27], v[132:135], v[220:223], v[24:27]
    s_waitcnt vmcnt(0) lgkmcnt(4)
    v_mfma_f32_16x16x32_bf16 v[16:19], v[136:139], v[228:231], v[16:19]
    ds_read_b128 v[132:135], v1 offset:50176
    v_mfma_f32_16x16x32_bf16 v[20:23], v[136:139], v[232:235], v[20:23]
    v_mfma_f32_16x16x32_bf16 v[28:31], v[140:143], v[232:235], v[28:31]
    ds_read_b128 v[136:139], v1 offset:62464
    v_mfma_f32_16x16x32_bf16 v[24:27], v[140:143], v[228:231], v[24:27]
    s_waitcnt lgkmcnt(4)
    v_mfma_f32_16x16x16_bf16 v[16:19], v[144:145], v[240:241], v[16:19]
    ds_read_b128 v[140:143], v1 offset:36864
    v_mfma_f32_16x16x16_bf16 v[20:23], v[144:145], v[242:243], v[20:23]
    v_mfma_f32_16x16x16_bf16 v[24:27], v[146:147], v[240:241], v[24:27]
    v_mfma_f32_16x16x16_bf16 v[28:31], v[146:147], v[242:243], v[28:31]
    v_mfma_f32_16x16x32_bf16 v[36:39], v[148:151], v[224:227], v[36:39]
    ds_read_b128 v[144:147], v1 offset:37888
    v_mfma_f32_16x16x32_bf16 v[32:35], v[148:151], v[220:223], v[32:35]
    s_waitcnt lgkmcnt(4)
    v_mfma_f32_16x16x32_bf16 v[40:43], v[152:155], v[220:223], v[40:43]
    ds_read_b128 v[148:151], v1 offset:51200
    v_mfma_f32_16x16x32_bf16 v[44:47], v[152:155], v[224:227], v[44:47]
    v_mfma_f32_16x16x32_bf16 v[36:39], v[128:131], v[232:235], v[36:39]
    ds_read_b128 v[152:155], v1 offset:52224
    v_mfma_f32_16x16x32_bf16 v[32:35], v[128:131], v[228:231], v[32:35]
    v_mul_f32 v16, v16, v24
    v_mul_f32 v17, v17, v25
    v_mul_f32 v18, v18, v26
    v_mul_f32 v19, v19, v27
    s_waitcnt lgkmcnt(4)
    v_mfma_f32_16x16x32_bf16 v[40:43], v[132:135], v[228:231], v[40:43]
    ds_read_b128 v[128:131], v1 offset:63488
    v_mfma_f32_16x16x32_bf16 v[44:47], v[132:135], v[232:235], v[44:47]
    v_mul_f32 v20, v20, v28
    v_mul_f32 v21, v21, v29
    v_mul_f32 v22, v22, v30
    v_mul_f32 v23, v23, v31
    v_mfma_f32_16x16x16_bf16 v[32:35], v[136:137], v[240:241], v[32:35]
    ds_read_b128 v[132:135], v1 offset:38912
    v_mfma_f32_16x16x16_bf16 v[36:39], v[136:137], v[242:243], v[36:39]
    v_mul_f32 v16, v16, v244
    v_mul_f32 v17, v17, v244
    v_mul_f32 v18, v18, v244
    v_mul_f32 v19, v19, v244
    v_mfma_f32_16x16x16_bf16 v[40:43], v[138:139], v[240:241], v[40:43]
    v_mul_f32 v20, v20, v245
    v_mul_f32 v21, v21, v245
    v_mul_f32 v22, v22, v245
    v_mul_f32 v23, v23, v245
    v_mfma_f32_16x16x16_bf16 v[44:47], v[138:139], v[242:243], v[44:47]
    v_cvt_pk_bf16_f32 v156, v16, v17
    v_cvt_pk_bf16_f32 v157, v18, v19
    v_cvt_pk_bf16_f32 v160, v20, v21
    v_cvt_pk_bf16_f32 v161, v22, v23
    s_waitcnt lgkmcnt(4)
    v_mfma_f32_16x16x32_bf16 v[48:51], v[140:143], v[220:223], v[48:51]
    ds_read_b128 v[136:139], v1 offset:39936
    v_mfma_f32_16x16x32_bf16 v[52:55], v[140:143], v[224:227], v[52:55]
    v_mfma_f32_16x16x32_bf16 v[60:63], v[144:147], v[224:227], v[60:63]
    ds_read_b128 v[140:143], v1 offset:53248
    v_mfma_f32_16x16x32_bf16 v[56:59], v[144:147], v[220:223], v[56:59]
    s_waitcnt lgkmcnt(4)
    v_mfma_f32_16x16x32_bf16 v[48:51], v[148:151], v[228:231], v[48:51]
    ds_read_b128 v[144:147], v1 offset:54272
    v_mfma_f32_16x16x32_bf16 v[52:55], v[148:151], v[232:235], v[52:55]
    v_mul_f32 v32, v32, v40
    v_mul_f32 v33, v33, v41
    v_mul_f32 v34, v34, v42
    v_mul_f32 v35, v35, v43
    v_mfma_f32_16x16x32_bf16 v[60:63], v[152:155], v[232:235], v[60:63]
    ds_read_b128 v[148:151], v1 offset:64512
    v_mfma_f32_16x16x32_bf16 v[56:59], v[152:155], v[228:231], v[56:59]
    v_mul_f32 v36, v36, v44
    v_mul_f32 v37, v37, v45
    v_mul_f32 v38, v38, v46
    v_mul_f32 v39, v39, v47
    s_waitcnt lgkmcnt(4)
    v_mfma_f32_16x16x16_bf16 v[48:51], v[128:129], v[240:241], v[48:51]
    ds_read_b128 v[152:155], v1 offset:40960
    v_mfma_f32_16x16x16_bf16 v[52:55], v[128:129], v[242:243], v[52:55]
    v_mul_f32 v32, v32, v244
    v_mul_f32 v33, v33, v244
    v_mul_f32 v34, v34, v244
    v_mul_f32 v35, v35, v244
    v_mfma_f32_16x16x16_bf16 v[56:59], v[130:131], v[240:241], v[56:59]
    v_mul_f32 v36, v36, v245
    v_mul_f32 v37, v37, v245
    v_mul_f32 v38, v38, v245
    v_mul_f32 v39, v39, v245
    v_mfma_f32_16x16x16_bf16 v[60:63], v[130:131], v[242:243], v[60:63]
    v_cvt_pk_bf16_f32 v158, v32, v33
    v_cvt_pk_bf16_f32 v159, v34, v35
    v_cvt_pk_bf16_f32 v162, v36, v37
    v_cvt_pk_bf16_f32 v163, v38, v39
    v_mfma_f32_16x16x32_bf16 v[68:71], v[132:135], v[224:227], v[68:71]
    ds_read_b128 v[128:131], v1 offset:41984
    v_mfma_f32_16x16x32_bf16 v[64:67], v[132:135], v[220:223], v[64:67]
    s_cbranch_scc1 L_ms60
    buffer_store_dwordx4 v[156:159], v1, s[16:19], s79 offen
L_mb60:
    s_cbranch_scc1 L_ms61
    buffer_store_dwordx4 v[160:163], v15, s[16:19], s79 offen
L_mb61:
    s_waitcnt lgkmcnt(4)
    v_mfma_f32_16x16x32_bf16 v[72:75], v[136:139], v[220:223], v[72:75]
    ds_read_b128 v[132:135], v1 offset:55296
    v_mfma_f32_16x16x32_bf16 v[76:79], v[136:139], v[224:227], v[76:79]
    v_mfma_f32_16x16x32_bf16 v[68:71], v[140:143], v[232:235], v[68:71]
    ds_read_b128 v[136:139], v1 offset:56320
    v_mfma_f32_16x16x32_bf16 v[64:67], v[140:143], v[228:231], v[64:67]
    v_mul_f32 v48, v48, v56
    v_mul_f32 v49, v49, v57
    v_mul_f32 v50, v50, v58
    v_mul_f32 v51, v51, v59
    s_waitcnt lgkmcnt(4)
    v_mfma_f32_16x16x32_bf16 v[72:75], v[144:147], v[228:231], v[72:75]
    ds_read_b128 v[140:143], v2 offset:0
    v_mfma_f32_16x16x32_bf16 v[76:79], v[144:147], v[232:235], v[76:79]
    v_mul_f32 v52, v52, v60
    v_mul_f32 v53, v53, v61
    v_mul_f32 v54, v54, v62
    v_mul_f32 v55, v55, v63
    v_mfma_f32_16x16x16_bf16 v[64:67], v[148:149], v[240:241], v[64:67]
    ds_read_b128 v[144:147], v1 offset:43008
    v_mfma_f32_16x16x16_bf16 v[68:71], v[148:149], v[242:243], v[68:71]
    v_mul_f32 v48, v48, v244
    v_mul_f32 v49, v49, v244
    v_mul_f32 v50, v50, v244
    v_mul_f32 v51, v51, v244
    v_mfma_f32_16x16x16_bf16 v[72:75], v[150:151], v[240:241], v[72:75]
    v_mul_f32 v52, v52, v245
    v_mul_f32 v53, v53, v245
    v_mul_f32 v54, v54, v245
    v_mul_f32 v55, v55, v245
    v_mfma_f32_16x16x16_bf16 v[76:79], v[150:151], v[242:243], v[76:79]
    v_cvt_pk_bf16_f32 v164, v48, v49
    v_cvt_pk_bf16_f32 v165, v50, v51
    v_cvt_pk_bf16_f32 v168, v52, v53
    v_cvt_pk_bf16_f32 v169, v54, v55
    s_waitcnt lgkmcnt(4)
    v_mfma_f32_16x16x32_bf16 v[80:83], v[152:155], v[220:223], v[80:83]
    ds_read_b128 v[148:151], v1 offset:44032
    v_mfma_f32_16x16x32_bf16 v[84:87], v[152:155], v[224:227], v[84:87]
    v_mfma_f32_16x16x32_bf16 v[92:95], v[128:131], v[224:227], v[92:95]
    ds_read_b128 v[152:155], v1 offset:57344
    v_mfma_f32_16x16x32_bf16 v[88:91], v[128:131], v[220:223], v[88:91]
    s_waitcnt lgkmcnt(4)
    v_mfma_f32_16x16x32_bf16 v[80:83], v[132:135], v[228:231], v[80:83]
    ds_read_b128 v[128:131], v1 offset:58368
    v_mfma_f32_16x16x32_bf16 v[84:87], v[132:135], v[232:235], v[84:87]
    v_mul_f32 v64, v64, v72
    v_mul_f32 v65, v65, v73
    v_mul_f32 v66, v66, v74
    v_mul_f32 v67, v67, v75
    v_mfma_f32_16x16x32_bf16 v[92:95], v[136:139], v[232:235], v[92:95]
    ds_read_b128 v[132:135], v2 offset:1024
    v_mfma_f32_16x16x32_bf16 v[88:91], v[136:139], v[228:231], v[88:91]
    v_mul_f32 v68, v68, v76
    v_mul_f32 v69, v69, v77
    v_mul_f32 v70, v70, v78
    v_mul_f32 v71, v71, v79
    s_waitcnt lgkmcnt(4)
    v_mfma_f32_16x16x16_bf16 v[80:83], v[140:141], v[240:241], v[80:83]
    ds_read_b128 v[136:139], v1 offset:45056
    v_mfma_f32_16x16x16_bf16 v[84:87], v[140:141], v[242:243], v[84:87]
    v_mul_f32 v64, v64, v244
    v_mul_f32 v65, v65, v244
    v_mul_f32 v66, v66, v244
    v_mul_f32 v67, v67, v244
    v_mfma_f32_16x16x16_bf16 v[88:91], v[142:143], v[240:241], v[88:91]
    v_mul_f32 v68, v68, v245
    v_mul_f32 v69, v69, v245
    v_mul_f32 v70, v70, v245
    v_mul_f32 v71, v71, v245
    v_mfma_f32_16x16x16_bf16 v[92:95], v[142:143], v[242:243], v[92:95]
    v_cvt_pk_bf16_f32 v166, v64, v65
    v_cvt_pk_bf16_f32 v167, v66, v67
    v_cvt_pk_bf16_f32 v170, v68, v69
    v_cvt_pk_bf16_f32 v171, v70, v71
    v_mfma_f32_16x16x32_bf16 v[100:103], v[144:147], v[224:227], v[100:103]
    ds_read_b128 v[140:143], v1 offset:46080
    v_mfma_f32_16x16x32_bf16 v[96:99], v[144:147], v[220:223], v[96:99]
    s_cbranch_scc1 L_ms62
    buffer_store_dwordx4 v[164:167], v1, s[16:19], s80 offen
L_mb62:
    s_cbranch_scc1 L_ms63
    buffer_store_dwordx4 v[168:171], v15, s[16:19], s80 offen
L_mb63:
    s_waitcnt lgkmcnt(4)
    v_mfma_f32_16x16x32_bf16 v[104:107], v[148:151], v[220:223], v[104:107]
    ds_read_b128 v[144:147], v1 offset:59392
    v_mfma_f32_16x16x32_bf16 v[108:111], v[148:151], v[224:227], v[108:111]
    v_mfma_f32_16x16x32_bf16 v[100:103], v[152:155], v[232:235], v[100:103]
    ds_read_b128 v[148:151], v1 offset:60416
    v_mfma_f32_16x16x32_bf16 v[96:99], v[152:155], v[228:231], v[96:99]
    v_mul_f32 v80, v80, v88
    v_mul_f32 v81, v81, v89
    v_mul_f32 v82, v82, v90
    v_mul_f32 v83, v83, v91
    s_waitcnt lgkmcnt(4)
    v_mfma_f32_16x16x32_bf16 v[104:107], v[128:131], v[228:231], v[104:107]
    ds_read_b128 v[152:155], v2 offset:2048
    v_mfma_f32_16x16x32_bf16 v[108:111], v[128:131], v[232:235], v[108:111]
    v_mul_f32 v84, v84, v92
    v_mul_f32 v85, v85, v93
    v_mul_f32 v86, v86, v94
    v_mul_f32 v87, v87, v95
    v_mfma_f32_16x16x16_bf16 v[96:99], v[132:133], v[240:241], v[96:99]
    v_mul_f32 v80, v80, v244
    v_mul_f32 v81, v81, v244
    v_mul_f32 v82, v82, v244
    v_mul_f32 v83, v83, v244
    v_mfma_f32_16x16x16_bf16 v[100:103], v[132:133], v[242:243], v[100:103]
    v_mul_f32 v84, v84, v245
    v_mul_f32 v85, v85, v245
    v_mul_f32 v86, v86, v245
    v_mul_f32 v87, v87, v245
    v_mfma_f32_16x16x16_bf16 v[104:107], v[134:135], v[240:241], v[104:107]
    v_cvt_pk_bf16_f32 v172, v80, v81
    v_cvt_pk_bf16_f32 v173, v82, v83
    v_cvt_pk_bf16_f32 v176, v84, v85
    v_cvt_pk_bf16_f32 v177, v86, v87
    v_mfma_f32_16x16x16_bf16 v[108:111], v[134:135], v[242:243], v[108:111]
    s_waitcnt lgkmcnt(3)
    v_mfma_f32_16x16x32_bf16 v[112:115], v[136:139], v[220:223], v[112:115]
    v_mfma_f32_16x16x32_bf16 v[116:119], v[136:139], v[224:227], v[116:119]
    v_mfma_f32_16x16x32_bf16 v[124:127], v[140:143], v[224:227], v[124:127]
    v_mfma_f32_16x16x32_bf16 v[120:123], v[140:143], v[220:223], v[120:123]
    s_waitcnt vmcnt(2)
    s_cbranch_scc1 L_ms64
    buffer_store_dword v14, off, s[16:19], s78 offset:64
L_mb64:
    s_waitcnt lgkmcnt(1)
    v_mfma_f32_16x16x32_bf16 v[112:115], v[144:147], v[228:231], v[112:115]
    v_mfma_f32_16x16x32_bf16 v[116:119], v[144:147], v[232:235], v[116:119]
    v_mul_f32 v96, v96, v104
    v_mul_f32 v97, v97, v105
    v_mul_f32 v98, v98, v106
    v_mul_f32 v99, v99, v107
    v_mfma_f32_16x16x32_bf16 v[124:127], v[148:151], v[232:235], v[124:127]
    v_mul_f32 v100, v100, v108
    v_mul_f32 v101, v101, v109
    v_mul_f32 v102, v102, v110
    v_mul_f32 v103, v103, v111
    v_mfma_f32_16x16x32_bf16 v[120:123], v[148:151], v[228:231], v[120:123]
    v_mul_f32 v96, v96, v244
    v_mul_f32 v97, v97, v244
    v_mul_f32 v98, v98, v244
    v_mul_f32 v99, v99, v244
    s_waitcnt lgkmcnt(0)
    v_mfma_f32_16x16x16_bf16 v[112:115], v[152:153], v[240:241], v[112:115]
    v_mul_f32 v100, v100, v245
    v_mul_f32 v101, v101, v245
    v_mul_f32 v102, v102, v245
    v_mul_f32 v103, v103, v245
    v_mfma_f32_16x16x16_bf16 v[116:119], v[152:153], v[242:243], v[116:119]
    v_cvt_pk_bf16_f32 v174, v96, v97
    v_cvt_pk_bf16_f32 v175, v98, v99
    v_cvt_pk_bf16_f32 v178, v100, v101
    v_cvt_pk_bf16_f32 v179, v102, v103
    v_mfma_f32_16x16x16_bf16 v[120:123], v[154:155], v[240:241], v[120:123]
    s_cbranch_scc1 L_ms65
    buffer_store_dwordx4 v[172:175], v1, s[16:19], s37 offen
L_mb65:
    s_cbranch_scc1 L_ms66
    buffer_store_dwordx4 v[176:179], v15, s[16:19], s37 offen
L_mb66:
    v_mfma_f32_16x16x16_bf16 v[124:127], v[154:155], v[242:243], v[124:127]
    s_barrier
    buffer_load_dword v9, v13, s[16:19], s36 offen offset:64 sc1
    s_nop 5
    v_pk_mul_f32 v[112:113], v[112:113], v[120:121]
    v_pk_mul_f32 v[114:115], v[114:115], v[122:123]
    v_pk_mul_f32 v[116:117], v[116:117], v[124:125]
    v_pk_mul_f32 v[118:119], v[118:119], v[126:127]
    v_pk_mul_f32 v[112:113], v[112:113], v[244:245] op_sel:[0,0] op_sel_hi:[1,0]
    v_pk_mul_f32 v[114:115], v[114:115], v[244:245] op_sel:[0,0] op_sel_hi:[1,0]
    v_pk_mul_f32 v[116:117], v[116:117], v[244:245] op_sel:[0,1] op_sel_hi:[1,1]
    v_pk_mul_f32 v[118:119], v[118:119], v[244:245] op_sel:[0,1] op_sel_hi:[1,1]
    v_cvt_pk_bf16_f32 v180, v112, v113
    v_cvt_pk_bf16_f32 v181, v114, v115
    v_cvt_pk_bf16_f32 v184, v116, v117
    v_cvt_pk_bf16_f32 v185, v118, v119
    s_cbranch_scc1 L_ms67
    buffer_store_dwordx2 v[180:181], v1, s[16:19], s83 offen
L_mb67:
    s_cbranch_scc1 L_ms68
    buffer_store_dwordx2 v[184:185], v15, s[16:19], s83 offen
L_mb68:
    s_mul_i32 s81, s65, 55296
    s_add_u32 s81, s81, 13238272
    s_mov_b32 s56, 400000
    s_and_b32 s34, s30, 1
    s_lshl_b32 s35, s34, 10
    s_add_u32 s81, s81, s35
    s_mul_i32 s34, s34, 442368
    s_sub_u32 s38, s81, s34
    s_add_u32 s38, s38, 221184
    s_waitcnt vmcnt(2)
L_rc69:
    v_cmp_eq_u32 vcc, 0, v9
    s_nop 0
    s_cbranch_vccnz L_rr69
L_ro69:
    buffer_load_dwordx4 v[116:119], v1, s[16:19], s38 offen offset:0 sc1
    buffer_load_dwordx4 v[120:123], v1, s[16:19], s81 offen offset:0 sc1
    buffer_load_dwordx4 v[124:127], v1, s[16:19], s38 offen offset:2048 sc1
    buffer_load_dwordx4 v[128:131], v1, s[16:19], s81 offen offset:2048 sc1
    s_add_u32 s38, s38, 4096
    buffer_load_dwordx4 v[132:135], v1, s[16:19], s38 offen offset:0 sc1
    s_add_u32 s81, s81, 4096
    buffer_load_dwordx4 v[136:139], v1, s[16:19], s81 offen offset:0 sc1
    buffer_load_dwordx4 v[140:143], v1, s[16:19], s38 offen offset:2048 sc1
    buffer_load_dwordx4 v[144:147], v1, s[16:19], s81 offen offset:2048 sc1
    v_mov_b32 v4, 1
    ds_read_b128 v[56:59], v2 offset:4096
    ds_read_b128 v[60:63], v2 offset:5120
    ds_read_b128 v[64:67], v2 offset:6144
    ds_read_b128 v[68:71], v2 offset:7168
    ds_read_b128 v[72:75], v2 offset:8192
    ds_read_b128 v[76:79], v2 offset:9216
    ds_read_b128 v[80:83], v2 offset:10240
    ds_read_b128 v[84:87], v2 offset:11264
    ds_read_b128 v[88:91], v2 offset:12288
    ds_read_b128 v[92:95], v2 offset:13312
    v_lshlrev_b32 v16, 16, v246
    v_and_b32 v17, 0xffff0000, v246
    v_lshlrev_b32 v18, 16, v247
    v_and_b32 v19, 0xffff0000, v247
    v_lshlrev_b32 v20, 16, v248
    v_and_b32 v21, 0xffff0000, v248
    v_lshlrev_b32 v22, 16, v249
    v_and_b32 v23, 0xffff0000, v249
    v_lshlrev_b32 v24, 16, v250
    v_and_b32 v25, 0xffff0000, v250
    v_lshlrev_b32 v26, 16, v251
    v_and_b32 v27, 0xffff0000, v251
    v_lshlrev_b32 v28, 16, v252
    v_and_b32 v29, 0xffff0000, v252
    v_lshlrev_b32 v30, 16, v253
    v_and_b32 v31, 0xffff0000, v253
    v_lshlrev_b32 v32, 16, v254
    v_and_b32 v33, 0xffff0000, v254
    v_lshlrev_b32 v34, 16, v255
    v_and_b32 v35, 0xffff0000, v255
    s_barrier
    s_waitcnt vmcnt(6) lgkmcnt(5)
    s_cmp_lg_u32 s31, 0
    s_cbranch_scc1 L_ms70
    buffer_store_dword v4, off, s[16:19], s78
L_mb70:
    v_mfma_f32_16x16x32_bf16 v[36:39], v[56:59], v[116:119], 0
    ds_read_b128 v[96:99], v2 offset:14336
    v_mfma_f32_16x16x32_bf16 v[16:19], v[56:59], v[120:123], v[16:19]
    s_add_u32 s38, s38, 4096
    buffer_load_dwordx4 v[148:151], v1, s[16:19], s38 offen offset:0 sc1
    v_mfma_f32_16x16x32_bf16 v[20:23], v[60:63], v[120:123], v[20:23]
    ds_read_b128 v[100:103], v2 offset:15360
    v_mfma_f32_16x16x32_bf16 v[40:43], v[60:63], v[116:119], 0
    s_add_u32 s81, s81, 4096
    buffer_load_dwordx4 v[152:155], v1, s[16:19], s81 offen offset:0 sc1
    v_mfma_f32_16x16x32_bf16 v[44:47], v[64:67], v[116:119], 0
    ds_read_b128 v[104:107], v2 offset:16384
    v_mfma_f32_16x16x32_bf16 v[24:27], v[64:67], v[120:123], v[24:27]
    v_mfma_f32_16x16x32_bf16 v[28:31], v[68:71], v[120:123], v[28:31]
    ds_read_b128 v[108:111], v2 offset:17408
    v_mfma_f32_16x16x32_bf16 v[48:51], v[68:71], v[116:119], 0
    buffer_load_dwordx4 v[156:159], v1, s[16:19], s38 offen offset:2048 sc1
    v_mfma_f32_16x16x32_bf16 v[52:55], v[72:75], v[116:119], 0
    ds_read_b128 v[112:115], v2 offset:18432
    v_mfma_f32_16x16x32_bf16 v[32:35], v[72:75], v[120:123], v[32:35]
    s_waitcnt vmcnt(8) lgkmcnt(5)
    v_mfma_f32_16x16x32_bf16 v[36:39], v[76:79], v[124:127], v[36:39]
    ds_read_b128 v[56:59], v2 offset:19456
    v_mfma_f32_16x16x32_bf16 v[16:19], v[76:79], v[128:131], v[16:19]
    buffer_load_dwordx4 v[160:163], v1, s[16:19], s81 offen offset:2048 sc1
    v_mfma_f32_16x16x32_bf16 v[20:23], v[80:83], v[128:131], v[20:23]
    ds_read_b128 v[60:63], v2 offset:20480
    v_mfma_f32_16x16x32_bf16 v[40:43], v[80:83], v[124:127], v[40:43]
    s_add_u32 s38, s38, 4096
    buffer_load_dwordx4 v[164:167], v1, s[16:19], s38 offen offset:0 sc1
    v_mfma_f32_16x16x32_bf16 v[44:47], v[84:87], v[124:127], v[44:47]
    ds_read_b128 v[64:67], v2 offset:21504
    v_mfma_f32_16x16x32_bf16 v[24:27], v[84:87], v[128:131], v[24:27]
    v_mfma_f32_16x16x32_bf16 v[28:31], v[88:91], v[128:131], v[28:31]
    ds_read_b128 v[68:71], v2 offset:22528
    v_mfma_f32_16x16x32_bf16 v[48:51], v[88:91], v[124:127], v[48:51]
    s_add_u32 s81, s81, 4096
    buffer_load_dwordx4 v[168:171], v1, s[16:19], s81 offen offset:0 sc1
    v_mfma_f32_16x16x32_bf16 v[52:55], v[92:95], v[124:127], v[52:55]
    ds_read_b128 v[72:75], v2 offset:23552
    v_mfma_f32_16x16x32_bf16 v[32:35], v[92:95], v[128:131], v[32:35]
    s_waitcnt vmcnt(9) lgkmcnt(5)
    buffer_load_dword v9, v13, s[16:19], s36 offen sc1
    v_mfma_f32_16x16x32_bf16 v[36:39], v[96:99], v[132:135], v[36:39]
    ds_read_b128 v[76:79], v2 offset:24576
    v_mfma_f32_16x16x32_bf16 v[16:19], v[96:99], v[136:139], v[16:19]
    buffer_load_dwordx4 v[172:175], v1, s[16:19], s38 offen offset:2048 sc1
    v_mfma_f32_16x16x32_bf16 v[20:23], v[100:103], v[136:139], v[20:23]
    ds_read_b128 v[80:83], v2 offset:25600
    v_mfma_f32_16x16x32_bf16 v[40:43], v[100:103], v[132:135], v[40:43]
    buffer_load_dwordx4 v[176:179], v1, s[16:19], s81 offen offset:2048 sc1
    v_mfma_f32_16x16x32_bf16 v[44:47], v[104:107], v[132:135], v[44:47]
    ds_read_b128 v[84:87], v2 offset:26624
    v_mfma_f32_16x16x32_bf16 v[24:27], v[104:107], v[136:139], v[24:27]
    v_mfma_f32_16x16x32_bf16 v[28:31], v[108:111], v[136:139], v[28:31]
    ds_read_b128 v[88:91], v2 offset:27648
    v_mfma_f32_16x16x32_bf16 v[48:51], v[108:111], v[132:135], v[48:51]
    v_mfma_f32_16x16x32_bf16 v[52:55], v[112:115], v[132:135], v[52:55]
    ds_read_b128 v[92:95], v2 offset:28672
    v_mfma_f32_16x16x32_bf16 v[32:35], v[112:115], v[136:139], v[32:35]
    s_waitcnt vmcnt(10) lgkmcnt(5)
    v_mfma_f32_16x16x32_bf16 v[36:39], v[56:59], v[140:143], v[36:39]
    ds_read_b128 v[96:99], v2 offset:29696
    v_mfma_f32_16x16x32_bf16 v[16:19], v[56:59], v[144:147], v[16:19]
    v_mfma_f32_16x16x32_bf16 v[20:23], v[60:63], v[144:147], v[20:23]
    ds_read_b128 v[100:103], v2 offset:30720
    v_mfma_f32_16x16x32_bf16 v[40:43], v[60:63], v[140:143], v[40:43]
    v_mfma_f32_16x16x32_bf16 v[44:47], v[64:67], v[140:143], v[44:47]
    ds_read_b128 v[104:107], v2 offset:31744
    v_mfma_f32_16x16x32_bf16 v[24:27], v[64:67], v[144:147], v[24:27]
    v_mfma_f32_16x16x32_bf16 v[28:31], v[68:71], v[144:147], v[28:31]
    ds_read_b128 v[108:111], v2 offset:32768
    v_mfma_f32_16x16x32_bf16 v[48:51], v[68:71], v[140:143], v[48:51]
    v_mfma_f32_16x16x32_bf16 v[52:55], v[72:75], v[140:143], v[52:55]
    ds_read_b128 v[112:115], v2 offset:33792
    v_mfma_f32_16x16x32_bf16 v[32:35], v[72:75], v[144:147], v[32:35]
    s_waitcnt vmcnt(7) lgkmcnt(5)
    s_waitcnt vmcnt(2)
L_rc71:
    v_cmp_eq_u32 vcc, 0, v9
    s_nop 0
    s_cbranch_vccnz L_rr71
L_ro71:
    v_mfma_f32_16x16x32_bf16 v[36:39], v[76:79], v[148:151], v[36:39]
    ds_read_b128 v[56:59], v2 offset:34816
    v_mfma_f32_16x16x32_bf16 v[16:19], v[76:79], v[152:155], v[16:19]
    s_add_u32 s38, s38, 4096
    buffer_load_dwordx4 v[180:183], v1, s[16:19], s38 offen offset:0 sc1
    v_mfma_f32_16x16x32_bf16 v[20:23], v[80:83], v[152:155], v[20:23]
    ds_read_b128 v[60:63], v2 offset:35840
    v_mfma_f32_16x16x32_bf16 v[40:43], v[80:83], v[148:151], v[40:43]
    s_add_u32 s81, s81, 4096
    buffer_load_dwordx4 v[184:187], v1, s[16:19], s81 offen offset:0 sc1
    v_mfma_f32_16x16x32_bf16 v[44:47], v[84:87], v[148:151], v[44:47]
    ds_read_b128 v[64:67], v2 offset:36864
    v_mfma_f32_16x16x32_bf16 v[24:27], v[84:87], v[152:155], v[24:27]
    v_mfma_f32_16x16x32_bf16 v[28:31], v[88:91], v[152:155], v[28:31]
    ds_read_b128 v[68:71], v2 offset:37888
    v_mfma_f32_16x16x32_bf16 v[48:51], v[88:91], v[148:151], v[48:51]
    buffer_load_dwordx4 v[188:191], v1, s[16:19], s38 offen offset:2048 sc1
    v_mfma_f32_16x16x32_bf16 v[52:55], v[92:95], v[148:151], v[52:55]
    ds_read_b128 v[72:75], v2 offset:38912
    v_mfma_f32_16x16x32_bf16 v[32:35], v[92:95], v[152:155], v[32:35]
    s_waitcnt vmcnt(8) lgkmcnt(5)
    v_mfma_f32_16x16x32_bf16 v[36:39], v[96:99], v[156:159], v[36:39]
    ds_read_b128 v[76:79], v2 offset:39936
    v_mfma_f32_16x16x32_bf16 v[16:19], v[96:99], v[160:163], v[16:19]
    buffer_load_dwordx4 v[192:195], v1, s[16:19], s81 offen offset:2048 sc1
    v_mfma_f32_16x16x32_bf16 v[20:23], v[100:103], v[160:163], v[20:23]
    ds_read_b128 v[80:83], v2 offset:40960
    v_mfma_f32_16x16x32_bf16 v[40:43], v[100:103], v[156:159], v[40:43]
    s_add_u32 s38, s38, 4096
    buffer_load_dwordx4 v[116:119], v1, s[16:19], s38 offen offset:0 sc1
    v_mfma_f32_16x16x32_bf16 v[44:47], v[104:107], v[156:159], v[44:47]
    ds_read_b128 v[84:87], v2 offset:41984
    v_mfma_f32_16x16x32_bf16 v[24:27], v[104:107], v[160:163], v[24:27]
    v_mfma_f32_16x16x32_bf16 v[28:31], v[108:111], v[160:163], v[28:31]
    ds_read_b128 v[88:91], v2 offset:43008
    v_mfma_f32_16x16x32_bf16 v[48:51], v[108:111], v[156:159], v[48:51]
    s_add_u32 s81, s81, 4096
    buffer_load_dwordx4 v[120:123], v1, s[16:19], s81 offen offset:0 sc1
    v_mfma_f32_16x16x32_bf16 v[52:55], v[112:115], v[156:159], v[52:55]
    ds_read_b128 v[92:95], v2 offset:44032
    v_mfma_f32_16x16x32_bf16 v[32:35], v[112:115], v[160:163], v[32:35]
    s_waitcnt vmcnt(9) lgkmcnt(5)
    s_barrier
    v_mfma_f32_16x16x32_bf16 v[36:39], v[56:59], v[164:167], v[36:39]
    ds_read_b128 v[96:99], v2 offset:45056
    v_mfma_f32_16x16x32_bf16 v[16:19], v[56:59], v[168:171], v[16:19]
    buffer_load_dwordx4 v[124:127], v1, s[16:19], s38 offen offset:2048 sc1
    v_mfma_f32_16x16x32_bf16 v[20:23], v[60:63], v[168:171], v[20:23]
    ds_read_b128 v[100:103], v2 offset:46080
    v_mfma_f32_16x16x32_bf16 v[40:43], v[60:63], v[164:167], v[40:43]
    buffer_load_dwordx4 v[128:131], v1, s[16:19], s81 offen offset:2048 sc1
    v_mfma_f32_16x16x32_bf16 v[44:47], v[64:67], v[164:167], v[44:47]
    ds_read_b128 v[104:107], v2 offset:47104
    v_mfma_f32_16x16x32_bf16 v[24:27], v[64:67], v[168:171], v[24:27]
    v_mfma_f32_16x16x32_bf16 v[28:31], v[68:71], v[168:171], v[28:31]
    ds_read_b128 v[108:111], v2 offset:48128
    v_mfma_f32_16x16x32_bf16 v[48:51], v[68:71], v[164:167], v[48:51]
    s_add_u32 s38, s38, 4096
    buffer_load_dwordx4 v[132:135], v1, s[16:19], s38 offen offset:0 sc1
    v_mfma_f32_16x16x32_bf16 v[52:55], v[72:75], v[164:167], v[52:55]
    ds_read_b128 v[112:115], v2 offset:49152
    v_mfma_f32_16x16x32_bf16 v[32:35], v[72:75], v[168:171], v[32:35]
    s_waitcnt vmcnt(9) lgkmcnt(5)
    v_mfma_f32_16x16x32_bf16 v[36:39], v[76:79], v[172:175], v[36:39]
    ds_read_b128 v[56:59], v2 offset:50176
    v_mfma_f32_16x16x32_bf16 v[16:19], v[76:79], v[176:179], v[16:19]
    s_add_u32 s81, s81, 4096
    buffer_load_dwordx4 v[136:139], v1, s[16:19], s81 offen offset:0 sc1
    v_mfma_f32_16x16x32_bf16 v[20:23], v[80:83], v[176:179], v[20:23]
    ds_read_b128 v[60:63], v2 offset:51200
    v_mfma_f32_16x16x32_bf16 v[40:43], v[80:83], v[172:175], v[40:43]
    buffer_load_dwordx4 v[140:143], v1, s[16:19], s38 offen offset:2048 sc1
    v_mfma_f32_16x16x32_bf16 v[44:47], v[84:87], v[172:175], v[44:47]
    ds_read_b128 v[64:67], v2 offset:52224
    v_mfma_f32_16x16x32_bf16 v[24:27], v[84:87], v[176:179], v[24:27]
    s_lshr_b32 s43, s65, 3
    s_lshl_b32 s43, s43, 2
    s_add_u32 s43, s43, s87
    v_mfma_f32_16x16x32_bf16 v[28:31], v[88:91], v[176:179], v[28:31]
    ds_read_b128 v[68:71], v2 offset:53248
    v_mfma_f32_16x16x32_bf16 v[48:51], v[88:91], v[172:175], v[48:51]
    buffer_load_dwordx4 v[144:147], v1, s[16:19], s81 offen offset:2048 sc1
    v_mfma_f32_16x16x32_bf16 v[52:55], v[92:95], v[172:175], v[52:55]
    ds_read_b128 v[72:75], v2 offset:54272
    v_mfma_f32_16x16x32_bf16 v[32:35], v[92:95], v[176:179], v[32:35]
    s_lshl_b32 s43, s43, 7
    s_add_u32 s43, s43, 28069952
    s_and_b32 s44, s30, 1
    s_waitcnt vmcnt(10) lgkmcnt(5)
    v_mfma_f32_16x16x32_bf16 v[36:39], v[96:99], v[180:183], v[36:39]
    ds_read_b128 v[76:79], v2 offset:55296
    v_mfma_f32_16x16x32_bf16 v[16:19], v[96:99], v[184:187], v[16:19]
    s_add_u32 s38, s38, 4096
    buffer_load_dwordx4 v[148:151], v1, s[16:19], s38 offen offset:0 sc1
    v_mfma_f32_16x16x32_bf16 v[20:23], v[100:103], v[184:187], v[20:23]
    ds_read_b128 v[80:83], v2 offset:56320
    v_mfma_f32_16x16x32_bf16 v[40:43], v[100:103], v[180:183], v[40:43]
    s_add_u32 s81, s81, 4096
    buffer_load_dwordx4 v[152:155], v1, s[16:19], s81 offen offset:0 sc1
    v_mfma_f32_16x16x32_bf16 v[44:47], v[104:107], v[180:183], v[44:47]
    ds_read_b128 v[84:87], v2 offset:57344
    v_mfma_f32_16x16x32_bf16 v[24:27], v[104:107], v[184:187], v[24:27]
    s_lshl_b32 s3, s67, 1
    s_add_u32 s44, s44, s3
    s_lshl_b32 s44, s44, 2
    v_mfma_f32_16x16x32_bf16 v[28:31], v[108:111], v[184:187], v[28:31]
    ds_read_b128 v[88:91], v2 offset:58368
    v_mfma_f32_16x16x32_bf16 v[48:51], v[108:111], v[180:183], v[48:51]
    buffer_load_dwordx4 v[156:159], v1, s[16:19], s38 offen offset:2048 sc1
    v_mfma_f32_16x16x32_bf16 v[52:55], v[112:115], v[180:183], v[52:55]
    ds_read_b128 v[92:95], v2 offset:59392
    v_mfma_f32_16x16x32_bf16 v[32:35], v[112:115], v[184:187], v[32:35]
    s_add_u32 s44, s44, s43
    v_and_b32 v13, 0x3c, v13
    s_lshl_b32 s34, s28, 12
    s_waitcnt vmcnt(11) lgkmcnt(5)
    v_mfma_f32_16x16x32_bf16 v[36:39], v[56:59], v[188:191], v[36:39]
    ds_read_b128 v[96:99], v2 offset:60416
    v_mfma_f32_16x16x32_bf16 v[16:19], v[56:59], v[192:195], v[16:19]
    buffer_load_dwordx4 v[160:163], v1, s[16:19], s81 offen offset:2048 sc1
    v_mfma_f32_16x16x32_bf16 v[20:23], v[60:63], v[192:195], v[20:23]
    ds_read_b128 v[100:103], v2 offset:61440
    v_mfma_f32_16x16x32_bf16 v[40:43], v[60:63], v[188:191], v[40:43]
    s_add_u32 s38, s38, 4096
    buffer_load_dwordx4 v[164:167], v1, s[16:19], s38 offen offset:0 sc1
    v_mfma_f32_16x16x32_bf16 v[44:47], v[64:67], v[188:191], v[44:47]
    ds_read_b128 v[104:107], v2 offset:62464
    v_mfma_f32_16x16x32_bf16 v[24:27], v[64:67], v[192:195], v[24:27]
    s_add_u32 s34, s34, 73728
    v_and_b32 v6, 15, v10
    v_lshrrev_b32 v7, 4, v10
    v_mfma_f32_16x16x32_bf16 v[28:31], v[68:71], v[192:195], v[28:31]
    ds_read_b128 v[108:111], v2 offset:63488
    v_mfma_f32_16x16x32_bf16 v[48:51], v[68:71], v[188:191], v[48:51]
    v_mul_u32_u24 v6, 176, v6
    v_add_u32 v6, s34, v6
    v_lshl_add_u32 v14, v7, 4, v6
    v_mfma_f32_16x16x32_bf16 v[52:55], v[72:75], v[188:191], v[52:55]
    ds_read_b128 v[112:115], v2 offset:64512
    v_mfma_f32_16x16x32_bf16 v[32:35], v[72:75], v[192:195], v[32:35]
    v_lshl_add_u32 v15, v7, 3, v6
    v_add_u32 v6, 0, v10
    v_mul_u32_u24 v7, 6554, v6
    s_waitcnt vmcnt(11) lgkmcnt(5)
    s_cmp_lg_u32 s31, 0
    s_cbranch_scc1 L_ms72
    buffer_store_dword v4, off, s[16:19], s44
L_mb72:
    v_mfma_f32_16x16x32_bf16 v[36:39], v[76:79], v[116:119], v[36:39]
    ds_read_b128 v[56:59], v3 offset:0
    v_mfma_f32_16x16x32_bf16 v[16:19], v[76:79], v[120:123], v[16:19]
    s_add_u32 s81, s81, 4096
    buffer_load_dwordx4 v[168:171], v1, s[16:19], s81 offen offset:0 sc1
    v_mfma_f32_16x16x32_bf16 v[20:23], v[80:83], v[120:123], v[20:23]
    ds_read_b128 v[60:63], v3 offset:1024
    v_mfma_f32_16x16x32_bf16 v[40:43], v[80:83], v[116:119], v[40:43]
    buffer_load_dwordx4 v[172:175], v1, s[16:19], s38 offen offset:2048 sc1
    v_mfma_f32_16x16x32_bf16 v[44:47], v[84:87], v[116:119], v[44:47]
    ds_read_b128 v[64:67], v3 offset:2048
    v_mfma_f32_16x16x32_bf16 v[24:27], v[84:87], v[120:123], v[24:27]
    v_lshrrev_b32 v7, 16, v7
    v_add_lshl_u32 v8, v6, v7, 4
    v_add_u32 v200, s34, v8
    v_mfma_f32_16x16x32_bf16 v[28:31], v[88:91], v[120:123], v[28:31]
    ds_read_b128 v[68:71], v3 offset:3072
    v_mfma_f32_16x16x32_bf16 v[48:51], v[88:91], v[116:119], v[48:51]
    v_mul_u32_u24 v7, 1120, v7
    v_lshl_add_u32 v204, v6, 4, v7
    v_add_u32 v6, 64, v10
    v_mfma_f32_16x16x32_bf16 v[52:55], v[92:95], v[116:119], v[52:55]
    ds_read_b128 v[72:75], v3 offset:4096
    v_mfma_f32_16x16x32_bf16 v[32:35], v[92:95], v[120:123], v[32:35]
    v_mul_u32_u24 v7, 6554, v6
    v_lshrrev_b32 v7, 16, v7
    v_add_lshl_u32 v8, v6, v7, 4
    s_waitcnt vmcnt(12) lgkmcnt(5)
    v_mfma_f32_16x16x32_bf16 v[36:39], v[96:99], v[124:127], v[36:39]
    ds_read_b128 v[76:79], v3 offset:5120
    v_mfma_f32_16x16x32_bf16 v[16:19], v[96:99], v[128:131], v[16:19]
    buffer_load_dwordx4 v[176:179], v1, s[16:19], s81 offen offset:2048 sc1
    v_mfma_f32_16x16x32_bf16 v[20:23], v[100:103], v[128:131], v[20:23]
    ds_read_b128 v[80:83], v3 offset:6144
    v_mfma_f32_16x16x32_bf16 v[40:43], v[100:103], v[124:127], v[40:43]
    s_add_u32 s38, s38, 4096
    buffer_load_dwordx4 v[180:183], v1, s[16:19], s38 offen offset:0 sc1
    v_mfma_f32_16x16x32_bf16 v[44:47], v[104:107], v[124:127], v[44:47]
    ds_read_b128 v[84:87], v3 offset:7168
    v_mfma_f32_16x16x32_bf16 v[24:27], v[104:107], v[128:131], v[24:27]
    v_add_u32 v201, s34, v8
    v_mul_u32_u24 v7, 1120, v7
    v_lshl_add_u32 v205, v6, 4, v7
    v_mfma_f32_16x16x32_bf16 v[28:31], v[108:111], v[128:131], v[28:31]
    ds_read_b128 v[88:91], v3 offset:8192
    v_mfma_f32_16x16x32_bf16 v[48:51], v[108:111], v[124:127], v[48:51]
    v_add_u32 v6, 128, v10
    v_mul_u32_u24 v7, 6554, v6
    v_lshrrev_b32 v7, 16, v7
    v_mfma_f32_16x16x32_bf16 v[52:55], v[112:115], v[124:127], v[52:55]
    ds_read_b128 v[92:95], v3 offset:9216
    v_mfma_f32_16x16x32_bf16 v[32:35], v[112:115], v[128:131], v[32:35]
    v_add_lshl_u32 v8, v6, v7, 4
    v_add_u32 v202, s34, v8
    v_mul_u32_u24 v7, 1120, v7
    s_waitcnt vmcnt(12) lgkmcnt(5)
    v_mfma_f32_16x16x32_bf16 v[36:39], v[56:59], v[132:135], v[36:39]
    ds_read_b128 v[96:99], v3 offset:10240
    v_mfma_f32_16x16x32_bf16 v[16:19], v[56:59], v[136:139], v[16:19]
    s_add_u32 s81, s81, 4096
    buffer_load_dwordx4 v[184:187], v1, s[16:19], s81 offen offset:0 sc1
    v_mfma_f32_16x16x32_bf16 v[20:23], v[60:63], v[136:139], v[20:23]
    ds_read_b128 v[100:103], v3 offset:11264
    v_mfma_f32_16x16x32_bf16 v[40:43], v[60:63], v[132:135], v[40:43]
    buffer_load_dwordx4 v[188:191], v1, s[16:19], s38 offen offset:2048 sc1
    v_mfma_f32_16x16x32_bf16 v[44:47], v[64:67], v[132:135], v[44:47]
    ds_read_b128 v[104:107], v3 offset:12288
    v_mfma_f32_16x16x32_bf16 v[24:27], v[64:67], v[136:139], v[24:27]
    v_lshl_add_u32 v206, v6, 4, v7
    v_mov_b32 v6, 2146435072
    v_cndmask_b32 v206, v206, v6, s[72:73]
    v_mfma_f32_16x16x32_bf16 v[28:31], v[68:71], v[136:139], v[28:31]
    ds_read_b128 v[108:111], v3 offset:13312
    v_mfma_f32_16x16x32_bf16 v[48:51], v[68:71], v[132:135], v[48:51]
    s_mul_i32 s79, s65, 20480
    s_mul_i32 s35, s67, 160
    s_add_u32 s79, s79, s35
    v_mfma_f32_16x16x32_bf16 v[52:55], v[72:75], v[132:135], v[52:55]
    ds_read_b128 v[112:115], v3 offset:14336
    v_mfma_f32_16x16x32_bf16 v[32:35], v[72:75], v[136:139], v[32:35]
    s_lshl_b32 s34, s65, 3
    s_add_u32 s34, s34, s67
    s_mul_i32 s3, s67, 2560
    s_waitcnt vmcnt(12) lgkmcnt(5)
    v_mfma_f32_16x16x32_bf16 v[36:39], v[76:79], v[140:143], v[36:39]
    ds_read_b128 v[56:59], v3 offset:15360
    v_mfma_f32_16x16x32_bf16 v[16:19], v[76:79], v[144:147], v[16:19]
    buffer_load_dwordx4 v[192:195], v1, s[16:19], s81 offen offset:2048 sc1
    v_mfma_f32_16x16x32_bf16 v[20:23], v[80:83], v[144:147], v[20:23]
    ds_read_b128 v[60:63], v3 offset:16384
    v_mfma_f32_16x16x32_bf16 v[40:43], v[80:83], v[140:143], v[40:43]
    s_add_u32 s38, s38, 4096
    buffer_load_dwordx4 v[116:119], v1, s[16:19], s38 offen offset:0 sc1
    v_mfma_f32_16x16x32_bf16 v[44:47], v[84:87], v[140:143], v[44:47]
    ds_read_b128 v[64:67], v3 offset:17408
    v_mfma_f32_16x16x32_bf16 v[24:27], v[84:87], v[144:147], v[24:27]
    s_add_u32 s3, s3, 13238272
    s_mul_i32 s40, s65, 55296
    s_add_u32 s40, s40, s3
    v_mfma_f32_16x16x32_bf16 v[28:31], v[88:91], v[144:147], v[28:31]
    ds_read_b128 v[68:71], v3 offset:18432
    v_mfma_f32_16x16x32_bf16 v[48:51], v[88:91], v[140:143], v[48:51]
    s_xor_b32 s35, s65, 4
    s_mul_i32 s39, s35, 55296
    s_add_u32 s39, s39, s3
    v_mfma_f32_16x16x32_bf16 v[52:55], v[92:95], v[140:143], v[52:55]
    ds_read_b128 v[72:75], v3 offset:19456
    v_mfma_f32_16x16x32_bf16 v[32:35], v[92:95], v[144:147], v[32:35]
    s_and_b32 s35, s34, 0xfff0
    s_add_u32 s34, s34, s35
    s_lshl_b32 s34, s34, 2
    s_waitcnt vmcnt(12) lgkmcnt(5)
    v_mfma_f32_16x16x32_bf16 v[36:39], v[96:99], v[148:151], v[36:39]
    ds_read_b128 v[76:79], v3 offset:20480
    v_mfma_f32_16x16x32_bf16 v[16:19], v[96:99], v[152:155], v[16:19]
    s_add_u32 s81, s81, 4096
    buffer_load_dwordx4 v[120:123], v1, s[16:19], s81 offen offset:0 sc1
    v_mfma_f32_16x16x32_bf16 v[20:23], v[100:103], v[152:155], v[20:23]
    ds_read_b128 v[80:83], v3 offset:21504
    v_mfma_f32_16x16x32_bf16 v[40:43], v[100:103], v[148:151], v[40:43]
    buffer_load_dwordx4 v[124:127], v1, s[16:19], s38 offen offset:2048 sc1
    v_mfma_f32_16x16x32_bf16 v[44:47], v[104:107], v[148:151], v[44:47]
    ds_read_b128 v[84:87], v3 offset:22528
    v_mfma_f32_16x16x32_bf16 v[24:27], v[104:107], v[152:155], v[24:27]
    s_add_u32 s42, s34, 28086336
    s_xor_b32 s34, s34, 256
    s_add_u32 s41, s34, 28086336
    v_mfma_f32_16x16x32_bf16 v[28:31], v[108:111], v[152:155], v[28:31]
    ds_read_b128 v[88:91], v3 offset:23552
    v_mfma_f32_16x16x32_bf16 v[48:51], v[108:111], v[148:151], v[48:51]
    v_lshlrev_b32 v5, 3, v10
    v_mfma_f32_16x16x32_bf16 v[52:55], v[112:115], v[148:151], v[52:55]
    ds_read_b128 v[92:95], v3 offset:24576
    v_mfma_f32_16x16x32_bf16 v[32:35], v[112:115], v[152:155], v[32:35]
    s_waitcnt vmcnt(12) lgkmcnt(5)
    v_mfma_f32_16x16x32_bf16 v[36:39], v[56:59], v[156:159], v[36:39]
    ds_read_b128 v[96:99], v3 offset:25600
    v_mfma_f32_16x16x32_bf16 v[16:19], v[56:59], v[160:163], v[16:19]
    buffer_load_dwordx4 v[128:131], v1, s[16:19], s81 offen offset:2048 sc1
    v_mfma_f32_16x16x32_bf16 v[20:23], v[60:63], v[160:163], v[20:23]
    ds_read_b128 v[100:103], v3 offset:26624
    v_mfma_f32_16x16x32_bf16 v[40:43], v[60:63], v[156:159], v[40:43]
    s_add_u32 s38, s38, 4096
    buffer_load_dwordx4 v[132:135], v1, s[16:19], s38 offen offset:0 sc1
    v_mfma_f32_16x16x32_bf16 v[44:47], v[64:67], v[156:159], v[44:47]
    ds_read_b128 v[104:107], v3 offset:27648
    v_mfma_f32_16x16x32_bf16 v[24:27], v[64:67], v[160:163], v[24:27]
    v_mfma_f32_16x16x32_bf16 v[28:31], v[68:71], v[160:163], v[28:31]
    ds_read_b128 v[108:111], v3 offset:28672
    v_mfma_f32_16x16x32_bf16 v[48:51], v[68:71], v[156:159], v[48:51]
    v_mfma_f32_16x16x32_bf16 v[52:55], v[72:75], v[156:159], v[52:55]
    ds_read_b128 v[112:115], v3 offset:29696
    v_mfma_f32_16x16x32_bf16 v[32:35], v[72:75], v[160:163], v[32:35]
    s_waitcnt vmcnt(11) lgkmcnt(5)
    v_mfma_f32_16x16x32_bf16 v[36:39], v[76:79], v[164:167], v[36:39]
    ds_read_b128 v[56:59], v3 offset:30720
    v_mfma_f32_16x16x32_bf16 v[16:19], v[76:79], v[168:171], v[16:19]
    s_add_u32 s81, s81, 4096
    buffer_load_dwordx4 v[136:139], v1, s[16:19], s81 offen offset:0 sc1
    v_mfma_f32_16x16x32_bf16 v[20:23], v[80:83], v[168:171], v[20:23]
    ds_read_b128 v[60:63], v3 offset:31744
    v_mfma_f32_16x16x32_bf16 v[40:43], v[80:83], v[164:167], v[40:43]
    buffer_load_dwordx4 v[140:143], v1, s[16:19], s38 offen offset:2048 sc1
    v_mfma_f32_16x16x32_bf16 v[44:47], v[84:87], v[164:167], v[44:47]
    ds_read_b128 v[64:67], v1 offset:0
    v_mfma_f32_16x16x32_bf16 v[24:27], v[84:87], v[168:171], v[24:27]
    v_mfma_f32_16x16x32_bf16 v[28:31], v[88:91], v[168:171], v[28:31]
    ds_read_b128 v[68:71], v1 offset:1024
    v_mfma_f32_16x16x32_bf16 v[48:51], v[88:91], v[164:167], v[48:51]
    v_mfma_f32_16x16x32_bf16 v[52:55], v[92:95], v[164:167], v[52:55]
    ds_read_b128 v[72:75], v1 offset:2048
    v_mfma_f32_16x16x32_bf16 v[32:35], v[92:95], v[168:171], v[32:35]
    s_waitcnt vmcnt(11) lgkmcnt(5)
    v_mfma_f32_16x16x32_bf16 v[36:39], v[96:99], v[172:175], v[36:39]
    ds_read_b128 v[76:79], v1 offset:3072
    v_mfma_f32_16x16x32_bf16 v[16:19], v[96:99], v[176:179], v[16:19]
    buffer_load_dwordx4 v[144:147], v1, s[16:19], s81 offen offset:2048 sc1
    v_mfma_f32_16x16x32_bf16 v[20:23], v[100:103], v[176:179], v[20:23]
    ds_read_b128 v[80:83], v1 offset:4096
    v_mfma_f32_16x16x32_bf16 v[40:43], v[100:103], v[172:175], v[40:43]
    s_add_u32 s38, s38, 4096
    buffer_load_dwordx4 v[148:151], v1, s[16:19], s38 offen offset:0 sc1
    v_mfma_f32_16x16x32_bf16 v[44:47], v[104:107], v[172:175], v[44:47]
    ds_read_b128 v[84:87], v1 offset:5120
    v_mfma_f32_16x16x32_bf16 v[24:27], v[104:107], v[176:179], v[24:27]
    v_mfma_f32_16x16x32_bf16 v[28:31], v[108:111], v[176:179], v[28:31]
    ds_read_b128 v[88:91], v1 offset:6144
    v_mfma_f32_16x16x32_bf16 v[48:51], v[108:111], v[172:175], v[48:51]
    v_mfma_f32_16x16x32_bf16 v[52:55], v[112:115], v[172:175], v[52:55]
    ds_read_b128 v[92:95], v1 offset:7168
    v_mfma_f32_16x16x32_bf16 v[32:35], v[112:115], v[176:179], v[32:35]
    s_waitcnt vmcnt(11) lgkmcnt(5)
    v_mfma_f32_16x16x32_bf16 v[36:39], v[56:59], v[180:183], v[36:39]
    ds_read_b128 v[96:99], v1 offset:8192
    v_mfma_f32_16x16x32_bf16 v[16:19], v[56:59], v[184:187], v[16:19]
    s_add_u32 s81, s81, 4096
    buffer_load_dwordx4 v[152:155], v1, s[16:19], s81 offen offset:0 sc1
    v_mfma_f32_16x16x32_bf16 v[20:23], v[60:63], v[184:187], v[20:23]
    ds_read_b128 v[100:103], v1 offset:9216
    v_mfma_f32_16x16x32_bf16 v[40:43], v[60:63], v[180:183], v[40:43]
    buffer_load_dwordx4 v[156:159], v1, s[16:19], s38 offen offset:2048 sc1
    v_mfma_f32_16x16x32_bf16 v[44:47], v[64:67], v[180:183], v[44:47]
    ds_read_b128 v[104:107], v1 offset:10240
    v_mfma_f32_16x16x32_bf16 v[24:27], v[64:67], v[184:187], v[24:27]
    v_mfma_f32_16x16x32_bf16 v[28:31], v[68:71], v[184:187], v[28:31]
    ds_read_b128 v[108:111], v1 offset:11264
    v_mfma_f32_16x16x32_bf16 v[48:51], v[68:71], v[180:183], v[48:51]
    v_mfma_f32_16x16x32_bf16 v[52:55], v[72:75], v[180:183], v[52:55]
    ds_read_b128 v[112:115], v1 offset:12288
    v_mfma_f32_16x16x32_bf16 v[32:35], v[72:75], v[184:187], v[32:35]
    s_waitcnt vmcnt(12) lgkmcnt(5)
    v_mfma_f32_16x16x32_bf16 v[36:39], v[76:79], v[188:191], v[36:39]
    ds_read_b128 v[56:59], v1 offset:13312
    v_mfma_f32_16x16x32_bf16 v[40:43], v[80:83], v[188:191], v[40:43]
    ds_read_b128 v[60:63], v1 offset:14336
    v_mfma_f32_16x16x32_bf16 v[44:47], v[84:87], v[188:191], v[44:47]
    ds_read_b128 v[64:67], v1 offset:15360
    v_mfma_f32_16x16x32_bf16 v[48:51], v[88:91], v[188:191], v[48:51]
    ds_read_b128 v[68:71], v1 offset:16384
    v_mfma_f32_16x16x32_bf16 v[52:55], v[92:95], v[188:191], v[52:55]
    ds_read_b128 v[72:75], v1 offset:17408
    buffer_load_dwordx4 v[160:163], v1, s[16:19], s81 offen offset:2048 sc1
    s_add_u32 s38, s38, 4096
    buffer_load_dwordx4 v[164:167], v1, s[16:19], s38 offen offset:0 sc1
    s_waitcnt vmcnt(12) lgkmcnt(5)
    buffer_load_dword v9, v13, s[16:19], s43 offen sc1
    v_mfma_f32_16x16x32_bf16 v[36:39], v[96:99], v[116:119], v[36:39]
    ds_read_b128 v[76:79], v1 offset:18432
    v_mfma_f32_16x16x32_bf16 v[40:43], v[100:103], v[116:119], v[40:43]
    ds_read_b128 v[80:83], v1 offset:19456
    v_mfma_f32_16x16x32_bf16 v[44:47], v[104:107], v[116:119], v[44:47]
    ds_read_b128 v[84:87], v1 offset:20480
    v_mfma_f32_16x16x32_bf16 v[48:51], v[108:111], v[116:119], v[48:51]
    ds_read_b128 v[88:91], v1 offset:21504
    v_mfma_f32_16x16x32_bf16 v[52:55], v[112:115], v[116:119], v[52:55]
    ds_read_b128 v[92:95], v1 offset:22528
    s_add_u32 s81, s81, 4096
    buffer_load_dwordx4 v[168:171], v1, s[16:19], s81 offen offset:0 sc1
    s_waitcnt vmcnt(12) lgkmcnt(5)
    v_mfma_f32_16x16x32_bf16 v[36:39], v[56:59], v[124:127], v[36:39]
    ds_read_b128 v[96:99], v1 offset:23552
    v_mfma_f32_16x16x32_bf16 v[40:43], v[60:63], v[124:127], v[40:43]
    ds_read_b128 v[100:103], v1 offset:24576
    v_mfma_f32_16x16x32_bf16 v[44:47], v[64:67], v[124:127], v[44:47]
    ds_read_b128 v[104:107], v1 offset:25600
    v_mfma_f32_16x16x32_bf16 v[48:51], v[68:71], v[124:127], v[48:51]
    ds_read_b128 v[108:111], v1 offset:26624
    v_mfma_f32_16x16x32_bf16 v[52:55], v[72:75], v[124:127], v[52:55]
    ds_read_b128 v[112:115], v1 offset:27648
    s_waitcnt vmcnt(10) lgkmcnt(5)
    v_mfma_f32_16x16x32_bf16 v[36:39], v[76:79], v[132:135], v[36:39]
    ds_read_b128 v[56:59], v1 offset:28672
    v_mfma_f32_16x16x32_bf16 v[40:43], v[80:83], v[132:135], v[40:43]
    ds_read_b128 v[60:63], v1 offset:29696
    v_mfma_f32_16x16x32_bf16 v[44:47], v[84:87], v[132:135], v[44:47]
    ds_read_b128 v[64:67], v1 offset:30720
    v_mfma_f32_16x16x32_bf16 v[48:51], v[88:91], v[132:135], v[48:51]
    ds_read_b128 v[68:71], v1 offset:31744
    v_mfma_f32_16x16x32_bf16 v[52:55], v[92:95], v[132:135], v[52:55]
    ds_read_b128 v[72:75], v1 offset:32768
    s_waitcnt vmcnt(8) lgkmcnt(5)
    v_mfma_f32_16x16x32_bf16 v[36:39], v[96:99], v[140:143], v[36:39]
    ds_read_b128 v[76:79], v1 offset:33792
    v_mfma_f32_16x16x32_bf16 v[40:43], v[100:103], v[140:143], v[40:43]
    ds_read_b128 v[80:83], v1 offset:34816
    v_mfma_f32_16x16x32_bf16 v[44:47], v[104:107], v[140:143], v[44:47]
    ds_read_b128 v[84:87], v1 offset:35840
    v_mfma_f32_16x16x32_bf16 v[48:51], v[108:111], v[140:143], v[48:51]
    ds_read_b128 v[88:91], v1 offset:36864
    v_mfma_f32_16x16x32_bf16 v[52:55], v[112:115], v[140:143], v[52:55]
    ds_read_b128 v[92:95], v1 offset:37888
    s_waitcnt vmcnt(6) lgkmcnt(5)
    v_mfma_f32_16x16x32_bf16 v[36:39], v[56:59], v[148:151], v[36:39]
    ds_read_b128 v[96:99], v1 offset:38912
    v_mfma_f32_16x16x32_bf16 v[40:43], v[60:63], v[148:151], v[40:43]
    ds_read_b128 v[100:103], v1 offset:39936
    v_mfma_f32_16x16x32_bf16 v[44:47], v[64:67], v[148:151], v[44:47]
    ds_read_b128 v[104:107], v1 offset:40960
    v_mfma_f32_16x16x32_bf16 v[48:51], v[68:71], v[148:151], v[48:51]
    ds_read_b128 v[108:111], v1 offset:41984
    v_mfma_f32_16x16x32_bf16 v[52:55], v[72:75], v[148:151], v[52:55]
    ds_read_b128 v[112:115], v1 offset:43008
    s_waitcnt vmcnt(4) lgkmcnt(5)
    v_mfma_f32_16x16x32_bf16 v[36:39], v[76:79], v[156:159], v[36:39]
    ds_read_b128 v[56:59], v1 offset:3072
    v_mfma_f32_16x16x32_bf16 v[40:43], v[80:83], v[156:159], v[40:43]
    ds_read_b128 v[60:63], v1 offset:4096
    v_mfma_f32_16x16x32_bf16 v[44:47], v[84:87], v[156:159], v[44:47]
    ds_read_b128 v[64:67], v1 offset:5120
    v_mfma_f32_16x16x32_bf16 v[48:51], v[88:91], v[156:159], v[48:51]
    ds_read_b128 v[68:71], v1 offset:6144
    v_mfma_f32_16x16x32_bf16 v[52:55], v[92:95], v[156:159], v[52:55]
    ds_read_b128 v[72:75], v1 offset:7168
    s_waitcnt vmcnt(2) lgkmcnt(5)
    s_waitcnt vmcnt(1)
L_rc73:
    v_cmp_eq_u32 vcc, 0, v9
    s_nop 0
    s_cbranch_vccnz L_rr73
L_ro73:
    v_mfma_f32_16x16x32_bf16 v[36:39], v[96:99], v[164:167], v[36:39]
    ds_read_b128 v[76:79], v1 offset:8192
    v_mfma_f32_16x16x32_bf16 v[40:43], v[100:103], v[164:167], v[40:43]
    ds_read_b128 v[80:83], v1 offset:9216
    v_mfma_f32_16x16x32_bf16 v[44:47], v[104:107], v[164:167], v[44:47]
    ds_read_b128 v[84:87], v1 offset:10240
    v_mfma_f32_16x16x32_bf16 v[48:51], v[108:111], v[164:167], v[48:51]
    ds_read_b128 v[88:91], v1 offset:11264
    v_mfma_f32_16x16x32_bf16 v[52:55], v[112:115], v[164:167], v[52:55]
    ds_read_b128 v[92:95], v1 offset:12288
    s_waitcnt lgkmcnt(5)
    v_mfma_f32_16x16x32_bf16 v[16:19], v[56:59], v[192:195], v[16:19]
    ds_read_b128 v[96:99], v1 offset:13312
    v_mfma_f32_16x16x32_bf16 v[20:23], v[60:63], v[192:195], v[20:23]
    ds_read_b128 v[100:103], v1 offset:14336
    v_mfma_f32_16x16x32_bf16 v[24:27], v[64:67], v[192:195], v[24:27]
    ds_read_b128 v[104:107], v1 offset:15360
    v_mfma_f32_16x16x32_bf16 v[28:31], v[68:71], v[192:195], v[28:31]
    ds_read_b128 v[108:111], v1 offset:16384
    v_mfma_f32_16x16x32_bf16 v[32:35], v[72:75], v[192:195], v[32:35]
    ds_read_b128 v[112:115], v1 offset:17408
    s_waitcnt lgkmcnt(5)
    s_cmp_lg_u32 s31, 0
    v_cvt_pk_bf16_f32 v246, v36, v37
    v_cvt_pk_bf16_f32 v247, v38, v39
    v_cvt_pk_bf16_f32 v248, v40, v41
    v_cvt_pk_bf16_f32 v249, v42, v43
    s_cbranch_scc1 L_ms74
    buffer_store_dwordx4 v[246:249], v1, s[16:19], s39 offen offset:0
L_mb74:
    v_cvt_pk_bf16_f32 v250, v44, v45
    v_cvt_pk_bf16_f32 v251, v46, v47
    v_cvt_pk_bf16_f32 v252, v48, v49
    v_cvt_pk_bf16_f32 v253, v50, v51
    s_cbranch_scc1 L_ms75
    buffer_store_dwordx4 v[250:253], v1, s[16:19], s39 offen offset:1024
L_mb75:
    v_cvt_pk_bf16_f32 v254, v52, v53
    v_cvt_pk_bf16_f32 v255, v54, v55
    s_cbranch_scc1 L_ms76
    buffer_store_dwordx2 v[254:255], v5, s[16:19], s39 offen offset:2048
L_mb76:
    v_mfma_f32_16x16x32_bf16 v[16:19], v[76:79], v[120:123], v[16:19]
    ds_read_b128 v[56:59], v1 offset:18432
    v_mfma_f32_16x16x32_bf16 v[20:23], v[80:83], v[120:123], v[20:23]
    ds_read_b128 v[60:63], v1 offset:19456
    v_mfma_f32_16x16x32_bf16 v[24:27], v[84:87], v[120:123], v[24:27]
    ds_read_b128 v[64:67], v1 offset:20480
    v_mfma_f32_16x16x32_bf16 v[28:31], v[88:91], v[120:123], v[28:31]
    ds_read_b128 v[68:71], v1 offset:21504
    v_mfma_f32_16x16x32_bf16 v[32:35], v[92:95], v[120:123], v[32:35]
    ds_read_b128 v[72:75], v1 offset:22528
    s_waitcnt lgkmcnt(5)
    v_mfma_f32_16x16x32_bf16 v[16:19], v[96:99], v[128:131], v[16:19]
    ds_read_b128 v[76:79], v1 offset:23552
    v_mfma_f32_16x16x32_bf16 v[20:23], v[100:103], v[128:131], v[20:23]
    ds_read_b128 v[80:83], v1 offset:24576
    v_mfma_f32_16x16x32_bf16 v[24:27], v[104:107], v[128:131], v[24:27]
    ds_read_b128 v[84:87], v1 offset:25600
    v_mfma_f32_16x16x32_bf16 v[28:31], v[108:111], v[128:131], v[28:31]
    ds_read_b128 v[88:91], v1 offset:26624
    v_mfma_f32_16x16x32_bf16 v[32:35], v[112:115], v[128:131], v[32:35]
    ds_read_b128 v[92:95], v1 offset:27648
    s_waitcnt lgkmcnt(5)
    v_mfma_f32_16x16x32_bf16 v[16:19], v[56:59], v[136:139], v[16:19]
    ds_read_b128 v[96:99], v1 offset:28672
    v_mfma_f32_16x16x32_bf16 v[20:23], v[60:63], v[136:139], v[20:23]
    ds_read_b128 v[100:103], v1 offset:29696
    v_mfma_f32_16x16x32_bf16 v[24:27], v[64:67], v[136:139], v[24:27]
    ds_read_b128 v[104:107], v1 offset:30720
    v_mfma_f32_16x16x32_bf16 v[28:31], v[68:71], v[136:139], v[28:31]
    ds_read_b128 v[108:111], v1 offset:31744
    v_mfma_f32_16x16x32_bf16 v[32:35], v[72:75], v[136:139], v[32:35]
    ds_read_b128 v[112:115], v1 offset:32768
    s_waitcnt lgkmcnt(5)
    v_mfma_f32_16x16x32_bf16 v[16:19], v[76:79], v[144:147], v[16:19]
    ds_read_b128 v[56:59], v1 offset:33792
    v_mfma_f32_16x16x32_bf16 v[20:23], v[80:83], v[144:147], v[20:23]
    ds_read_b128 v[60:63], v1 offset:34816
    v_mfma_f32_16x16x32_bf16 v[24:27], v[84:87], v[144:147], v[24:27]
    ds_read_b128 v[64:67], v1 offset:35840
    v_mfma_f32_16x16x32_bf16 v[28:31], v[88:91], v[144:147], v[28:31]
    ds_read_b128 v[68:71], v1 offset:36864
    v_mfma_f32_16x16x32_bf16 v[32:35], v[92:95], v[144:147], v[32:35]
    ds_read_b128 v[72:75], v1 offset:37888
    s_waitcnt lgkmcnt(5)
    s_cmp_lg_u32 s31, 0
    s_waitcnt vmcnt(0)
    s_cbranch_scc1 L_ms77
    buffer_store_dword v4, off, s[16:19], s41
L_mb77:
    v_mfma_f32_16x16x32_bf16 v[16:19], v[96:99], v[152:155], v[16:19]
    ds_read_b128 v[76:79], v1 offset:38912
    v_mfma_f32_16x16x32_bf16 v[20:23], v[100:103], v[152:155], v[20:23]
    ds_read_b128 v[80:83], v1 offset:39936
    v_mfma_f32_16x16x32_bf16 v[24:27], v[104:107], v[152:155], v[24:27]
    ds_read_b128 v[84:87], v1 offset:40960
    v_mfma_f32_16x16x32_bf16 v[28:31], v[108:111], v[152:155], v[28:31]
    ds_read_b128 v[88:91], v1 offset:41984
    v_mfma_f32_16x16x32_bf16 v[32:35], v[112:115], v[152:155], v[32:35]
    ds_read_b128 v[92:95], v1 offset:43008
    s_waitcnt lgkmcnt(5)
    v_mfma_f32_16x16x32_bf16 v[16:19], v[56:59], v[160:163], v[16:19]
    v_mfma_f32_16x16x32_bf16 v[20:23], v[60:63], v[160:163], v[20:23]
    v_mfma_f32_16x16x32_bf16 v[24:27], v[64:67], v[160:163], v[24:27]
    v_mfma_f32_16x16x32_bf16 v[28:31], v[68:71], v[160:163], v[28:31]
    v_mfma_f32_16x16x32_bf16 v[32:35], v[72:75], v[160:163], v[32:35]
    s_waitcnt vmcnt(4) lgkmcnt(0)
    buffer_load_dword v9, off, s[16:19], s42 sc1
    v_mfma_f32_16x16x32_bf16 v[16:19], v[76:79], v[168:171], v[16:19]
    v_mfma_f32_16x16x32_bf16 v[20:23], v[80:83], v[168:171], v[20:23]
    v_mfma_f32_16x16x32_bf16 v[24:27], v[84:87], v[168:171], v[24:27]
    v_mfma_f32_16x16x32_bf16 v[28:31], v[88:91], v[168:171], v[28:31]
    v_mfma_f32_16x16x32_bf16 v[32:35], v[92:95], v[168:171], v[32:35]
    s_waitcnt vmcnt(0)
L_rc78:
    v_cmp_eq_u32 vcc, 0, v9
    s_nop 0
    s_cbranch_vccnz L_rr78
L_ro78:
    buffer_load_dwordx4 v[36:39], v1, s[16:19], s40 offen offset:0 sc1
    buffer_load_dwordx4 v[40:43], v1, s[16:19], s40 offen offset:1024 sc1
    buffer_load_dwordx2 v[44:45], v5, s[16:19], s40 offen offset:2048 sc1
    s_waitcnt vmcnt(2)
    v_lshlrev_b32 v6, 16, v36
    v_and_b32 v7, 0xffff0000, v36
    v_pk_add_f32 v[16:17], v[16:17], v[6:7]
    v_lshlrev_b32 v6, 16, v37
    v_and_b32 v7, 0xffff0000, v37
    v_pk_add_f32 v[18:19], v[18:19], v[6:7]
    v_lshlrev_b32 v6, 16, v38
    v_and_b32 v7, 0xffff0000, v38
    v_pk_add_f32 v[20:21], v[20:21], v[6:7]
    v_lshlrev_b32 v6, 16, v39
    v_and_b32 v7, 0xffff0000, v39
    v_pk_add_f32 v[22:23], v[22:23], v[6:7]
    s_waitcnt vmcnt(1)
    v_lshlrev_b32 v6, 16, v40
    v_and_b32 v7, 0xffff0000, v40
    v_pk_add_f32 v[24:25], v[24:25], v[6:7]
    v_lshlrev_b32 v6, 16, v41
    v_and_b32 v7, 0xffff0000, v41
    v_pk_add_f32 v[26:27], v[26:27], v[6:7]
    v_lshlrev_b32 v6, 16, v42
    v_and_b32 v7, 0xffff0000, v42
    v_pk_add_f32 v[28:29], v[28:29], v[6:7]
    v_lshlrev_b32 v6, 16, v43
    v_and_b32 v7, 0xffff0000, v43
    v_pk_add_f32 v[30:31], v[30:31], v[6:7]
    s_waitcnt vmcnt(0)
    v_lshlrev_b32 v6, 16, v44
    v_and_b32 v7, 0xffff0000, v44
    v_pk_add_f32 v[32:33], v[32:33], v[6:7]
    v_lshlrev_b32 v6, 16, v45
    v_and_b32 v7, 0xffff0000, v45
    v_pk_add_f32 v[34:35], v[34:35], v[6:7]
    v_cvt_pk_bf16_f32 v246, v16, v17
    v_cvt_pk_bf16_f32 v247, v18, v19
    v_cvt_pk_bf16_f32 v248, v20, v21
    v_cvt_pk_bf16_f32 v249, v22, v23
    ds_write_b128 v14, v[246:249]
    v_cvt_pk_bf16_f32 v250, v24, v25
    v_cvt_pk_bf16_f32 v251, v26, v27
    v_cvt_pk_bf16_f32 v252, v28, v29
    v_cvt_pk_bf16_f32 v253, v30, v31
    ds_write_b128 v14, v[250:253] offset:64
    v_cvt_pk_bf16_f32 v254, v32, v33
    v_cvt_pk_bf16_f32 v255, v34, v35
    ds_write_b64 v15, v[254:255] offset:128
    s_waitcnt lgkmcnt(0)
    ds_read_b128 v[48:51], v200
    ds_read_b128 v[52:55], v201
    ds_read_b128 v[56:59], v202
    s_waitcnt lgkmcnt(2)
    buffer_store_dwordx4 v[48:51], v204, s[8:11], s79 offen nt
    s_waitcnt lgkmcnt(1)
    buffer_store_dwordx4 v[52:55], v205, s[8:11], s79 offen nt
    s_waitcnt lgkmcnt(0)
    buffer_store_dwordx4 v[56:59], v206, s[8:11], s79 offen nt
    s_endpgm
L_help:
    s_setprio 0
    s_lshl_b32 s33, s87, 10
    s_mul_i32 s78, s68, 294912
    s_add_u32 s78, s78, s33
    s_add_u32 s78, s78, 21135360
    s_mul_i32 s79, s67, 276480
    s_and_b32 s34, s30, 1
    s_mul_i32 s34, s34, 138240
    s_add_u32 s79, s79, s34
    s_add_u32 s79, s79, s33
    s_add_u32 s79, s79, 25853952
    v_add_u32 v8, s33, v2
    v_add_u32 v9, s33, v3
    v_add_u32 v7, s33, v1
    s_barrier
    s_add_u32 m0, s33, 143360
    s_add_u32 s34, s78, 40960
    buffer_load_dwordx4 v1, s[16:19], s34 offen sc1 lds
    s_add_u32 m0, s33, 147456
    s_add_u32 s34, s78, 45056
    buffer_load_dwordx4 v1, s[16:19], s34 offen sc1 lds
    s_barrier
    s_barrier
    s_barrier
    s_add_u32 m0, s33, 151552
    s_add_u32 s34, s78, 49152
    buffer_load_dwordx4 v1, s[16:19], s34 offen sc1 lds
    s_add_u32 m0, s33, 155648
    s_add_u32 s34, s78, 53248
    buffer_load_dwordx4 v1, s[16:19], s34 offen sc1 lds
    s_barrier
    s_add_u32 m0, s33, 159744
    s_add_u32 s34, s78, 57344
    buffer_load_dwordx4 v1, s[16:19], s34 offen sc1 lds
    s_add_u32 m0, s33, 0
    s_add_u32 s34, s78, 61440
    buffer_load_dwordx4 v1, s[16:19], s34 offen sc1 lds
    s_add_u32 m0, s33, 4096
    s_add_u32 s34, s78, 65536
    buffer_load_dwordx4 v1, s[16:19], s34 offen sc1 lds
    s_add_u32 m0, s33, 8192
    s_add_u32 s34, s78, 69632
    buffer_load_dwordx4 v1, s[16:19], s34 offen sc1 lds
    s_add_u32 m0, s33, 12288
    s_add_u32 s34, s78, 73728
    buffer_load_dwordx4 v1, s[16:19], s34 offen sc1 lds
    s_add_u32 m0, s33, 16384
    s_add_u32 s34, s78, 77824
    buffer_load_dwordx4 v1, s[16:19], s34 offen sc1 lds
    s_barrier
    s_add_u32 m0, s33, 20480
    s_add_u32 s34, s78, 81920
    buffer_load_dwordx4 v1, s[16:19], s34 offen sc1 lds
    s_add_u32 m0, s33, 24576
    s_add_u32 s34, s78, 86016
    buffer_load_dwordx4 v1, s[16:19], s34 offen sc1 lds
    s_barrier
    s_barrier
    s_add_u32 m0, s33, 28672
    s_add_u32 s34, s78, 90112
    buffer_load_dwordx4 v1, s[16:19], s34 offen sc1 lds
    s_add_u32 m0, s33, 32768
    s_add_u32 s34, s78, 94208
    buffer_load_dwordx4 v1, s[16:19], s34 offen sc1 lds
    s_add_u32 m0, s33, 36864
    s_add_u32 s34, s78, 98304
    buffer_load_dwordx4 v1, s[16:19], s34 offen sc1 lds
    s_add_u32 m0, s33, 40960
    s_add_u32 s34, s78, 102400
    buffer_load_dwordx4 v1, s[16:19], s34 offen sc1 lds
    s_add_u32 m0, s33, 45056
    s_add_u32 s34, s78, 106496
    buffer_load_dwordx4 v1, s[16:19], s34 offen sc1 lds
    s_add_u32 m0, s33, 49152
    s_add_u32 s34, s78, 110592
    buffer_load_dwordx4 v1, s[16:19], s34 offen sc1 lds
    s_add_u32 m0, s33, 53248
    s_add_u32 s34, s78, 114688
    buffer_load_dwordx4 v1, s[16:19], s34 offen sc1 lds
    s_waitcnt vmcnt(15)
    s_barrier
    s_add_u32 m0, s33, 57344
    s_add_u32 s34, s78, 118784
    buffer_load_dwordx4 v1, s[16:19], s34 offen sc1 lds
    s_add_u32 m0, s33, 61440
    s_add_u32 s34, s78, 122880
    buffer_load_dwordx4 v1, s[16:19], s34 offen sc1 lds
    s_add_u32 m0, s33, 65536
    s_add_u32 s34, s78, 126976
    buffer_load_dwordx4 v1, s[16:19], s34 offen sc1 lds
    s_add_u32 m0, s33, 69632
    s_add_u32 s34, s78, 131072
    buffer_load_dwordx4 v1, s[16:19], s34 offen sc1 lds
    s_add_u32 m0, s33, 73728
    s_add_u32 s34, s78, 135168
    buffer_load_dwordx4 v1, s[16:19], s34 offen sc1 lds
    s_add_u32 m0, s33, 77824
    s_add_u32 s34, s78, 139264
    buffer_load_dwordx4 v1, s[16:19], s34 offen sc1 lds
    s_add_u32 m0, s33, 81920
    s_add_u32 s34, s78, 143360
    buffer_load_dwordx4 v1, s[16:19], s34 offen sc1 lds
    s_waitcnt vmcnt(15)
    s_barrier
    s_add_u32 m0, s33, 86016
    s_add_u32 s34, s78, 147456
    buffer_load_dwordx4 v1, s[16:19], s34 offen sc1 lds
    s_add_u32 m0, s33, 90112
    s_add_u32 s34, s78, 151552
    buffer_load_dwordx4 v1, s[16:19], s34 offen sc1 lds
    s_add_u32 m0, s33, 94208
    s_add_u32 s34, s78, 155648
    buffer_load_dwordx4 v1, s[16:19], s34 offen sc1 lds
    s_add_u32 m0, s33, 98304
    s_add_u32 s34, s78, 159744
    buffer_load_dwordx4 v1, s[16:19], s34 offen sc1 lds
    s_add_u32 m0, s33, 102400
    s_add_u32 s34, s78, 163840
    buffer_load_dwordx4 v1, s[16:19], s34 offen sc1 lds
    s_add_u32 m0, s33, 106496
    s_add_u32 s34, s78, 167936
    buffer_load_dwordx4 v1, s[16:19], s34 offen sc1 lds
    s_add_u32 m0, s33, 110592
    s_add_u32 s34, s78, 172032
    buffer_load_dwordx4 v1, s[16:19], s34 offen sc1 lds
    s_waitcnt vmcnt(15)
    s_barrier
    s_add_u32 m0, s33, 114688
    s_add_u32 s34, s78, 176128
    buffer_load_dwordx4 v1, s[16:19], s34 offen sc1 lds
    s_add_u32 m0, s33, 118784
    s_add_u32 s34, s78, 180224
    buffer_load_dwordx4 v1, s[16:19], s34 offen sc1 lds
    s_add_u32 m0, s33, 122880
    s_add_u32 s34, s78, 184320
    buffer_load_dwordx4 v1, s[16:19], s34 offen sc1 lds
    s_add_u32 m0, s33, 126976
    s_add_u32 s34, s78, 188416
    buffer_load_dwordx4 v1, s[16:19], s34 offen sc1 lds
    s_add_u32 m0, s33, 131072
    s_add_u32 s34, s78, 192512
    buffer_load_dwordx4 v1, s[16:19], s34 offen sc1 lds
    s_add_u32 m0, s33, 135168
    s_add_u32 s34, s78, 196608
    buffer_load_dwordx4 v1, s[16:19], s34 offen sc1 lds
    s_add_u32 m0, s33, 139264
    s_add_u32 s34, s78, 200704
    buffer_load_dwordx4 v1, s[16:19], s34 offen sc1 lds
    s_waitcnt vmcnt(15)
    s_barrier
    s_add_u32 m0, s33, 143360
    s_add_u32 s34, s78, 204800
    buffer_load_dwordx4 v1, s[16:19], s34 offen sc1 lds
    s_add_u32 m0, s33, 147456
    s_add_u32 s34, s78, 208896
    buffer_load_dwordx4 v1, s[16:19], s34 offen sc1 lds
    s_add_u32 m0, s33, 151552
    s_add_u32 s34, s78, 212992
    buffer_load_dwordx4 v1, s[16:19], s34 offen sc1 lds
    s_add_u32 m0, s33, 155648
    s_add_u32 s34, s78, 217088
    buffer_load_dwordx4 v1, s[16:19], s34 offen sc1 lds
    s_add_u32 m0, s33, 159744
    s_add_u32 s34, s78, 221184
    buffer_load_dwordx4 v1, s[16:19], s34 offen sc1 lds
    s_add_u32 m0, s33, 0
    s_add_u32 s34, s78, 225280
    buffer_load_dwordx4 v1, s[16:19], s34 offen sc1 lds
    s_add_u32 m0, s33, 4096
    s_add_u32 s34, s78, 229376
    buffer_load_dwordx4 v1, s[16:19], s34 offen sc1 lds
    s_waitcnt vmcnt(15)
    s_barrier
    s_add_u32 m0, s33, 8192
    s_add_u32 s34, s78, 233472
    buffer_load_dwordx4 v1, s[16:19], s34 offen sc1 lds
    s_add_u32 m0, s33, 12288
    s_add_u32 s34, s78, 237568
    buffer_load_dwordx4 v1, s[16:19], s34 offen sc1 lds
    s_add_u32 m0, s33, 16384
    s_add_u32 s34, s78, 241664
    buffer_load_dwordx4 v1, s[16:19], s34 offen sc1 lds
    s_add_u32 m0, s33, 20480
    s_add_u32 s34, s78, 245760
    buffer_load_dwordx4 v1, s[16:19], s34 offen sc1 lds
    s_add_u32 m0, s33, 24576
    s_add_u32 s34, s78, 249856
    buffer_load_dwordx4 v1, s[16:19], s34 offen sc1 lds
    s_add_u32 m0, s33, 28672
    s_add_u32 s34, s78, 253952
    buffer_load_dwordx4 v1, s[16:19], s34 offen sc1 lds
    s_add_u32 m0, s33, 32768
    s_add_u32 s34, s78, 258048
    buffer_load_dwordx4 v1, s[16:19], s34 offen sc1 lds
    s_waitcnt vmcnt(15)
    s_barrier
    s_add_u32 m0, s33, 36864
    s_add_u32 s34, s78, 262144
    buffer_load_dwordx4 v1, s[16:19], s34 offen sc1 lds
    s_add_u32 m0, s33, 40960
    s_add_u32 s34, s78, 266240
    buffer_load_dwordx4 v1, s[16:19], s34 offen sc1 lds
    s_add_u32 m0, s33, 45056
    s_add_u32 s34, s78, 270336
    buffer_load_dwordx4 v1, s[16:19], s34 offen sc1 lds
    s_add_u32 m0, s33, 49152
    s_add_u32 s34, s78, 274432
    buffer_load_dwordx4 v1, s[16:19], s34 offen sc1 lds
    s_add_u32 m0, s33, 53248
    s_add_u32 s34, s78, 278528
    buffer_load_dwordx4 v1, s[16:19], s34 offen sc1 lds
    s_add_u32 m0, s33, 57344
    s_add_u32 s34, s78, 282624
    buffer_load_dwordx4 v1, s[16:19], s34 offen sc1 lds
    s_add_u32 m0, s33, 61440
    s_add_u32 s34, s78, 286720
    buffer_load_dwordx4 v1, s[16:19], s34 offen sc1 lds
    s_add_u32 m0, s33, 65536
    s_add_u32 s34, s78, 290816
    buffer_load_dwordx4 v1, s[16:19], s34 offen sc1 lds
    s_add_u32 m0, s33, 69632
    s_add_u32 s34, s79, 0
    buffer_load_dwordx4 v1, s[16:19], s34 offen sc1 lds
    s_add_u32 m0, s33, 73728
    s_add_u32 s34, s79, 4096
    buffer_load_dwordx4 v1, s[16:19], s34 offen sc1 lds
    s_waitcnt vmcnt(18)
    s_barrier
    s_add_u32 m0, s33, 77824
    s_add_u32 s34, s79, 8192
    buffer_load_dwordx4 v1, s[16:19], s34 offen sc1 lds
    s_add_u32 m0, s33, 81920
    s_add_u32 s34, s79, 12288
    buffer_load_dwordx4 v1, s[16:19], s34 offen sc1 lds
    s_add_u32 m0, s33, 86016
    s_add_u32 s34, s79, 16384
    buffer_load_dwordx4 v1, s[16:19], s34 offen sc1 lds
    s_add_u32 m0, s33, 90112
    s_add_u32 s34, s79, 20480
    buffer_load_dwordx4 v1, s[16:19], s34 offen sc1 lds
    s_add_u32 m0, s33, 94208
    s_add_u32 s34, s79, 24576
    buffer_load_dwordx4 v1, s[16:19], s34 offen sc1 lds
    s_add_u32 m0, s33, 98304
    s_add_u32 s34, s79, 28672
    buffer_load_dwordx4 v1, s[16:19], s34 offen sc1 lds
    s_add_u32 m0, s33, 102400
    s_add_u32 s34, s79, 32768
    buffer_load_dwordx4 v1, s[16:19], s34 offen sc1 lds
    s_add_u32 m0, s33, 106496
    s_add_u32 s34, s79, 36864
    buffer_load_dwordx4 v1, s[16:19], s34 offen sc1 lds
    s_add_u32 m0, s33, 110592
    s_add_u32 s34, s79, 40960
    buffer_load_dwordx4 v1, s[16:19], s34 offen sc1 lds
    s_add_u32 m0, s33, 114688
    s_add_u32 s34, s79, 45056
    buffer_load_dwordx4 v1, s[16:19], s34 offen sc1 lds
    s_add_u32 m0, s33, 118784
    s_add_u32 s34, s79, 49152
    buffer_load_dwordx4 v1, s[16:19], s34 offen sc1 lds
    s_add_u32 m0, s33, 122880
    s_add_u32 s34, s79, 53248
    buffer_load_dwordx4 v1, s[16:19], s34 offen sc1 lds
    s_mov_b64 exec, 31
    global_load_dword v5, v175, s[74:75]
    s_mov_b64 exec, -1
    s_waitcnt vmcnt(24)
    s_barrier
    s_add_u32 m0, s33, 126976
    s_add_u32 s34, s79, 57344
    buffer_load_dwordx4 v1, s[16:19], s34 offen sc1 lds
    s_add_u32 m0, s33, 131072
    s_add_u32 s34, s79, 61440
    buffer_load_dwordx4 v1, s[16:19], s34 offen sc1 lds
    s_add_u32 m0, s33, 135168
    s_add_u32 s34, s79, 65536
    buffer_load_dwordx4 v1, s[16:19], s34 offen sc1 lds
    s_add_u32 m0, s33, 139264
    s_add_u32 s34, s79, 69632
    buffer_load_dwordx4 v1, s[16:19], s34 offen sc1 lds
    s_add_u32 m0, s33, 143360
    s_add_u32 s34, s79, 73728
    buffer_load_dwordx4 v1, s[16:19], s34 offen sc1 lds
    s_add_u32 m0, s33, 147456
    s_add_u32 s34, s79, 77824
    buffer_load_dwordx4 v1, s[16:19], s34 offen sc1 lds
    s_add_u32 m0, s33, 151552
    s_add_u32 s34, s79, 81920
    buffer_load_dwordx4 v1, s[16:19], s34 offen sc1 lds
    s_add_u32 m0, s33, 155648
    s_add_u32 s34, s79, 86016
    buffer_load_dwordx4 v1, s[16:19], s34 offen sc1 lds
    s_add_u32 m0, s33, 159744
    s_add_u32 s34, s79, 90112
    buffer_load_dwordx4 v1, s[16:19], s34 offen sc1 lds
    s_waitcnt vmcnt(24)
    s_barrier
    s_add_u32 m0, s33, 0
    s_add_u32 s34, s79, 94208
    buffer_load_dwordx4 v1, s[16:19], s34 offen sc1 lds
    s_add_u32 m0, s33, 4096
    s_add_u32 s34, s79, 98304
    buffer_load_dwordx4 v1, s[16:19], s34 offen sc1 lds
    s_add_u32 m0, s33, 8192
    s_add_u32 s34, s79, 102400
    buffer_load_dwordx4 v1, s[16:19], s34 offen sc1 lds
    s_add_u32 m0, s33, 12288
    s_add_u32 s34, s79, 106496
    buffer_load_dwordx4 v1, s[16:19], s34 offen sc1 lds
    s_add_u32 m0, s33, 16384
    s_add_u32 s34, s79, 110592
    buffer_load_dwordx4 v1, s[16:19], s34 offen sc1 lds
    s_add_u32 m0, s33, 20480
    s_add_u32 s34, s79, 114688
    buffer_load_dwordx4 v1, s[16:19], s34 offen sc1 lds
    s_add_u32 m0, s33, 24576
    s_add_u32 s34, s79, 118784
    buffer_load_dwordx4 v1, s[16:19], s34 offen sc1 lds
    s_add_u32 s34, s79, 122880
    buffer_load_dwordx4 v[176:179], v1, s[16:19], s34 offen sc1
    s_add_u32 s34, s79, 126976
    buffer_load_dwordx4 v[180:183], v1, s[16:19], s34 offen sc1
    s_add_u32 s34, s79, 131072
    buffer_load_dwordx4 v[184:187], v1, s[16:19], s34 offen sc1
    s_add_u32 s34, s79, 135168
    buffer_load_dwordx4 v[188:191], v1, s[16:19], s34 offen sc1
    s_waitcnt vmcnt(32)
    s_barrier
    s_waitcnt vmcnt(3)
    ds_write_b128 v7, v[176:179] offset:28672
    s_waitcnt vmcnt(2)
    ds_write_b128 v7, v[180:183] offset:32768
    s_waitcnt vmcnt(1)
    ds_write_b128 v7, v[184:187] offset:36864
    s_waitcnt vmcnt(0)
    ds_write_b128 v7, v[188:191] offset:40960
    s_waitcnt vmcnt(25) lgkmcnt(0)
    s_barrier
    s_waitcnt vmcnt(4)
    s_barrier
    s_lshl_b32 s34, s29, 10
    s_add_u32 s34, s34, 28069888
    v_and_b32 v6, 7, v10
    v_lshlrev_b32 v6, 7, v6
    v_bfe_u32 v5, v10, 3, 1
    v_lshl_add_u32 v6, v5, 14, v6
    s_cmp_eq_u32 s87, 0
    s_cselect_b32 s34, s34, 2146435072
    s_mov_b64 exec, 0xffff
    buffer_load_dword v5, v6, s[16:19], s34 offen sc1
    s_mov_b64 exec, -1
    s_endpgm
L_dr1:
    s_sub_u32 s56, s56, 1
    s_cbranch_scc1 L_do1
    s_sleep 8
    buffer_load_dword v67, v68, s[24:27], 0 offen sc1
    s_waitcnt vmcnt(0)
    s_branch L_dc1
L_dr2:
    s_sub_u32 s56, s56, 1
    s_cbranch_scc1 L_do2
    s_sleep 4
    buffer_load_dword v67, v75, s[16:19], 0 offen sc1
    s_waitcnt vmcnt(0)
    s_branch L_dc2
L_dr3:
    s_sub_u32 s56, s56, 1
    s_cbranch_scc1 L_do3
    s_sleep 16
    buffer_load_dword v67, v76, s[24:27], 0 offen sc1
    s_waitcnt vmcnt(0)
    s_branch L_dc3
L_sva:
    v_mul_u32_u24 v15, 320, v12
    s_lshl_b32 s82, s82, 6
    s_add_u32 s78, s78, 1280
    v_add3_u32 v4, s82, v11, 0
    v_mul_u32_u24 v5, 3277, v4
    v_lshrrev_b32 v5, 16, v5
    v_mul_u32_u24 v6, 20, v5
    v_sub_u32 v6, v4, v6
    v_mul_u32_u24 v5, 163840, v5
    v_lshl_add_u32 v5, v6, 4, v5
    v_add_u32 v248, v5, v15
    v_add3_u32 v4, s82, v11, 32
    v_mul_u32_u24 v5, 3277, v4
    v_lshrrev_b32 v5, 16, v5
    v_mul_u32_u24 v6, 20, v5
    v_sub_u32 v6, v4, v6
    v_mul_u32_u24 v5, 163840, v5
    v_lshl_add_u32 v5, v6, 4, v5
    v_add_u32 v249, v5, v15
    v_mov_b32 v250, -1
    v_mov_b32 v251, -1
    s_branch L_sja
L_svb:
    v_mul_u32_u24 v15, 320, v12
    s_lshl_b32 s82, s82, 6
    s_add_u32 s80, s80, 1280
    v_add3_u32 v4, s82, v11, 0
    v_mul_u32_u24 v5, 3277, v4
    v_lshrrev_b32 v5, 16, v5
    v_mul_u32_u24 v6, 20, v5
    v_sub_u32 v6, v4, v6
    v_mul_u32_u24 v5, 163840, v5
    v_lshl_add_u32 v5, v6, 4, v5
    v_add_u32 v252, v5, v15
    v_add3_u32 v4, s82, v11, 32
    v_mul_u32_u24 v5, 3277, v4
    v_lshrrev_b32 v5, 16, v5
    v_mul_u32_u24 v6, 20, v5
    v_sub_u32 v6, v4, v6
    v_mul_u32_u24 v5, 163840, v5
    v_lshl_add_u32 v5, v6, 4, v5
    v_add_u32 v253, v5, v15
    v_mov_b32 v254, -1
    v_mov_b32 v255, -1
    s_branch L_sjb
L_xr5:
    s_sub_u32 s56, s56, 1
    s_cbranch_scc1 L_xo5
    s_sleep 2
    buffer_load_dwordx2 v[6:7], v15, s[16:19], s82 offen sc1
    s_branch L_xc5
L_ms10:
    buffer_store_dwordx4 v[92:95], v252, s[16:19], s80 offen sc1
    s_branch L_mb10
L_ms12:
    buffer_store_dwordx2 v[92:93], v252, s[16:19], s80 offen sc1
    s_branch L_mb12
L_ms13:
    buffer_store_dwordx2 v[94:95], v252, s[16:19], s81 offen sc1
    s_branch L_mb13
L_ms14:
    buffer_store_dwordx4 v[100:103], v253, s[16:19], s80 offen sc1
    s_branch L_mb14
L_ms16:
    buffer_store_dwordx2 v[100:101], v253, s[16:19], s80 offen sc1
    s_branch L_mb16
L_ms17:
    buffer_store_dwordx2 v[102:103], v253, s[16:19], s81 offen sc1
    s_branch L_mb17
L_ms18:
    buffer_store_dwordx4 v[108:111], v254, s[16:19], s80 offen sc1
    s_branch L_mb18
L_ms20:
    buffer_store_dwordx2 v[108:109], v254, s[16:19], s80 offen sc1
    s_branch L_mb20
L_ms21:
    buffer_store_dwordx2 v[110:111], v254, s[16:19], s81 offen sc1
    s_branch L_mb21
L_ms22:
    buffer_store_dwordx4 v[116:119], v255, s[16:19], s80 offen sc1
    s_branch L_mb22
L_ms24:
    buffer_store_dwordx2 v[116:117], v255, s[16:19], s80 offen sc1
    s_branch L_mb24
L_ms25:
    buffer_store_dwordx2 v[118:119], v255, s[16:19], s81 offen sc1
    s_branch L_mb25
L_xr26:
    s_sub_u32 s56, s56, 1
    s_cbranch_scc1 L_xo26
    s_sleep 2
    buffer_load_dwordx2 v[6:7], v15, s[16:19], s82 offen sc1
    s_branch L_xc26
L_ms27:
    buffer_store_dwordx4 v[92:95], v252, s[16:19], s80 offen sc1
    s_branch L_mb27
L_ms29:
    buffer_store_dwordx2 v[92:93], v252, s[16:19], s80 offen sc1
    s_branch L_mb29
L_ms30:
    buffer_store_dwordx2 v[94:95], v252, s[16:19], s81 offen sc1
    s_branch L_mb30
L_ms31:
    buffer_store_dwordx4 v[100:103], v253, s[16:19], s80 offen sc1
    s_branch L_mb31
L_ms33:
    buffer_store_dwordx2 v[100:101], v253, s[16:19], s80 offen sc1
    s_branch L_mb33
L_ms34:
    buffer_store_dwordx2 v[102:103], v253, s[16:19], s81 offen sc1
    s_branch L_mb34
L_ms35:
    buffer_store_dwordx4 v[108:111], v254, s[16:19], s80 offen sc1
    s_branch L_mb35
L_ms37:
    buffer_store_dwordx2 v[108:109], v254, s[16:19], s80 offen sc1
    s_branch L_mb37
L_ms38:
    buffer_store_dwordx2 v[110:111], v254, s[16:19], s81 offen sc1
    s_branch L_mb38
L_ms39:
    buffer_store_dwordx4 v[116:119], v255, s[16:19], s80 offen sc1
    s_branch L_mb39
L_ms41:
    buffer_store_dwordx2 v[116:117], v255, s[16:19], s80 offen sc1
    s_branch L_mb41
L_ms42:
    buffer_store_dwordx2 v[118:119], v255, s[16:19], s81 offen sc1
    s_branch L_mb42
L_xr43:
    s_sub_u32 s56, s56, 1
    s_cbranch_scc1 L_xo43
    s_sleep 2
    buffer_load_dwordx2 v[6:7], v15, s[16:19], s82 offen sc1
    s_branch L_xc43
L_dr44:
    s_sub_u32 s56, s56, 1
    s_cbranch_scc1 L_do44
    s_sleep 16
    buffer_load_dword v67, v68, s[24:27], 0 offen sc1
    s_waitcnt vmcnt(0)
    s_branch L_dc44
L_dr45:
    s_sub_u32 s56, s56, 1
    s_cbranch_scc1 L_do45
    s_sleep 16
    buffer_load_dword v67, v75, s[16:19], 0 offen sc1
    s_waitcnt vmcnt(0)
    s_branch L_dc45
L_ms46:
    buffer_store_dword v127, off, s[16:19], s64 sc1
    s_branch L_mb46
L_dr47:
    s_sub_u32 s56, s56, 1
    s_cbranch_scc1 L_do47
    s_sleep 16
    buffer_load_dword v67, v76, s[24:27], 0 offen sc1
    s_waitcnt vmcnt(0)
    s_branch L_dc47
L_tb:
    s_mov_b32 s58, 1
    s_mov_b32 s12, s48
    s_mov_b32 s13, s49
    s_sub_u32 s34, s2, 112
    s_mul_i32 s3, s34, 2560
    s_and_b32 s35, s34, 1
    s_mul_i32 s35, s35, 135680
    s_add_u32 s3, s3, s35
    s_mul_i32 s59, s28, 276480
    s_add_u32 s59, s59, 25853952
    s_add_u32 s59, s59, s3
    s_cmp_ge_u32 s34, 16
    s_cselect_b32 s3, 109, -1
    s_cmp_ge_u32 s34, 31
    s_cselect_b32 s3, 212, s3
    s_mul_i32 s69, s34, 7
    s_sub_u32 s35, s69, 319
    s_sub_u32 s69, s69, s3
    s_lshr_b32 s69, s69, 1
    s_cmp_ge_u32 s34, 46
    s_cselect_b32 s69, s35, s69
    s_mul_i32 s69, s69, 40960
    s_cmp_lt_u32 s34, 54
    s_cselect_b32 s59, s59, 2146435072
    s_cselect_b32 s14, 2211840, 0
    s_mov_b32 s61, 2146435072
    s_mov_b32 s60, 1024
    s_mul_i32 s78, s28, 5120
    s_add_u32 s69, s69, s78
    v_add_u32 v4, 0, v10
    v_mul_u32_u24 v5, 52429, v4
    v_lshrrev_b32 v5, 22, v5
    v_mul_u32_u24 v6, 84, v5
    v_cmp_lt_u32 vcc, v4, v6
    v_lshlrev_b32 v5, 2, v5
    v_sub_u32 v4, v4, v5
    v_add_u32 v5, 80, v4
    v_cndmask_b32 v4, v4, v5, vcc
    v_lshlrev_b32 v216, 4, v4
    v_add_u32 v4, 64, v10
    v_mul_u32_u24 v5, 52429, v4
    v_lshrrev_b32 v5, 22, v5
    v_mul_u32_u24 v6, 84, v5
    v_cmp_lt_u32 vcc, v4, v6
    v_lshlrev_b32 v5, 2, v5
    v_sub_u32 v4, v4, v5
    v_add_u32 v5, 80, v4
    v_cndmask_b32 v4, v4, v5, vcc
    v_lshlrev_b32 v217, 4, v4
    v_add_u32 v4, 128, v10
    v_mul_u32_u24 v5, 52429, v4
    v_lshrrev_b32 v5, 22, v5
    v_mul_u32_u24 v6, 84, v5
    v_cmp_lt_u32 vcc, v4, v6
    v_lshlrev_b32 v5, 2, v5
    v_sub_u32 v4, v4, v5
    v_add_u32 v5, 80, v4
    v_cndmask_b32 v4, v4, v5, vcc
    v_lshlrev_b32 v218, 4, v4
    v_add_u32 v4, 192, v10
    v_mul_u32_u24 v5, 52429, v4
    v_lshrrev_b32 v5, 22, v5
    v_mul_u32_u24 v6, 84, v5
    v_cmp_lt_u32 vcc, v4, v6
    v_lshlrev_b32 v5, 2, v5
    v_sub_u32 v4, v4, v5
    v_add_u32 v5, 80, v4
    v_cndmask_b32 v4, v4, v5, vcc
    v_lshlrev_b32 v219, 4, v4
    v_add_u32 v4, 256, v10
    v_mul_u32_u24 v5, 52429, v4
    v_lshrrev_b32 v5, 22, v5
    v_mul_u32_u24 v6, 84, v5
    v_cmp_lt_u32 vcc, v4, v6
    v_lshlrev_b32 v5, 2, v5
    v_sub_u32 v4, v4, v5
    v_add_u32 v5, 80, v4
    v_cndmask_b32 v4, v4, v5, vcc
    v_lshlrev_b32 v220, 4, v4
    s_branch L_tj0
L_tb1:
    s_mul_i32 s78, s28, 10
    v_lshrrev_b32 v4, 4, v10
    v_bfe_u32 v5, v10, 2, 2
    v_lshl_add_u32 v4, v4, 3, v5
    v_mul_u32_u24 v4, 1280, v4
    v_add_u32 v4, 122880, v4
    v_lshl_add_u32 v5, v5, 2, s78
    v_and_b32 v6, 3, v10
    v_add3_u32 v7, v5, v6, 0
    v_cmp_lt_u32 vcc, 79, v7
    v_subrev_u32 v8, 80, v7
    s_nop 0
    v_cndmask_b32 v7, v7, v8, vcc
    v_lshl_add_u32 v176, v7, 4, v4
    v_add3_u32 v7, v5, v6, 4
    v_cmp_lt_u32 vcc, 79, v7
    v_subrev_u32 v8, 80, v7
    s_nop 0
    v_cndmask_b32 v7, v7, v8, vcc
    v_lshl_add_u32 v177, v7, 4, v4
    v_lshrrev_b32 v7, 1, v6
    v_add3_u32 v7, v5, v7, 8
    v_cmp_lt_u32 vcc, 79, v7
    v_subrev_u32 v8, 80, v7
    s_nop 0
    v_cndmask_b32 v7, v7, v8, vcc
    v_lshl_add_u32 v178, v7, 4, v4
    v_and_b32 v6, 1, v6
    v_lshl_add_u32 v178, v6, 3, v178
    s_branch L_tj
L_wr:
    s_sub_u32 s56, s56, 1
    s_cbranch_scc1 L_wo
    s_sleep 8
    buffer_load_dwordx4 v[224:227], v126, s[16:19], s83 offen sc1
    s_waitcnt vmcnt(0)
    s_branch L_wc
L_trb0:
    ds_read_b64_tr_b16 v[180:181], v176 offset:0
    ds_read_b64_tr_b16 v[182:183], v176 offset:5120
    s_branch L_trj0
L_trb1:
    ds_read_b64_tr_b16 v[184:185], v176 offset:8
    ds_read_b64_tr_b16 v[186:187], v176 offset:5128
    s_branch L_trj1
L_trb2:
    ds_read_b64_tr_b16 v[188:189], v177 offset:0
    ds_read_b64_tr_b16 v[190:191], v177 offset:5120
    s_branch L_trj2
L_trb3:
    ds_read_b64_tr_b16 v[192:193], v177 offset:8
    ds_read_b64_tr_b16 v[194:195], v177 offset:5128
    s_branch L_trj3
L_trb4:
    ds_read_b64_tr_b16 v[196:197], v178 offset:0
    ds_read_b64_tr_b16 v[198:199], v178 offset:5120
    s_branch L_trj4
L_fr:
    s_sub_u32 s56, s56, 1
    s_cbranch_scc1 L_fo
    s_sleep 8
    buffer_load_dword v8, v170, s[16:19], s81 offen sc1
    s_waitcnt vmcnt(0)
    s_branch L_fc
L_ms50:
    buffer_store_dwordx4 v[16:19], v173, s[16:19], s79 offen sc1
    s_branch L_mb50
L_ms51:
    buffer_store_dwordx2 v[20:21], v174, s[16:19], s80 offen sc1
    s_branch L_mb51
L_ms52:
    buffer_store_dword v4, off, s[16:19], s78 sc1
    s_branch L_mb52
L_ms54:
    buffer_store_dwordx4 v[246:249], v14, s[16:19], s79 offen sc1
    s_branch L_mb54
L_ms55:
    buffer_store_dwordx4 v[250:253], v14, s[16:19], s79 offen offset:2048 sc1
    s_branch L_mb55
L_ms56:
    buffer_store_dwordx2 v[254:255], v15, s[16:19], s79 offen sc1
    s_branch L_mb56
L_ms57:
    buffer_store_dword v6, v13, s[16:19], s80 offen sc1
    s_branch L_mb57
L_ms58:
    buffer_store_dword v4, off, s[16:19], s78 sc1
    s_branch L_mb58
L_ms60:
    buffer_store_dwordx4 v[156:159], v1, s[16:19], s79 offen sc1
    s_branch L_mb60
L_ms61:
    buffer_store_dwordx4 v[160:163], v15, s[16:19], s79 offen sc1
    s_branch L_mb61
L_ms62:
    buffer_store_dwordx4 v[164:167], v1, s[16:19], s80 offen sc1
    s_branch L_mb62
L_ms63:
    buffer_store_dwordx4 v[168:171], v15, s[16:19], s80 offen sc1
    s_branch L_mb63
L_ms64:
    buffer_store_dword v14, off, s[16:19], s78 offset:64 sc1
    s_branch L_mb64
L_ms65:
    buffer_store_dwordx4 v[172:175], v1, s[16:19], s37 offen sc1
    s_branch L_mb65
L_ms66:
    buffer_store_dwordx4 v[176:179], v15, s[16:19], s37 offen sc1
    s_branch L_mb66
L_ms67:
    buffer_store_dwordx2 v[180:181], v1, s[16:19], s83 offen sc1
    s_branch L_mb67
L_ms68:
    buffer_store_dwordx2 v[184:185], v15, s[16:19], s83 offen sc1
    s_branch L_mb68
L_rr69:
    s_sub_u32 s56, s56, 1
    s_cbranch_scc1 L_ro69
    buffer_load_dword v9, v13, s[16:19], s36 offen offset:64 sc1
    s_waitcnt vmcnt(0)
    s_branch L_rc69
L_ms70:
    buffer_store_dword v4, off, s[16:19], s78 sc1
    s_branch L_mb70
L_rr71:
    s_sub_u32 s56, s56, 1
    s_cbranch_scc1 L_ro71
    buffer_load_dword v9, v13, s[16:19], s36 offen sc1
    s_waitcnt vmcnt(0)
    s_branch L_rc71
L_ms72:
    buffer_store_dword v4, off, s[16:19], s44 sc1
    s_branch L_mb72
L_rr73:
    s_sub_u32 s56, s56, 1
    s_cbranch_scc1 L_ro73
    buffer_load_dword v9, v13, s[16:19], s43 offen sc1
    s_waitcnt vmcnt(0)
    s_branch L_rc73
L_ms74:
    buffer_store_dwordx4 v[246:249], v1, s[16:19], s39 offen offset:0 sc1
    s_branch L_mb74
L_ms75:
    buffer_store_dwordx4 v[250:253], v1, s[16:19], s39 offen offset:1024 sc1
    s_branch L_mb75
L_ms76:
    buffer_store_dwordx2 v[254:255], v5, s[16:19], s39 offen offset:2048 sc1
    s_branch L_mb76
L_ms77:
    buffer_store_dword v4, off, s[16:19], s41 sc1
    s_branch L_mb77
L_rr78:
    s_sub_u32 s56, s56, 1
    s_cbranch_scc1 L_ro78
    buffer_load_dword v9, off, s[16:19], s42 sc1
    s_waitcnt vmcnt(0)
    s_branch L_rc78
L_exact:
    s_cmp_lg_u32 s58, 0
    s_cbranch_scc1 L_pub
    s_mov_b32 s58, 1
    v_lshlrev_b32 v6, 3, v11
    v_mov_b32 v7, 0xff800000
    s_sub_u32 s34, s57, s33
    s_mov_b32 s56, 63
L_ex1:
    buffer_load_dwordx4 v[104:107], v1, s[16:19], s34 offen sc1
    buffer_load_dwordx2 v[112:113], v6, s[16:19], s34 offen offset:1024 sc1
    s_waitcnt vmcnt(0)
    v_mfma_f32_32x32x8_bf16 v[16:31], v[112:113], v[100:101], 0
    v_mfma_f32_32x32x16_bf16 v[16:31], v[104:107], v[96:99], v[16:31]
    s_add_u32 s34, s34, 2560
    s_sub_u32 s56, s56, 1
    s_nop 11
    v_max3_f32 v7, v7, v16, v17
    v_max3_f32 v7, v7, v18, v19
    v_max3_f32 v7, v7, v20, v21
    v_max3_f32 v7, v7, v22, v23
    v_max3_f32 v7, v7, v24, v25
    v_max3_f32 v7, v7, v26, v27
    v_max3_f32 v7, v7, v28, v29
    v_max3_f32 v7, v7, v30, v31
    s_cbranch_scc0 L_ex1
    v_mov_b32 v5, v7
    s_sub_u32 s34, s57, s33
    s_mov_b32 s56, 63
    v_permlane32_swap_b32 v5, v7
    v_max_f32 v7, v5, v7
    v_mov_b32 v80, 0
    v_mov_b32 v81, 0
    v_mov_b32 v82, 0
    v_mov_b32 v83, 0
    v_mov_b32 v84, 0
    v_mov_b32 v85, 0
    v_mov_b32 v86, 0
    v_mov_b32 v87, 0
    v_mov_b32 v88, 0
    v_mov_b32 v89, 0
    v_mov_b32 v90, 0
    v_mov_b32 v91, 0
    v_mov_b32 v92, 0
    v_mov_b32 v93, 0
    v_mov_b32 v94, 0
    v_mov_b32 v95, 0
L_ex2:
    buffer_load_dwordx4 v[104:107], v1, s[16:19], s34 offen sc1
    buffer_load_dwordx2 v[112:113], v6, s[16:19], s34 offen offset:1024 sc1
    s_mov_b64 exec, s[70:71]
    buffer_load_dwordx4 v[128:131], v13, s[16:19], s34 offen offset:1280 sc1
    buffer_load_dwordx4 v[132:135], v13, s[16:19], s34 offen offset:1920 sc1
    s_mov_b64 exec, -1
    s_waitcnt vmcnt(0)
    v_mfma_f32_32x32x8_bf16 v[16:31], v[112:113], v[100:101], 0
    v_mfma_f32_32x32x16_bf16 v[16:31], v[104:107], v[96:99], v[16:31]
    s_add_u32 s34, s34, 2560
    s_sub_u32 s56, s56, 1
    s_nop 11
    v_sub_f32 v16, v16, v7
    v_sub_f32 v17, v17, v7
    v_sub_f32 v18, v18, v7
    v_sub_f32 v19, v19, v7
    v_sub_f32 v20, v20, v7
    v_sub_f32 v21, v21, v7
    v_sub_f32 v22, v22, v7
    v_sub_f32 v23, v23, v7
    v_sub_f32 v24, v24, v7
    v_sub_f32 v25, v25, v7
    v_sub_f32 v26, v26, v7
    v_sub_f32 v27, v27, v7
    v_sub_f32 v28, v28, v7
    v_sub_f32 v29, v29, v7
    v_sub_f32 v30, v30, v7
    v_sub_f32 v31, v31, v7
    v_exp_f32 v16, v16
    v_exp_f32 v17, v17
    v_exp_f32 v18, v18
    v_exp_f32 v19, v19
    v_exp_f32 v20, v20
    v_exp_f32 v21, v21
    v_exp_f32 v22, v22
    v_exp_f32 v23, v23
    v_exp_f32 v24, v24
    v_exp_f32 v25, v25
    v_exp_f32 v26, v26
    v_exp_f32 v27, v27
    v_exp_f32 v28, v28
    v_exp_f32 v29, v29
    v_exp_f32 v30, v30
    v_exp_f32 v31, v31
    s_nop 1
    v_smfmac_f32_32x32x32_bf16 v[80:95], v[128:131], v[16:23], v114
    v_smfmac_f32_32x32x32_bf16 v[80:95], v[132:135], v[24:31], v114
    s_cbranch_scc0 L_ex2
    s_nop 11
    s_branch L_fin
L_end:
    s_endpgm
.section .rodata,"a"
.p2align 6
.amdhsa_kernel sequential_preLN__softmax_full_mha__glu_gated_bilinear__prompt_kernel
  .amdhsa_next_free_vgpr 256
  .amdhsa_next_free_sgpr 102
  .amdhsa_accum_offset 256
  .amdhsa_group_segment_fixed_size 0
  .amdhsa_kernarg_size 80
  .amdhsa_user_sgpr_count 2
  .amdhsa_user_sgpr_kernarg_segment_ptr 1
  .amdhsa_system_sgpr_workgroup_id_x 1
.end_amdhsa_kernel
```
